```python
import torch

def _softmax(x, axis=-1):
    return torch.softmax(x, dim=axis)

def _gelu(x):
    return torch.nn.functional.gelu(x, approximate='tanh')

def _silu(x):
    return torch.nn.functional.silu(x)

def _sigmoid(x):
    return torch.sigmoid(x)

def _layernorm(x, axis=-1, eps=1e-05):
    m = x.mean(dim=axis, keepdim=True)
    v = x.var(dim=axis, keepdim=True, unbiased=False)
    return (x - m) / torch.sqrt(v + eps)

def _scatter_add(tgt, idx, src, axis=0):
    return tgt.clone().index_add_(axis, idx, src)

def _segment_sum(src, seg, n):
    out = torch.zeros((n,) + src.shape[1:], dtype=src.dtype)
    return out.index_add_(0, seg, src)

def _pad(x, pw):
    flat = tuple((v for pair in reversed(pw) for v in pair))
    return torch.nn.functional.pad(x, flat)
kernel_name = 'parallel_sum__memory_aug_recurrent_mem_tr__glu_gated_reglu__prompt'

def setup_inputs():

    _w = lambda a: (lambda t: t.to(torch.bfloat16) if t.is_floating_point() else t)(torch.as_tensor(a))

    def _A_setup():
        B, S, Dm = (1, 2048, 640)
        H, Dh = (32, 192)
        M, seg = (8, 32)
        seg = min(seg, S)
        S = S // seg * seg
        return {'x': _w((lambda *s: torch.randn(*s, dtype=torch.bfloat16) * 0.05)(B, S, Dm)), 'mem0': _w((lambda *s: torch.randn(*s, dtype=torch.bfloat16) * 0.2)(B, M, Dm)), 'Wq': _w((lambda *s: torch.randn(*s, dtype=torch.bfloat16) * 1.6)(Dm, H, Dh) * Dm ** (-0.5)), 'Wk': _w((lambda *s: torch.randn(*s, dtype=torch.bfloat16) * 1.6)(Dm, H, Dh) * Dm ** (-0.5)), 'Wv': _w((lambda *s: torch.randn(*s, dtype=torch.bfloat16) * 0.2)(Dm, H, Dh) * Dm ** (-0.5)), 'Wo': _w((lambda *s: torch.randn(*s, dtype=torch.bfloat16) * 0.2)(H, Dh, Dm) * (H * Dh) ** (-0.5)), 'seg_len': seg}
    _A_in = _A_setup()

    def _B_setup():
        B, S, D, F = (1, 2048, 640, 1536)
        return {'x': _w((lambda *s: torch.randn(*s, dtype=torch.bfloat16) * 0.05)(B, S, D)), 'W_gate': _w((lambda *s: torch.randn(*s, dtype=torch.bfloat16) * 0.2)(D, F) * (2.0 / D) ** 0.5), 'W_up': _w((lambda *s: torch.randn(*s, dtype=torch.bfloat16) * 0.2)(D, F) * (2.0 / D) ** 0.5), 'W_down': _w((lambda *s: torch.randn(*s, dtype=torch.bfloat16) * 0.2)(F, D) * (1.0 / F) ** 0.5)}
    _B_in = _B_setup()
    return {'A_x': _A_in['x'], 'A_mem0': _A_in['mem0'], 'A_Wq': _A_in['Wq'], 'A_Wk': _A_in['Wk'], 'A_Wv': _A_in['Wv'], 'A_Wo': _A_in['Wo'], 'A_seg_len': _A_in['seg_len'], 'B_x': _B_in['x'], 'B_W_gate': _B_in['W_gate'], 'B_W_up': _B_in['W_up'], 'B_W_down': _B_in['W_down']}

def reference(A_x, A_mem0, A_Wq, A_Wk, A_Wv, A_Wo, A_seg_len, B_x, B_W_gate, B_W_up, B_W_down):

    def _A_ref(x, mem0, Wq, Wk, Wv, Wo, seg_len):
        B, S, Dm = x.shape
        H, Dh = (Wq.shape[1], Wq.shape[2])
        M = mem0.shape[1]
        scale = Dh ** (-0.5)
        n_seg = S // seg_len
        L = M + seg_len
        idx = torch.arange(L)
        mask = (idx[:, None] < M) | (idx[:, None] >= idx[None, :])
        mem = mem0
        outs = []
        for s in range(n_seg):
            xs = x[:, s * seg_len:(s + 1) * seg_len, :].clone()
            h = torch.concatenate([mem, xs], axis=1)
            q = torch.einsum('btd,dhe->bhte', h, Wq)
            k = torch.einsum('btd,dhe->bhte', h, Wk)
            v = torch.einsum('btd,dhe->bhte', h, Wv)
            scores = torch.einsum('bhqe,bhke->bhqk', q, k) * scale
            scores = torch.where(mask[None, None], scores, -1000000000.0)
            p = _softmax(scores, axis=-1)
            o = torch.einsum('bhqk,bhke->bhqe', p, v)
            o = torch.einsum('bhte,hed->btd', o, Wo)
            mem = o[:, :M, :].clone()
            outs.append(o[:, M:, :])
        return torch.concatenate(outs, axis=1)

    def _B_ref(x, W_gate, W_up, W_down):
        gate = torch.einsum('bsd,df->bsf', x, W_gate)
        up = torch.einsum('bsd,df->bsf', x, W_up)
        gate = gate * (lambda x, dt: x.to(dt))(gate > 0, gate.dtype)
        h = gate * up
        return torch.einsum('bsf,fd->bsd', h, W_down)
    x = A_x
    xn = _layernorm(x, axis=-1)
    return x + _A_ref(xn, A_mem0, A_Wq, A_Wk, A_Wv, A_Wo, A_seg_len) + _B_ref(xn, B_W_gate, B_W_up, B_W_down)
```

```asm
; @launch kernel=prep_kernel grid=(512,1,1) block=(256,1,1) lds=0
; @launch kernel=mega_kernel grid=(256,1,1) block=(256,1,1) lds=163840
.amdgcn_target "amdgcn-amd-amdhsa--gfx950"
.text
.globl prep_kernel
.p2align 8
.type prep_kernel,@function
prep_kernel:
    s_cmp_ge_u32 s2, 512
    s_cbranch_scc1 prep_done
    s_load_dwordx2 s[4:5], s[0:1], 0
    s_load_dwordx2 s[6:7], s[0:1], 8
    s_load_dwordx2 s[24:25], s[0:1], 104
    s_waitcnt lgkmcnt(0)
    s_mov_b32 s8, s4
    s_mov_b32 s9, s5
    s_mov_b32 s10, 2621440
    s_mov_b32 s11, 0x00020000
    s_mov_b32 s12, s24
    s_mov_b32 s13, s25
    s_mov_b32 s14, 2621440
    s_mov_b32 s15, 0x00020000
    s_add_u32 s16, s24, 194521088
    s_addc_u32 s17, s25, 0
    s_mov_b32 s18, 1968128
    s_mov_b32 s19, 0x00020000
    s_mov_b32 s20, s6
    s_mov_b32 s21, s7
    s_mov_b32 s22, 10240
    s_mov_b32 s23, 0x00020000
    s_add_u32 s28, s24, 194510848
    s_addc_u32 s29, s25, 0
    s_mov_b32 s30, 10240
    s_mov_b32 s31, 0x00020000
    s_lshl_b32 s3, s2, 8
    v_add_u32 v1, s3, v0
    v_lshlrev_b32 v2, 4, v1
    v_mov_b32 v4, -1
    v_mov_b32 v5, -1
    v_mov_b32 v6, -1
    v_mov_b32 v7, -1
    buffer_store_dwordx4 v[4:7], v2, s[16:19], 0 offen
    s_add_u32 s32, s24, 231616512
    s_addc_u32 s33, s25, 0
    s_mov_b32 s34, 65536
    s_mov_b32 s35, 0x00020000
    v_mov_b32 v56, 0
    v_mov_b32 v57, 0
    v_mov_b32 v58, 0
    v_mov_b32 v59, 0
    buffer_store_dwordx4 v[56:59], v2, s[32:35], 0 offen
    v_lshrrev_b32 v3, 3, v1
    v_and_b32 v8, 7, v1
    v_mul_u32_u24 v8, 1280, v8
    v_lshl_add_u32 v8, v3, 4, v8
    v_mov_b32 v9, 0x7fffffff
    v_cmp_gt_u32 vcc, 640, v1
    s_nop 1
    v_cndmask_b32 v8, v9, v8, vcc
    v_cndmask_b32 v2, v9, v2, vcc
    buffer_load_dwordx4 v[40:43], v8, s[20:23], 0 offen
    v_lshrrev_b32 v10, 6, v0
    v_and_b32 v11, 63, v0
    s_lshl_b32 s3, s2, 2
    v_add_u32 v10, s3, v10
    v_mul_u32_u24 v10, 1280, v10
    v_lshl_add_u32 v10, v11, 2, v10
    buffer_load_dword v12, v10, s[8:11], 0 offen offset:0
    buffer_load_dword v13, v10, s[8:11], 0 offen offset:256
    buffer_load_dword v14, v10, s[8:11], 0 offen offset:512
    buffer_load_dword v15, v10, s[8:11], 0 offen offset:768
    buffer_load_dword v16, v10, s[8:11], 0 offen offset:1024
    s_waitcnt vmcnt(5)
    v_min_u32 v40, -2, v40
    v_min_u32 v41, -2, v41
    v_min_u32 v42, -2, v42
    v_min_u32 v43, -2, v43
    buffer_store_dwordx4 v[40:43], v2, s[28:31], 0 offen
    s_waitcnt vmcnt(1)
    v_lshlrev_b32 v20, 16, v12
    v_and_b32 v21, 0xffff0000, v12
    v_lshlrev_b32 v22, 16, v13
    v_and_b32 v23, 0xffff0000, v13
    v_lshlrev_b32 v24, 16, v14
    v_and_b32 v25, 0xffff0000, v14
    v_lshlrev_b32 v26, 16, v15
    v_and_b32 v27, 0xffff0000, v15
    v_lshlrev_b32 v28, 16, v16
    v_and_b32 v29, 0xffff0000, v16
    v_add_f32 v30, v20, v21
    v_add_f32 v30, v30, v22
    v_add_f32 v30, v30, v23
    v_add_f32 v30, v30, v24
    v_add_f32 v30, v30, v25
    v_add_f32 v30, v30, v26
    v_add_f32 v30, v30, v27
    v_add_f32 v30, v30, v28
    v_add_f32 v30, v30, v29
    s_nop 1
    v_add_f32_dpp v30, v30, v30 row_shr:1 row_mask:0xf bank_mask:0xf
    s_nop 1
    v_add_f32_dpp v30, v30, v30 row_shr:2 row_mask:0xf bank_mask:0xf
    s_nop 1
    v_add_f32_dpp v30, v30, v30 row_shr:4 row_mask:0xf bank_mask:0xf
    s_nop 1
    v_add_f32_dpp v30, v30, v30 row_shr:8 row_mask:0xf bank_mask:0xf
    s_nop 1
    v_add_f32_dpp v30, v30, v30 row_bcast:15 row_mask:0xa bank_mask:0xf
    s_nop 1
    v_add_f32_dpp v30, v30, v30 row_bcast:31 row_mask:0xc bank_mask:0xf
    s_nop 1
    v_readlane_b32 s34, v30, 63
    s_nop 3
    v_mov_b32 v31, 0x3acccccd
    v_mul_f32 v31, s34, v31
    v_sub_f32 v44, v20, v31
    v_sub_f32 v45, v21, v31
    v_sub_f32 v46, v22, v31
    v_sub_f32 v47, v23, v31
    v_sub_f32 v48, v24, v31
    v_sub_f32 v49, v25, v31
    v_sub_f32 v50, v26, v31
    v_sub_f32 v51, v27, v31
    v_sub_f32 v52, v28, v31
    v_sub_f32 v53, v29, v31
    v_mul_f32 v30, v44, v44
    v_fmac_f32 v30, v45, v45
    v_fmac_f32 v30, v46, v46
    v_fmac_f32 v30, v47, v47
    v_fmac_f32 v30, v48, v48
    v_fmac_f32 v30, v49, v49
    v_fmac_f32 v30, v50, v50
    v_fmac_f32 v30, v51, v51
    v_fmac_f32 v30, v52, v52
    v_fmac_f32 v30, v53, v53
    s_nop 1
    v_add_f32_dpp v30, v30, v30 row_shr:1 row_mask:0xf bank_mask:0xf
    s_nop 1
    v_add_f32_dpp v30, v30, v30 row_shr:2 row_mask:0xf bank_mask:0xf
    s_nop 1
    v_add_f32_dpp v30, v30, v30 row_shr:4 row_mask:0xf bank_mask:0xf
    s_nop 1
    v_add_f32_dpp v30, v30, v30 row_shr:8 row_mask:0xf bank_mask:0xf
    s_nop 1
    v_add_f32_dpp v30, v30, v30 row_bcast:15 row_mask:0xa bank_mask:0xf
    s_nop 1
    v_add_f32_dpp v30, v30, v30 row_bcast:31 row_mask:0xc bank_mask:0xf
    s_nop 1
    v_readlane_b32 s35, v30, 63
    s_nop 3
    v_mov_b32 v32, 0x3acccccd
    v_mul_f32 v32, s35, v32
    v_cvt_pk_bf16_f32 v33, v31, v32
    v_lshlrev_b32 v31, 16, v33
    v_and_b32 v32, 0xffff0000, v33
    v_add_f32 v32, 0x3727c5ac, v32
    v_cvt_pk_bf16_f32 v33, v32, v32
    v_and_b32 v32, 0xffff0000, v33
    v_sqrt_f32 v32, v32
    s_nop 0
    v_cvt_pk_bf16_f32 v33, v32, v32
    v_and_b32 v32, 0xffff0000, v33
    v_rcp_f32 v34, v32
    s_nop 0
    v_sub_f32 v36, v20, v31
    v_sub_f32 v37, v21, v31
    v_cvt_pk_bf16_f32 v38, v36, v37
    v_lshlrev_b32 v36, 16, v38
    v_and_b32 v37, 0xffff0000, v38
    v_mul_f32 v38, v36, v34
    v_mul_f32 v39, v37, v34
    v_fma_f32 v36, -v38, v32, v36
    v_fma_f32 v37, -v39, v32, v37
    v_fmac_f32 v38, v36, v34
    v_fmac_f32 v39, v37, v34
    v_cvt_pk_bf16_f32 v12, v38, v39
    buffer_store_dword v12, v10, s[12:15], 0 offen offset:0
    v_sub_f32 v36, v22, v31
    v_sub_f32 v37, v23, v31
    v_cvt_pk_bf16_f32 v38, v36, v37
    v_lshlrev_b32 v36, 16, v38
    v_and_b32 v37, 0xffff0000, v38
    v_mul_f32 v38, v36, v34
    v_mul_f32 v39, v37, v34
    v_fma_f32 v36, -v38, v32, v36
    v_fma_f32 v37, -v39, v32, v37
    v_fmac_f32 v38, v36, v34
    v_fmac_f32 v39, v37, v34
    v_cvt_pk_bf16_f32 v13, v38, v39
    buffer_store_dword v13, v10, s[12:15], 0 offen offset:256
    v_sub_f32 v36, v24, v31
    v_sub_f32 v37, v25, v31
    v_cvt_pk_bf16_f32 v38, v36, v37
    v_lshlrev_b32 v36, 16, v38
    v_and_b32 v37, 0xffff0000, v38
    v_mul_f32 v38, v36, v34
    v_mul_f32 v39, v37, v34
    v_fma_f32 v36, -v38, v32, v36
    v_fma_f32 v37, -v39, v32, v37
    v_fmac_f32 v38, v36, v34
    v_fmac_f32 v39, v37, v34
    v_cvt_pk_bf16_f32 v14, v38, v39
    buffer_store_dword v14, v10, s[12:15], 0 offen offset:512
    v_sub_f32 v36, v26, v31
    v_sub_f32 v37, v27, v31
    v_cvt_pk_bf16_f32 v38, v36, v37
    v_lshlrev_b32 v36, 16, v38
    v_and_b32 v37, 0xffff0000, v38
    v_mul_f32 v38, v36, v34
    v_mul_f32 v39, v37, v34
    v_fma_f32 v36, -v38, v32, v36
    v_fma_f32 v37, -v39, v32, v37
    v_fmac_f32 v38, v36, v34
    v_fmac_f32 v39, v37, v34
    v_cvt_pk_bf16_f32 v15, v38, v39
    buffer_store_dword v15, v10, s[12:15], 0 offen offset:768
    v_sub_f32 v36, v28, v31
    v_sub_f32 v37, v29, v31
    v_cvt_pk_bf16_f32 v38, v36, v37
    v_lshlrev_b32 v36, 16, v38
    v_and_b32 v37, 0xffff0000, v38
    v_mul_f32 v38, v36, v34
    v_mul_f32 v39, v37, v34
    v_fma_f32 v36, -v38, v32, v36
    v_fma_f32 v37, -v39, v32, v37
    v_fmac_f32 v38, v36, v34
    v_fmac_f32 v39, v37, v34
    v_cvt_pk_bf16_f32 v16, v38, v39
    buffer_store_dword v16, v10, s[12:15], 0 offen offset:1024
prep_done:
    s_endpgm
.section .rodata,"a"
.p2align 6
.amdhsa_kernel prep_kernel
  .amdhsa_next_free_vgpr 64
  .amdhsa_next_free_sgpr 40
  .amdhsa_accum_offset 64
  .amdhsa_group_segment_fixed_size 0
  .amdhsa_kernarg_size 112
  .amdhsa_user_sgpr_count 2
  .amdhsa_user_sgpr_kernarg_segment_ptr 1
  .amdhsa_system_sgpr_workgroup_id_x 1
.end_amdhsa_kernel
.text
.globl mega_kernel
.p2align 8
.type mega_kernel,@function
mega_kernel:
    s_cmp_ge_u32 s2, 256
    s_cbranch_scc1 chain_end
    s_load_dwordx2 s[64:65], s[0:1], 104
    s_load_dwordx2 s[36:37], s[0:1], 96
    s_mov_b32 s60, s2
    v_readfirstlane_b32 s61, v0
    s_waitcnt lgkmcnt(0)
    s_lshr_b32 s61, s61, 6
    s_add_u32 s56, s64, 231616512
    s_addc_u32 s57, s65, 0
    s_mov_b32 s58, 131072
    s_mov_b32 s59, 0x00020000
    s_mov_b32 s63, 0
    s_cmp_lt_u32 s60, 32
    s_cbranch_scc1 mega_roles
    s_mov_b32 s66, 0
    s_mov_b32 s75, 0
    s_cmp_lg_u32 s61, 0
    s_cbranch_scc1 if_skip_1
    s_mov_b64 exec, 1
    v_accvgpr_write_b32 a255, 1
    v_mov_b32 v3, 0
    s_nop 1
    buffer_atomic_add a255, v3, s[56:59], s75 offen sc0 sc1
    s_mov_b64 exec, -1
if_skip_1:
    s_waitcnt vmcnt(0)
    s_xor_b32 s66, s66, 16
    v_mov_b32 v3, 160000
    v_add_u32 v3, s66, v3
    s_cmp_lg_u32 s61, 0
    s_cbranch_scc1 fi1_2
    v_accvgpr_read_b32 v2, a255
    s_mov_b64 exec, 1
    ds_write_b32 v3, v2
    s_mov_b64 exec, -1
    s_waitcnt lgkmcnt(0)
fi1_2:
    s_barrier
    ds_read_b32 v4, v3
    s_waitcnt lgkmcnt(0)
    v_readfirstlane_b32 s62, v4
    s_nop 3
mega_decA:
    s_cmp_ge_u32 s62, 224
    s_cbranch_scc1 mega_roles
    s_mov_b32 s70, 0
    s_cmp_ge_u32 s62, 128
    s_cbranch_scc1 mA1
    s_cmp_ge_u32 s62, 96
    s_cbranch_scc1 mA0
    s_and_b32 s71, s62, 31
    s_lshr_b32 s24, s62, 5
    s_lshl_b32 s72, s24, 1
    s_cmp_eq_u32 s24, 2
    s_cselect_b32 s73, 1, 2
    s_branch blk_vu
mA0:
    s_and_b32 s71, s62, 31
    s_mov_b32 s73, 0
    s_branch blk_qkv
mA1:
    s_sub_u32 s24, s62, 128
    s_lshr_b32 s70, s24, 5
    s_and_b32 s71, s24, 31
    s_branch blk_bt
mega_roles:
    s_mov_b32 s63, 1
    s_mov_b32 s2, s60
    s_cmp_lt_u32 s60, 112
    s_cbranch_scc1 chain_entry
    s_mov_b32 s75, 128
mega_loopB:
    s_cmp_lg_u32 s61, 0
    s_cbranch_scc1 if_skip_4
    s_mov_b64 exec, 1
    v_accvgpr_write_b32 a255, 1
    v_mov_b32 v3, 0
    s_nop 1
    buffer_atomic_add a255, v3, s[56:59], s75 offen sc0 sc1
    s_mov_b64 exec, -1
if_skip_4:
    s_waitcnt vmcnt(0)
    s_xor_b32 s66, s66, 16
    v_mov_b32 v3, 160000
    v_add_u32 v3, s66, v3
    s_cmp_lg_u32 s61, 0
    s_cbranch_scc1 fi1_5
    v_accvgpr_read_b32 v2, a255
    s_mov_b64 exec, 1
    ds_write_b32 v3, v2
    s_mov_b64 exec, -1
    s_waitcnt lgkmcnt(0)
fi1_5:
    s_barrier
    ds_read_b32 v4, v3
    s_waitcnt lgkmcnt(0)
    v_readfirstlane_b32 s62, v4
    s_nop 3
mega_decB:
    s_cmp_ge_u32 s62, 2102
    s_cbranch_scc1 chain_end
    s_mov_b32 s67, s62
    s_cmp_lt_u32 s62, 932
    s_cbranch_scc1 mB_p1
    s_sub_u32 s27, s62, 932
    s_mul_i32 s24, s27, 3641
    s_lshr_b32 s24, s24, 16
    s_mul_i32 s25, s24, 18
    s_sub_u32 s25, s27, s25
    s_cmp_ge_u32 s25, 8
    s_cbranch_scc1 mB_f2
    s_cmp_ge_u32 s24, 64
    s_cbranch_scc1 mega_loopB
    s_mov_b32 s3, s24
    s_mov_b32 s2, s25
    s_branch blk_f1
mB_f2:
    s_cmp_eq_u32 s24, 0
    s_cbranch_scc1 mega_loopB
    s_sub_u32 s3, s24, 1
    s_sub_u32 s2, s25, 8
    s_branch blk_f2
mB_p1:
    s_mul_i32 s24, s62, 9040
    s_lshr_b32 s24, s24, 20
    s_mul_i32 s25, s24, 116
    s_sub_u32 s25, s62, s25
    s_add_u32 s24, s24, 1
    s_cmp_lt_u32 s24, 9
    s_cbranch_scc1 mB_sel
    s_add_u32 s25, s25, 112
mB_sel:
    s_cmp_ge_u32 s25, 32
    s_cbranch_scc1 mB_7
    s_sub_u32 s70, s24, 0
    s_cmp_gt_u32 s70, 7
    s_cbranch_scc1 mega_loopB
    s_sub_u32 s26, s25, 0
    s_mov_b32 s71, s26
    s_mov_b32 s72, 0
    s_mov_b32 s73, 5
    s_branch blk_vu
mB_7:
    s_cmp_ge_u32 s25, 64
    s_cbranch_scc1 mB_8
    s_sub_u32 s70, s24, 0
    s_cmp_gt_u32 s70, 7
    s_cbranch_scc1 mega_loopB
    s_sub_u32 s26, s25, 32
    s_mov_b32 s71, s26
    s_mov_b32 s73, 0
    s_branch blk_qkv
mB_8:
    s_cmp_ge_u32 s25, 96
    s_cbranch_scc1 mB_9
    s_sub_u32 s70, s24, 1
    s_cmp_gt_u32 s70, 7
    s_cbranch_scc1 mega_loopB
    s_sub_u32 s26, s25, 64
    s_mov_b32 s71, s26
    s_mov_b32 s73, 2
    s_branch blk_qkv
mB_9:
    s_cmp_ge_u32 s25, 112
    s_cbranch_scc1 mB_10
    s_sub_u32 s70, s24, 1
    s_cmp_gt_u32 s70, 7
    s_cbranch_scc1 mega_loopB
    s_sub_u32 s26, s25, 96
    s_mov_b32 s71, s26
    s_branch blk_glu
mB_10:
    s_cmp_ge_u32 s25, 116
    s_cbranch_scc1 mB_11
    s_sub_u32 s70, s24, 2
    s_cmp_gt_u32 s70, 7
    s_cbranch_scc1 mega_loopB
    s_sub_u32 s26, s25, 112
    s_mov_b32 s71, s26
    s_branch blk_down
mB_11:
    s_branch mega_loopB
blk_qkv:
    s_load_dwordx4 s[32:35], s[0:1], 16
    s_load_dwordx2 s[36:37], s[0:1], 32
    s_mov_b32 s8, s64
    s_mov_b32 s9, s65
    s_mov_b32 s10, 2621440
    s_mov_b32 s11, 0x00020000
    s_add_u32 s16, s64, 2621440
    s_addc_u32 s17, s65, 0
    s_mov_b32 s18, 75497472
    s_mov_b32 s19, 0x00020000
    s_waitcnt lgkmcnt(0)
    s_cmp_eq_u32 s73, 0
    s_cselect_b32 s40, s34, s36
    s_cselect_b32 s41, s35, s37
    s_cmp_eq_u32 s73, 2
    s_cselect_b32 s40, s32, s40
    s_cselect_b32 s41, s33, s41
    s_mov_b32 s12, s40
    s_mov_b32 s13, s41
    s_mov_b32 s14, 7864320
    s_mov_b32 s15, 0x00020000
    s_mul_i32 s20, s70, 327680
    s_mul_i32 s21, s71, 384
    s_mul_i32 s23, s73, 25165824
    s_mul_i32 s24, s70, 3145728
    s_add_u32 s23, s23, s24
    s_add_u32 s23, s23, s21
    s_add_u32 s74, s70, 8
    s_add_u32 s24, s70, 24
    s_cmp_eq_u32 s73, 2
    s_cselect_b32 s74, s24, s74
    s_lshl_b32 s24, s70, 5
    s_add_u32 s24, s24, s71
    s_add_u32 s24, s24, 128
    s_cmp_eq_u32 s73, 1
    s_cselect_b32 s74, s24, s74
    s_lshl_b32 s74, s74, 7
    v_lshrrev_b32 v1, 3, v0
    v_and_b32 v60, 7, v0
    s_mov_b32 s24, 1280
    v_mul_lo_u32 v2, v1, s24
    v_lshl_add_u32 v2, v60, 4, v2
    v_add_u32 v3, 40960, v2
    v_add_u32 v4, 81920, v2
    v_add_u32 v5, 122880, v2
    v_add_u32 v6, 163840, v2
    v_add_u32 v7, 204800, v2
    v_add_u32 v8, 245760, v2
    v_add_u32 v9, 286720, v2
    v_mul_u32_u24 v12, 144, v1
    v_lshl_add_u32 v12, v60, 4, v12
    v_add_u32 v13, 63488, v12
    s_mov_b32 s24, 12288
    v_mul_lo_u32 v10, v1, s24
    v_lshl_add_u32 v10, v60, 4, v10
    v_add_u32 v11, 393216, v10
    v_mul_u32_u24 v14, 416, v1
    v_lshl_add_u32 v14, v60, 4, v14
    v_add_u32 v14, 36864, v14
    v_add_u32 v15, 63488, v14
    v_and_b32 v60, 15, v0
    v_bfe_u32 v61, v0, 4, 2
    v_lshrrev_b32 v62, 7, v0
    v_bfe_u32 v63, v0, 6, 1
    v_lshl_add_u32 v64, v62, 7, v60
    v_mul_u32_u24 v16, 144, v64
    v_lshl_add_u32 v16, v61, 3, v16
    v_add_u32 v17, 63488, v16
    v_lshrrev_b32 v64, 2, v60
    v_lshl_add_u32 v64, v61, 2, v64
    v_mul_u32_u24 v18, 416, v64
    v_and_b32 v64, 3, v60
    v_lshl_add_u32 v18, v64, 3, v18
    v_mul_u32_u24 v64, 192, v63
    v_add_u32 v18, v64, v18
    v_add_u32 v18, 36864, v18
    v_add_u32 v19, 63488, v18
    buffer_load_dwordx4 v[20:23], v2, s[8:11], s20 offen
    buffer_load_dwordx4 v[24:27], v3, s[8:11], s20 offen
    buffer_load_dwordx4 v[28:31], v4, s[8:11], s20 offen
    buffer_load_dwordx4 v[32:35], v5, s[8:11], s20 offen
    buffer_load_dwordx4 v[36:39], v6, s[8:11], s20 offen
    buffer_load_dwordx4 v[40:43], v7, s[8:11], s20 offen
    buffer_load_dwordx4 v[44:47], v8, s[8:11], s20 offen
    buffer_load_dwordx4 v[48:51], v9, s[8:11], s20 offen
    buffer_load_dwordx4 v[52:55], v10, s[12:15], s21 offen offset:0
    buffer_load_dwordx4 v[56:59], v10, s[12:15], s21 offen offset:128
    buffer_load_dwordx4 v[60:63], v10, s[12:15], s21 offen offset:256
    buffer_load_dwordx4 v[64:67], v11, s[12:15], s21 offen offset:0
    buffer_load_dwordx4 v[68:71], v11, s[12:15], s21 offen offset:128
    buffer_load_dwordx4 v[72:75], v11, s[12:15], s21 offen offset:256
    s_add_u32 s20, s20, 128
    s_add_u32 s21, s21, 786432
    buffer_load_dwordx4 v[188:191], v2, s[8:11], s20 offen
    buffer_load_dwordx4 v[192:195], v3, s[8:11], s20 offen
    buffer_load_dwordx4 v[196:199], v4, s[8:11], s20 offen
    buffer_load_dwordx4 v[200:203], v5, s[8:11], s20 offen
    buffer_load_dwordx4 v[204:207], v6, s[8:11], s20 offen
    buffer_load_dwordx4 v[208:211], v7, s[8:11], s20 offen
    buffer_load_dwordx4 v[212:215], v8, s[8:11], s20 offen
    buffer_load_dwordx4 v[216:219], v9, s[8:11], s20 offen
    buffer_load_dwordx4 v[220:223], v10, s[12:15], s21 offen offset:0
    buffer_load_dwordx4 v[224:227], v10, s[12:15], s21 offen offset:128
    buffer_load_dwordx4 v[228:231], v10, s[12:15], s21 offen offset:256
    buffer_load_dwordx4 v[232:235], v11, s[12:15], s21 offen offset:0
    buffer_load_dwordx4 v[236:239], v11, s[12:15], s21 offen offset:128
    buffer_load_dwordx4 v[240:243], v11, s[12:15], s21 offen offset:256
    s_add_u32 s20, s20, 128
    s_add_u32 s21, s21, 786432
    v_accvgpr_write_b32 a0, 0
    v_accvgpr_write_b32 a1, 0
    v_accvgpr_write_b32 a2, 0
    v_accvgpr_write_b32 a3, 0
    v_accvgpr_write_b32 a4, 0
    v_accvgpr_write_b32 a5, 0
    v_accvgpr_write_b32 a6, 0
    v_accvgpr_write_b32 a7, 0
    v_accvgpr_write_b32 a8, 0
    v_accvgpr_write_b32 a9, 0
    v_accvgpr_write_b32 a10, 0
    v_accvgpr_write_b32 a11, 0
    v_accvgpr_write_b32 a12, 0
    v_accvgpr_write_b32 a13, 0
    v_accvgpr_write_b32 a14, 0
    v_accvgpr_write_b32 a15, 0
    v_accvgpr_write_b32 a16, 0
    v_accvgpr_write_b32 a17, 0
    v_accvgpr_write_b32 a18, 0
    v_accvgpr_write_b32 a19, 0
    v_accvgpr_write_b32 a20, 0
    v_accvgpr_write_b32 a21, 0
    v_accvgpr_write_b32 a22, 0
    v_accvgpr_write_b32 a23, 0
    v_accvgpr_write_b32 a24, 0
    v_accvgpr_write_b32 a25, 0
    v_accvgpr_write_b32 a26, 0
    v_accvgpr_write_b32 a27, 0
    v_accvgpr_write_b32 a28, 0
    v_accvgpr_write_b32 a29, 0
    v_accvgpr_write_b32 a30, 0
    v_accvgpr_write_b32 a31, 0
    v_accvgpr_write_b32 a32, 0
    v_accvgpr_write_b32 a33, 0
    v_accvgpr_write_b32 a34, 0
    v_accvgpr_write_b32 a35, 0
    v_accvgpr_write_b32 a36, 0
    v_accvgpr_write_b32 a37, 0
    v_accvgpr_write_b32 a38, 0
    v_accvgpr_write_b32 a39, 0
    v_accvgpr_write_b32 a40, 0
    v_accvgpr_write_b32 a41, 0
    v_accvgpr_write_b32 a42, 0
    v_accvgpr_write_b32 a43, 0
    v_accvgpr_write_b32 a44, 0
    v_accvgpr_write_b32 a45, 0
    v_accvgpr_write_b32 a46, 0
    v_accvgpr_write_b32 a47, 0
    v_accvgpr_write_b32 a48, 0
    v_accvgpr_write_b32 a49, 0
    v_accvgpr_write_b32 a50, 0
    v_accvgpr_write_b32 a51, 0
    v_accvgpr_write_b32 a52, 0
    v_accvgpr_write_b32 a53, 0
    v_accvgpr_write_b32 a54, 0
    v_accvgpr_write_b32 a55, 0
    v_accvgpr_write_b32 a56, 0
    v_accvgpr_write_b32 a57, 0
    v_accvgpr_write_b32 a58, 0
    v_accvgpr_write_b32 a59, 0
    v_accvgpr_write_b32 a60, 0
    v_accvgpr_write_b32 a61, 0
    v_accvgpr_write_b32 a62, 0
    v_accvgpr_write_b32 a63, 0
    v_accvgpr_write_b32 a64, 0
    v_accvgpr_write_b32 a65, 0
    v_accvgpr_write_b32 a66, 0
    v_accvgpr_write_b32 a67, 0
    v_accvgpr_write_b32 a68, 0
    v_accvgpr_write_b32 a69, 0
    v_accvgpr_write_b32 a70, 0
    v_accvgpr_write_b32 a71, 0
    v_accvgpr_write_b32 a72, 0
    v_accvgpr_write_b32 a73, 0
    v_accvgpr_write_b32 a74, 0
    v_accvgpr_write_b32 a75, 0
    v_accvgpr_write_b32 a76, 0
    v_accvgpr_write_b32 a77, 0
    v_accvgpr_write_b32 a78, 0
    v_accvgpr_write_b32 a79, 0
    v_accvgpr_write_b32 a80, 0
    v_accvgpr_write_b32 a81, 0
    v_accvgpr_write_b32 a82, 0
    v_accvgpr_write_b32 a83, 0
    v_accvgpr_write_b32 a84, 0
    v_accvgpr_write_b32 a85, 0
    v_accvgpr_write_b32 a86, 0
    v_accvgpr_write_b32 a87, 0
    v_accvgpr_write_b32 a88, 0
    v_accvgpr_write_b32 a89, 0
    v_accvgpr_write_b32 a90, 0
    v_accvgpr_write_b32 a91, 0
    v_accvgpr_write_b32 a92, 0
    v_accvgpr_write_b32 a93, 0
    v_accvgpr_write_b32 a94, 0
    v_accvgpr_write_b32 a95, 0
    v_accvgpr_write_b32 a96, 0
    v_accvgpr_write_b32 a97, 0
    v_accvgpr_write_b32 a98, 0
    v_accvgpr_write_b32 a99, 0
    v_accvgpr_write_b32 a100, 0
    v_accvgpr_write_b32 a101, 0
    v_accvgpr_write_b32 a102, 0
    v_accvgpr_write_b32 a103, 0
    v_accvgpr_write_b32 a104, 0
    v_accvgpr_write_b32 a105, 0
    v_accvgpr_write_b32 a106, 0
    v_accvgpr_write_b32 a107, 0
    v_accvgpr_write_b32 a108, 0
    v_accvgpr_write_b32 a109, 0
    v_accvgpr_write_b32 a110, 0
    v_accvgpr_write_b32 a111, 0
    v_accvgpr_write_b32 a112, 0
    v_accvgpr_write_b32 a113, 0
    v_accvgpr_write_b32 a114, 0
    v_accvgpr_write_b32 a115, 0
    v_accvgpr_write_b32 a116, 0
    v_accvgpr_write_b32 a117, 0
    v_accvgpr_write_b32 a118, 0
    v_accvgpr_write_b32 a119, 0
    v_accvgpr_write_b32 a120, 0
    v_accvgpr_write_b32 a121, 0
    v_accvgpr_write_b32 a122, 0
    v_accvgpr_write_b32 a123, 0
    v_accvgpr_write_b32 a124, 0
    v_accvgpr_write_b32 a125, 0
    v_accvgpr_write_b32 a126, 0
    v_accvgpr_write_b32 a127, 0
    v_accvgpr_write_b32 a128, 0
    v_accvgpr_write_b32 a129, 0
    v_accvgpr_write_b32 a130, 0
    v_accvgpr_write_b32 a131, 0
    v_accvgpr_write_b32 a132, 0
    v_accvgpr_write_b32 a133, 0
    v_accvgpr_write_b32 a134, 0
    v_accvgpr_write_b32 a135, 0
    v_accvgpr_write_b32 a136, 0
    v_accvgpr_write_b32 a137, 0
    v_accvgpr_write_b32 a138, 0
    v_accvgpr_write_b32 a139, 0
    v_accvgpr_write_b32 a140, 0
    v_accvgpr_write_b32 a141, 0
    v_accvgpr_write_b32 a142, 0
    v_accvgpr_write_b32 a143, 0
    v_accvgpr_write_b32 a144, 0
    v_accvgpr_write_b32 a145, 0
    v_accvgpr_write_b32 a146, 0
    v_accvgpr_write_b32 a147, 0
    v_accvgpr_write_b32 a148, 0
    v_accvgpr_write_b32 a149, 0
    v_accvgpr_write_b32 a150, 0
    v_accvgpr_write_b32 a151, 0
    v_accvgpr_write_b32 a152, 0
    v_accvgpr_write_b32 a153, 0
    v_accvgpr_write_b32 a154, 0
    v_accvgpr_write_b32 a155, 0
    v_accvgpr_write_b32 a156, 0
    v_accvgpr_write_b32 a157, 0
    v_accvgpr_write_b32 a158, 0
    v_accvgpr_write_b32 a159, 0
    v_accvgpr_write_b32 a160, 0
    v_accvgpr_write_b32 a161, 0
    v_accvgpr_write_b32 a162, 0
    v_accvgpr_write_b32 a163, 0
    v_accvgpr_write_b32 a164, 0
    v_accvgpr_write_b32 a165, 0
    v_accvgpr_write_b32 a166, 0
    v_accvgpr_write_b32 a167, 0
    v_accvgpr_write_b32 a168, 0
    v_accvgpr_write_b32 a169, 0
    v_accvgpr_write_b32 a170, 0
    v_accvgpr_write_b32 a171, 0
    v_accvgpr_write_b32 a172, 0
    v_accvgpr_write_b32 a173, 0
    v_accvgpr_write_b32 a174, 0
    v_accvgpr_write_b32 a175, 0
    v_accvgpr_write_b32 a176, 0
    v_accvgpr_write_b32 a177, 0
    v_accvgpr_write_b32 a178, 0
    v_accvgpr_write_b32 a179, 0
    v_accvgpr_write_b32 a180, 0
    v_accvgpr_write_b32 a181, 0
    v_accvgpr_write_b32 a182, 0
    v_accvgpr_write_b32 a183, 0
    v_accvgpr_write_b32 a184, 0
    v_accvgpr_write_b32 a185, 0
    v_accvgpr_write_b32 a186, 0
    v_accvgpr_write_b32 a187, 0
    v_accvgpr_write_b32 a188, 0
    v_accvgpr_write_b32 a189, 0
    v_accvgpr_write_b32 a190, 0
    v_accvgpr_write_b32 a191, 0
    s_waitcnt vmcnt(14)
    ds_write_b128 v12, v[20:23] offset:0
    ds_write_b128 v12, v[24:27] offset:4608
    ds_write_b128 v12, v[28:31] offset:9216
    ds_write_b128 v12, v[32:35] offset:13824
    ds_write_b128 v12, v[36:39] offset:18432
    ds_write_b128 v12, v[40:43] offset:23040
    ds_write_b128 v12, v[44:47] offset:27648
    ds_write_b128 v12, v[48:51] offset:32256
    ds_write_b128 v14, v[52:55] offset:0
    ds_write_b128 v14, v[56:59] offset:128
    ds_write_b128 v14, v[60:63] offset:256
    ds_write_b128 v14, v[64:67] offset:13312
    ds_write_b128 v14, v[68:71] offset:13440
    ds_write_b128 v14, v[72:75] offset:13568
    s_waitcnt lgkmcnt(0)
    buffer_load_dwordx4 v[20:23], v2, s[8:11], s20 offen
    buffer_load_dwordx4 v[24:27], v3, s[8:11], s20 offen
    buffer_load_dwordx4 v[28:31], v4, s[8:11], s20 offen
    buffer_load_dwordx4 v[32:35], v5, s[8:11], s20 offen
    buffer_load_dwordx4 v[36:39], v6, s[8:11], s20 offen
    buffer_load_dwordx4 v[40:43], v7, s[8:11], s20 offen
    buffer_load_dwordx4 v[44:47], v8, s[8:11], s20 offen
    buffer_load_dwordx4 v[48:51], v9, s[8:11], s20 offen
    buffer_load_dwordx4 v[52:55], v10, s[12:15], s21 offen offset:0
    buffer_load_dwordx4 v[56:59], v10, s[12:15], s21 offen offset:128
    buffer_load_dwordx4 v[60:63], v10, s[12:15], s21 offen offset:256
    buffer_load_dwordx4 v[64:67], v11, s[12:15], s21 offen offset:0
    buffer_load_dwordx4 v[68:71], v11, s[12:15], s21 offen offset:128
    buffer_load_dwordx4 v[72:75], v11, s[12:15], s21 offen offset:256
    s_add_u32 s20, s20, 128
    s_add_u32 s21, s21, 786432
    s_barrier
    ds_read_b64_tr_b16 v[108:109], v18 offset:0
    ds_read_b64_tr_b16 v[110:111], v18 offset:6656
    ds_read_b64_tr_b16 v[112:113], v18 offset:32
    ds_read_b64_tr_b16 v[114:115], v18 offset:6688
    ds_read_b64_tr_b16 v[116:117], v18 offset:64
    ds_read_b64_tr_b16 v[118:119], v18 offset:6720
    ds_read_b64_tr_b16 v[120:121], v18 offset:96
    ds_read_b64_tr_b16 v[122:123], v18 offset:6752
    ds_read_b64_tr_b16 v[124:125], v18 offset:128
    ds_read_b64_tr_b16 v[126:127], v18 offset:6784
    ds_read_b64_tr_b16 v[128:129], v18 offset:160
    ds_read_b64_tr_b16 v[130:131], v18 offset:6816
    ds_read_b64 v[76:77], v16 offset:0
    ds_read_b64 v[78:79], v16 offset:32
    ds_read_b64 v[80:81], v16 offset:2304
    ds_read_b64 v[82:83], v16 offset:2336
    ds_read_b64 v[84:85], v16 offset:4608
    ds_read_b64 v[86:87], v16 offset:4640
    ds_read_b64 v[88:89], v16 offset:6912
    ds_read_b64 v[90:91], v16 offset:6944
    ds_read_b64 v[92:93], v16 offset:9216
    ds_read_b64 v[94:95], v16 offset:9248
    ds_read_b64 v[96:97], v16 offset:11520
    ds_read_b64 v[98:99], v16 offset:11552
    ds_read_b64 v[100:101], v16 offset:13824
    ds_read_b64 v[102:103], v16 offset:13856
    ds_read_b64 v[104:105], v16 offset:16128
    ds_read_b64 v[106:107], v16 offset:16160
    s_mov_b32 s22, 10
    s_waitcnt lgkmcnt(0)
mqkv_loop:
    v_mfma_f32_16x16x32_bf16 a[0:3], v[108:111], v[76:79], a[0:3]
    v_mfma_f32_16x16x32_bf16 a[4:7], v[112:115], v[76:79], a[4:7]
    ds_read_b64_tr_b16 v[164:165], v18 offset:13312
    v_mfma_f32_16x16x32_bf16 a[8:11], v[116:119], v[76:79], a[8:11]
    ds_read_b64_tr_b16 v[166:167], v18 offset:19968
    v_mfma_f32_16x16x32_bf16 a[12:15], v[120:123], v[76:79], a[12:15]
    ds_read_b64_tr_b16 v[168:169], v18 offset:13344
    v_mfma_f32_16x16x32_bf16 a[16:19], v[124:127], v[76:79], a[16:19]
    ds_read_b64_tr_b16 v[170:171], v18 offset:20000
    v_mfma_f32_16x16x32_bf16 a[20:23], v[128:131], v[76:79], a[20:23]
    ds_read_b64_tr_b16 v[172:173], v18 offset:13376
    v_mfma_f32_16x16x32_bf16 a[24:27], v[108:111], v[80:83], a[24:27]
    ds_read_b64_tr_b16 v[174:175], v18 offset:20032
    v_mfma_f32_16x16x32_bf16 a[28:31], v[112:115], v[80:83], a[28:31]
    ds_read_b64_tr_b16 v[176:177], v18 offset:13408
    v_mfma_f32_16x16x32_bf16 a[32:35], v[116:119], v[80:83], a[32:35]
    ds_read_b64_tr_b16 v[178:179], v18 offset:20064
    v_mfma_f32_16x16x32_bf16 a[36:39], v[120:123], v[80:83], a[36:39]
    ds_read_b64_tr_b16 v[180:181], v18 offset:13440
    v_mfma_f32_16x16x32_bf16 a[40:43], v[124:127], v[80:83], a[40:43]
    ds_read_b64_tr_b16 v[182:183], v18 offset:20096
    v_mfma_f32_16x16x32_bf16 a[44:47], v[128:131], v[80:83], a[44:47]
    ds_read_b64_tr_b16 v[184:185], v18 offset:13472
    v_mfma_f32_16x16x32_bf16 a[48:51], v[108:111], v[84:87], a[48:51]
    ds_read_b64_tr_b16 v[186:187], v18 offset:20128
    v_mfma_f32_16x16x32_bf16 a[52:55], v[112:115], v[84:87], a[52:55]
    ds_read_b64 v[132:133], v16 offset:64
    v_mfma_f32_16x16x32_bf16 a[56:59], v[116:119], v[84:87], a[56:59]
    ds_read_b64 v[134:135], v16 offset:96
    v_mfma_f32_16x16x32_bf16 a[60:63], v[120:123], v[84:87], a[60:63]
    ds_read_b64 v[136:137], v16 offset:2368
    v_mfma_f32_16x16x32_bf16 a[64:67], v[124:127], v[84:87], a[64:67]
    ds_read_b64 v[138:139], v16 offset:2400
    v_mfma_f32_16x16x32_bf16 a[68:71], v[128:131], v[84:87], a[68:71]
    ds_read_b64 v[140:141], v16 offset:4672
    v_mfma_f32_16x16x32_bf16 a[72:75], v[108:111], v[88:91], a[72:75]
    ds_read_b64 v[142:143], v16 offset:4704
    v_mfma_f32_16x16x32_bf16 a[76:79], v[112:115], v[88:91], a[76:79]
    ds_read_b64 v[144:145], v16 offset:6976
    v_mfma_f32_16x16x32_bf16 a[80:83], v[116:119], v[88:91], a[80:83]
    ds_read_b64 v[146:147], v16 offset:7008
    v_mfma_f32_16x16x32_bf16 a[84:87], v[120:123], v[88:91], a[84:87]
    ds_read_b64 v[148:149], v16 offset:9280
    v_mfma_f32_16x16x32_bf16 a[88:91], v[124:127], v[88:91], a[88:91]
    ds_read_b64 v[150:151], v16 offset:9312
    v_mfma_f32_16x16x32_bf16 a[92:95], v[128:131], v[88:91], a[92:95]
    ds_read_b64 v[152:153], v16 offset:11584
    v_mfma_f32_16x16x32_bf16 a[96:99], v[108:111], v[92:95], a[96:99]
    ds_read_b64 v[154:155], v16 offset:11616
    v_mfma_f32_16x16x32_bf16 a[100:103], v[112:115], v[92:95], a[100:103]
    ds_read_b64 v[156:157], v16 offset:13888
    v_mfma_f32_16x16x32_bf16 a[104:107], v[116:119], v[92:95], a[104:107]
    ds_read_b64 v[158:159], v16 offset:13920
    v_mfma_f32_16x16x32_bf16 a[108:111], v[120:123], v[92:95], a[108:111]
    ds_read_b64 v[160:161], v16 offset:16192
    v_mfma_f32_16x16x32_bf16 a[112:115], v[124:127], v[92:95], a[112:115]
    ds_read_b64 v[162:163], v16 offset:16224
    v_mfma_f32_16x16x32_bf16 a[116:119], v[128:131], v[92:95], a[116:119]
    v_mfma_f32_16x16x32_bf16 a[120:123], v[108:111], v[96:99], a[120:123]
    v_mfma_f32_16x16x32_bf16 a[124:127], v[112:115], v[96:99], a[124:127]
    v_mfma_f32_16x16x32_bf16 a[128:131], v[116:119], v[96:99], a[128:131]
    v_mfma_f32_16x16x32_bf16 a[132:135], v[120:123], v[96:99], a[132:135]
    v_mfma_f32_16x16x32_bf16 a[136:139], v[124:127], v[96:99], a[136:139]
    v_mfma_f32_16x16x32_bf16 a[140:143], v[128:131], v[96:99], a[140:143]
    v_mfma_f32_16x16x32_bf16 a[144:147], v[108:111], v[100:103], a[144:147]
    v_mfma_f32_16x16x32_bf16 a[148:151], v[112:115], v[100:103], a[148:151]
    v_mfma_f32_16x16x32_bf16 a[152:155], v[116:119], v[100:103], a[152:155]
    v_mfma_f32_16x16x32_bf16 a[156:159], v[120:123], v[100:103], a[156:159]
    v_mfma_f32_16x16x32_bf16 a[160:163], v[124:127], v[100:103], a[160:163]
    v_mfma_f32_16x16x32_bf16 a[164:167], v[128:131], v[100:103], a[164:167]
    v_mfma_f32_16x16x32_bf16 a[168:171], v[108:111], v[104:107], a[168:171]
    v_mfma_f32_16x16x32_bf16 a[172:175], v[112:115], v[104:107], a[172:175]
    v_mfma_f32_16x16x32_bf16 a[176:179], v[116:119], v[104:107], a[176:179]
    v_mfma_f32_16x16x32_bf16 a[180:183], v[120:123], v[104:107], a[180:183]
    v_mfma_f32_16x16x32_bf16 a[184:187], v[124:127], v[104:107], a[184:187]
    v_mfma_f32_16x16x32_bf16 a[188:191], v[128:131], v[104:107], a[188:191]
    s_waitcnt lgkmcnt(0)
    s_waitcnt vmcnt(14)
    v_mfma_f32_16x16x32_bf16 a[0:3], v[164:167], v[132:135], a[0:3]
    ds_write_b128 v13, v[188:191] offset:0
    v_mfma_f32_16x16x32_bf16 a[4:7], v[168:171], v[132:135], a[4:7]
    ds_write_b128 v13, v[192:195] offset:4608
    v_mfma_f32_16x16x32_bf16 a[8:11], v[172:175], v[132:135], a[8:11]
    ds_write_b128 v13, v[196:199] offset:9216
    v_mfma_f32_16x16x32_bf16 a[12:15], v[176:179], v[132:135], a[12:15]
    ds_write_b128 v13, v[200:203] offset:13824
    v_mfma_f32_16x16x32_bf16 a[16:19], v[180:183], v[132:135], a[16:19]
    ds_write_b128 v13, v[204:207] offset:18432
    v_mfma_f32_16x16x32_bf16 a[20:23], v[184:187], v[132:135], a[20:23]
    ds_write_b128 v13, v[208:211] offset:23040
    v_mfma_f32_16x16x32_bf16 a[24:27], v[164:167], v[136:139], a[24:27]
    ds_write_b128 v13, v[212:215] offset:27648
    v_mfma_f32_16x16x32_bf16 a[28:31], v[168:171], v[136:139], a[28:31]
    ds_write_b128 v13, v[216:219] offset:32256
    v_mfma_f32_16x16x32_bf16 a[32:35], v[172:175], v[136:139], a[32:35]
    ds_write_b128 v15, v[220:223] offset:0
    v_mfma_f32_16x16x32_bf16 a[36:39], v[176:179], v[136:139], a[36:39]
    ds_write_b128 v15, v[224:227] offset:128
    v_mfma_f32_16x16x32_bf16 a[40:43], v[180:183], v[136:139], a[40:43]
    ds_write_b128 v15, v[228:231] offset:256
    v_mfma_f32_16x16x32_bf16 a[44:47], v[184:187], v[136:139], a[44:47]
    ds_write_b128 v15, v[232:235] offset:13312
    v_mfma_f32_16x16x32_bf16 a[48:51], v[164:167], v[140:143], a[48:51]
    ds_write_b128 v15, v[236:239] offset:13440
    v_mfma_f32_16x16x32_bf16 a[52:55], v[168:171], v[140:143], a[52:55]
    ds_write_b128 v15, v[240:243] offset:13568
    v_mfma_f32_16x16x32_bf16 a[56:59], v[172:175], v[140:143], a[56:59]
    v_mfma_f32_16x16x32_bf16 a[60:63], v[176:179], v[140:143], a[60:63]
    s_waitcnt lgkmcnt(0)
    s_barrier
    v_mfma_f32_16x16x32_bf16 a[64:67], v[180:183], v[140:143], a[64:67]
    ds_read_b64_tr_b16 v[108:109], v19 offset:0
    ds_read_b64_tr_b16 v[110:111], v19 offset:6656
    v_mfma_f32_16x16x32_bf16 a[68:71], v[184:187], v[140:143], a[68:71]
    buffer_load_dwordx4 v[188:191], v2, s[8:11], s20 offen
    ds_read_b64_tr_b16 v[112:113], v19 offset:32
    v_mfma_f32_16x16x32_bf16 a[72:75], v[164:167], v[144:147], a[72:75]
    ds_read_b64_tr_b16 v[114:115], v19 offset:6688
    buffer_load_dwordx4 v[192:195], v3, s[8:11], s20 offen
    v_mfma_f32_16x16x32_bf16 a[76:79], v[168:171], v[144:147], a[76:79]
    ds_read_b64_tr_b16 v[116:117], v19 offset:64
    ds_read_b64_tr_b16 v[118:119], v19 offset:6720
    v_mfma_f32_16x16x32_bf16 a[80:83], v[172:175], v[144:147], a[80:83]
    buffer_load_dwordx4 v[196:199], v4, s[8:11], s20 offen
    ds_read_b64_tr_b16 v[120:121], v19 offset:96
    v_mfma_f32_16x16x32_bf16 a[84:87], v[176:179], v[144:147], a[84:87]
    ds_read_b64_tr_b16 v[122:123], v19 offset:6752
    buffer_load_dwordx4 v[200:203], v5, s[8:11], s20 offen
    v_mfma_f32_16x16x32_bf16 a[88:91], v[180:183], v[144:147], a[88:91]
    ds_read_b64_tr_b16 v[124:125], v19 offset:128
    ds_read_b64_tr_b16 v[126:127], v19 offset:6784
    v_mfma_f32_16x16x32_bf16 a[92:95], v[184:187], v[144:147], a[92:95]
    buffer_load_dwordx4 v[204:207], v6, s[8:11], s20 offen
    ds_read_b64_tr_b16 v[128:129], v19 offset:160
    v_mfma_f32_16x16x32_bf16 a[96:99], v[164:167], v[148:151], a[96:99]
    ds_read_b64_tr_b16 v[130:131], v19 offset:6816
    buffer_load_dwordx4 v[208:211], v7, s[8:11], s20 offen
    v_mfma_f32_16x16x32_bf16 a[100:103], v[168:171], v[148:151], a[100:103]
    ds_read_b64 v[76:77], v17 offset:0
    ds_read_b64 v[78:79], v17 offset:32
    v_mfma_f32_16x16x32_bf16 a[104:107], v[172:175], v[148:151], a[104:107]
    buffer_load_dwordx4 v[212:215], v8, s[8:11], s20 offen
    ds_read_b64 v[80:81], v17 offset:2304
    v_mfma_f32_16x16x32_bf16 a[108:111], v[176:179], v[148:151], a[108:111]
    ds_read_b64 v[82:83], v17 offset:2336
    buffer_load_dwordx4 v[216:219], v9, s[8:11], s20 offen
    v_mfma_f32_16x16x32_bf16 a[112:115], v[180:183], v[148:151], a[112:115]
    ds_read_b64 v[84:85], v17 offset:4608
    ds_read_b64 v[86:87], v17 offset:4640
    v_mfma_f32_16x16x32_bf16 a[116:119], v[184:187], v[148:151], a[116:119]
    buffer_load_dwordx4 v[220:223], v10, s[12:15], s21 offen offset:0
    ds_read_b64 v[88:89], v17 offset:6912
    v_mfma_f32_16x16x32_bf16 a[120:123], v[164:167], v[152:155], a[120:123]
    ds_read_b64 v[90:91], v17 offset:6944
    buffer_load_dwordx4 v[224:227], v10, s[12:15], s21 offen offset:128
    v_mfma_f32_16x16x32_bf16 a[124:127], v[168:171], v[152:155], a[124:127]
    ds_read_b64 v[92:93], v17 offset:9216
    ds_read_b64 v[94:95], v17 offset:9248
    v_mfma_f32_16x16x32_bf16 a[128:131], v[172:175], v[152:155], a[128:131]
    buffer_load_dwordx4 v[228:231], v10, s[12:15], s21 offen offset:256
    ds_read_b64 v[96:97], v17 offset:11520
    v_mfma_f32_16x16x32_bf16 a[132:135], v[176:179], v[152:155], a[132:135]
    ds_read_b64 v[98:99], v17 offset:11552
    buffer_load_dwordx4 v[232:235], v11, s[12:15], s21 offen offset:0
    v_mfma_f32_16x16x32_bf16 a[136:139], v[180:183], v[152:155], a[136:139]
    ds_read_b64 v[100:101], v17 offset:13824
    ds_read_b64 v[102:103], v17 offset:13856
    v_mfma_f32_16x16x32_bf16 a[140:143], v[184:187], v[152:155], a[140:143]
    buffer_load_dwordx4 v[236:239], v11, s[12:15], s21 offen offset:128
    ds_read_b64 v[104:105], v17 offset:16128
    v_mfma_f32_16x16x32_bf16 a[144:147], v[164:167], v[156:159], a[144:147]
    ds_read_b64 v[106:107], v17 offset:16160
    buffer_load_dwordx4 v[240:243], v11, s[12:15], s21 offen offset:256
    v_mfma_f32_16x16x32_bf16 a[148:151], v[168:171], v[156:159], a[148:151]
    v_mfma_f32_16x16x32_bf16 a[152:155], v[172:175], v[156:159], a[152:155]
    v_mfma_f32_16x16x32_bf16 a[156:159], v[176:179], v[156:159], a[156:159]
    v_mfma_f32_16x16x32_bf16 a[160:163], v[180:183], v[156:159], a[160:163]
    v_mfma_f32_16x16x32_bf16 a[164:167], v[184:187], v[156:159], a[164:167]
    v_mfma_f32_16x16x32_bf16 a[168:171], v[164:167], v[160:163], a[168:171]
    v_mfma_f32_16x16x32_bf16 a[172:175], v[168:171], v[160:163], a[172:175]
    v_mfma_f32_16x16x32_bf16 a[176:179], v[172:175], v[160:163], a[176:179]
    v_mfma_f32_16x16x32_bf16 a[180:183], v[176:179], v[160:163], a[180:183]
    v_mfma_f32_16x16x32_bf16 a[184:187], v[180:183], v[160:163], a[184:187]
    v_mfma_f32_16x16x32_bf16 a[188:191], v[184:187], v[160:163], a[188:191]
    s_add_u32 s20, s20, 128
    s_add_u32 s21, s21, 786432
    s_sub_u32 s22, s22, 1
    s_cmp_eq_u32 s22, 0
    s_waitcnt lgkmcnt(0)
    s_cbranch_scc1 mqkv_done
    v_mfma_f32_16x16x32_bf16 a[0:3], v[108:111], v[76:79], a[0:3]
    v_mfma_f32_16x16x32_bf16 a[4:7], v[112:115], v[76:79], a[4:7]
    ds_read_b64_tr_b16 v[164:165], v19 offset:13312
    v_mfma_f32_16x16x32_bf16 a[8:11], v[116:119], v[76:79], a[8:11]
    ds_read_b64_tr_b16 v[166:167], v19 offset:19968
    v_mfma_f32_16x16x32_bf16 a[12:15], v[120:123], v[76:79], a[12:15]
    ds_read_b64_tr_b16 v[168:169], v19 offset:13344
    v_mfma_f32_16x16x32_bf16 a[16:19], v[124:127], v[76:79], a[16:19]
    ds_read_b64_tr_b16 v[170:171], v19 offset:20000
    v_mfma_f32_16x16x32_bf16 a[20:23], v[128:131], v[76:79], a[20:23]
    ds_read_b64_tr_b16 v[172:173], v19 offset:13376
    v_mfma_f32_16x16x32_bf16 a[24:27], v[108:111], v[80:83], a[24:27]
    ds_read_b64_tr_b16 v[174:175], v19 offset:20032
    v_mfma_f32_16x16x32_bf16 a[28:31], v[112:115], v[80:83], a[28:31]
    ds_read_b64_tr_b16 v[176:177], v19 offset:13408
    v_mfma_f32_16x16x32_bf16 a[32:35], v[116:119], v[80:83], a[32:35]
    ds_read_b64_tr_b16 v[178:179], v19 offset:20064
    v_mfma_f32_16x16x32_bf16 a[36:39], v[120:123], v[80:83], a[36:39]
    ds_read_b64_tr_b16 v[180:181], v19 offset:13440
    v_mfma_f32_16x16x32_bf16 a[40:43], v[124:127], v[80:83], a[40:43]
    ds_read_b64_tr_b16 v[182:183], v19 offset:20096
    v_mfma_f32_16x16x32_bf16 a[44:47], v[128:131], v[80:83], a[44:47]
    ds_read_b64_tr_b16 v[184:185], v19 offset:13472
    v_mfma_f32_16x16x32_bf16 a[48:51], v[108:111], v[84:87], a[48:51]
    ds_read_b64_tr_b16 v[186:187], v19 offset:20128
    v_mfma_f32_16x16x32_bf16 a[52:55], v[112:115], v[84:87], a[52:55]
    ds_read_b64 v[132:133], v17 offset:64
    v_mfma_f32_16x16x32_bf16 a[56:59], v[116:119], v[84:87], a[56:59]
    ds_read_b64 v[134:135], v17 offset:96
    v_mfma_f32_16x16x32_bf16 a[60:63], v[120:123], v[84:87], a[60:63]
    ds_read_b64 v[136:137], v17 offset:2368
    v_mfma_f32_16x16x32_bf16 a[64:67], v[124:127], v[84:87], a[64:67]
    ds_read_b64 v[138:139], v17 offset:2400
    v_mfma_f32_16x16x32_bf16 a[68:71], v[128:131], v[84:87], a[68:71]
    ds_read_b64 v[140:141], v17 offset:4672
    v_mfma_f32_16x16x32_bf16 a[72:75], v[108:111], v[88:91], a[72:75]
    ds_read_b64 v[142:143], v17 offset:4704
    v_mfma_f32_16x16x32_bf16 a[76:79], v[112:115], v[88:91], a[76:79]
    ds_read_b64 v[144:145], v17 offset:6976
    v_mfma_f32_16x16x32_bf16 a[80:83], v[116:119], v[88:91], a[80:83]
    ds_read_b64 v[146:147], v17 offset:7008
    v_mfma_f32_16x16x32_bf16 a[84:87], v[120:123], v[88:91], a[84:87]
    ds_read_b64 v[148:149], v17 offset:9280
    v_mfma_f32_16x16x32_bf16 a[88:91], v[124:127], v[88:91], a[88:91]
    ds_read_b64 v[150:151], v17 offset:9312
    v_mfma_f32_16x16x32_bf16 a[92:95], v[128:131], v[88:91], a[92:95]
    ds_read_b64 v[152:153], v17 offset:11584
    v_mfma_f32_16x16x32_bf16 a[96:99], v[108:111], v[92:95], a[96:99]
    ds_read_b64 v[154:155], v17 offset:11616
    v_mfma_f32_16x16x32_bf16 a[100:103], v[112:115], v[92:95], a[100:103]
    ds_read_b64 v[156:157], v17 offset:13888
    v_mfma_f32_16x16x32_bf16 a[104:107], v[116:119], v[92:95], a[104:107]
    ds_read_b64 v[158:159], v17 offset:13920
    v_mfma_f32_16x16x32_bf16 a[108:111], v[120:123], v[92:95], a[108:111]
    ds_read_b64 v[160:161], v17 offset:16192
    v_mfma_f32_16x16x32_bf16 a[112:115], v[124:127], v[92:95], a[112:115]
    ds_read_b64 v[162:163], v17 offset:16224
    v_mfma_f32_16x16x32_bf16 a[116:119], v[128:131], v[92:95], a[116:119]
    v_mfma_f32_16x16x32_bf16 a[120:123], v[108:111], v[96:99], a[120:123]
    v_mfma_f32_16x16x32_bf16 a[124:127], v[112:115], v[96:99], a[124:127]
    v_mfma_f32_16x16x32_bf16 a[128:131], v[116:119], v[96:99], a[128:131]
    v_mfma_f32_16x16x32_bf16 a[132:135], v[120:123], v[96:99], a[132:135]
    v_mfma_f32_16x16x32_bf16 a[136:139], v[124:127], v[96:99], a[136:139]
    v_mfma_f32_16x16x32_bf16 a[140:143], v[128:131], v[96:99], a[140:143]
    v_mfma_f32_16x16x32_bf16 a[144:147], v[108:111], v[100:103], a[144:147]
    v_mfma_f32_16x16x32_bf16 a[148:151], v[112:115], v[100:103], a[148:151]
    v_mfma_f32_16x16x32_bf16 a[152:155], v[116:119], v[100:103], a[152:155]
    v_mfma_f32_16x16x32_bf16 a[156:159], v[120:123], v[100:103], a[156:159]
    v_mfma_f32_16x16x32_bf16 a[160:163], v[124:127], v[100:103], a[160:163]
    v_mfma_f32_16x16x32_bf16 a[164:167], v[128:131], v[100:103], a[164:167]
    v_mfma_f32_16x16x32_bf16 a[168:171], v[108:111], v[104:107], a[168:171]
    v_mfma_f32_16x16x32_bf16 a[172:175], v[112:115], v[104:107], a[172:175]
    v_mfma_f32_16x16x32_bf16 a[176:179], v[116:119], v[104:107], a[176:179]
    v_mfma_f32_16x16x32_bf16 a[180:183], v[120:123], v[104:107], a[180:183]
    v_mfma_f32_16x16x32_bf16 a[184:187], v[124:127], v[104:107], a[184:187]
    v_mfma_f32_16x16x32_bf16 a[188:191], v[128:131], v[104:107], a[188:191]
    s_waitcnt lgkmcnt(0)
    s_waitcnt vmcnt(14)
    v_mfma_f32_16x16x32_bf16 a[0:3], v[164:167], v[132:135], a[0:3]
    ds_write_b128 v12, v[20:23] offset:0
    v_mfma_f32_16x16x32_bf16 a[4:7], v[168:171], v[132:135], a[4:7]
    ds_write_b128 v12, v[24:27] offset:4608
    v_mfma_f32_16x16x32_bf16 a[8:11], v[172:175], v[132:135], a[8:11]
    ds_write_b128 v12, v[28:31] offset:9216
    v_mfma_f32_16x16x32_bf16 a[12:15], v[176:179], v[132:135], a[12:15]
    ds_write_b128 v12, v[32:35] offset:13824
    v_mfma_f32_16x16x32_bf16 a[16:19], v[180:183], v[132:135], a[16:19]
    ds_write_b128 v12, v[36:39] offset:18432
    v_mfma_f32_16x16x32_bf16 a[20:23], v[184:187], v[132:135], a[20:23]
    ds_write_b128 v12, v[40:43] offset:23040
    v_mfma_f32_16x16x32_bf16 a[24:27], v[164:167], v[136:139], a[24:27]
    ds_write_b128 v12, v[44:47] offset:27648
    v_mfma_f32_16x16x32_bf16 a[28:31], v[168:171], v[136:139], a[28:31]
    ds_write_b128 v12, v[48:51] offset:32256
    v_mfma_f32_16x16x32_bf16 a[32:35], v[172:175], v[136:139], a[32:35]
    ds_write_b128 v14, v[52:55] offset:0
    v_mfma_f32_16x16x32_bf16 a[36:39], v[176:179], v[136:139], a[36:39]
    ds_write_b128 v14, v[56:59] offset:128
    v_mfma_f32_16x16x32_bf16 a[40:43], v[180:183], v[136:139], a[40:43]
    ds_write_b128 v14, v[60:63] offset:256
    v_mfma_f32_16x16x32_bf16 a[44:47], v[184:187], v[136:139], a[44:47]
    ds_write_b128 v14, v[64:67] offset:13312
    v_mfma_f32_16x16x32_bf16 a[48:51], v[164:167], v[140:143], a[48:51]
    ds_write_b128 v14, v[68:71] offset:13440
    v_mfma_f32_16x16x32_bf16 a[52:55], v[168:171], v[140:143], a[52:55]
    ds_write_b128 v14, v[72:75] offset:13568
    v_mfma_f32_16x16x32_bf16 a[56:59], v[172:175], v[140:143], a[56:59]
    v_mfma_f32_16x16x32_bf16 a[60:63], v[176:179], v[140:143], a[60:63]
    s_waitcnt lgkmcnt(0)
    s_barrier
    v_mfma_f32_16x16x32_bf16 a[64:67], v[180:183], v[140:143], a[64:67]
    ds_read_b64_tr_b16 v[108:109], v18 offset:0
    ds_read_b64_tr_b16 v[110:111], v18 offset:6656
    v_mfma_f32_16x16x32_bf16 a[68:71], v[184:187], v[140:143], a[68:71]
    buffer_load_dwordx4 v[20:23], v2, s[8:11], s20 offen
    ds_read_b64_tr_b16 v[112:113], v18 offset:32
    v_mfma_f32_16x16x32_bf16 a[72:75], v[164:167], v[144:147], a[72:75]
    ds_read_b64_tr_b16 v[114:115], v18 offset:6688
    buffer_load_dwordx4 v[24:27], v3, s[8:11], s20 offen
    v_mfma_f32_16x16x32_bf16 a[76:79], v[168:171], v[144:147], a[76:79]
    ds_read_b64_tr_b16 v[116:117], v18 offset:64
    ds_read_b64_tr_b16 v[118:119], v18 offset:6720
    v_mfma_f32_16x16x32_bf16 a[80:83], v[172:175], v[144:147], a[80:83]
    buffer_load_dwordx4 v[28:31], v4, s[8:11], s20 offen
    ds_read_b64_tr_b16 v[120:121], v18 offset:96
    v_mfma_f32_16x16x32_bf16 a[84:87], v[176:179], v[144:147], a[84:87]
    ds_read_b64_tr_b16 v[122:123], v18 offset:6752
    buffer_load_dwordx4 v[32:35], v5, s[8:11], s20 offen
    v_mfma_f32_16x16x32_bf16 a[88:91], v[180:183], v[144:147], a[88:91]
    ds_read_b64_tr_b16 v[124:125], v18 offset:128
    ds_read_b64_tr_b16 v[126:127], v18 offset:6784
    v_mfma_f32_16x16x32_bf16 a[92:95], v[184:187], v[144:147], a[92:95]
    buffer_load_dwordx4 v[36:39], v6, s[8:11], s20 offen
    ds_read_b64_tr_b16 v[128:129], v18 offset:160
    v_mfma_f32_16x16x32_bf16 a[96:99], v[164:167], v[148:151], a[96:99]
    ds_read_b64_tr_b16 v[130:131], v18 offset:6816
    buffer_load_dwordx4 v[40:43], v7, s[8:11], s20 offen
    v_mfma_f32_16x16x32_bf16 a[100:103], v[168:171], v[148:151], a[100:103]
    ds_read_b64 v[76:77], v16 offset:0
    ds_read_b64 v[78:79], v16 offset:32
    v_mfma_f32_16x16x32_bf16 a[104:107], v[172:175], v[148:151], a[104:107]
    buffer_load_dwordx4 v[44:47], v8, s[8:11], s20 offen
    ds_read_b64 v[80:81], v16 offset:2304
    v_mfma_f32_16x16x32_bf16 a[108:111], v[176:179], v[148:151], a[108:111]
    ds_read_b64 v[82:83], v16 offset:2336
    buffer_load_dwordx4 v[48:51], v9, s[8:11], s20 offen
    v_mfma_f32_16x16x32_bf16 a[112:115], v[180:183], v[148:151], a[112:115]
    ds_read_b64 v[84:85], v16 offset:4608
    ds_read_b64 v[86:87], v16 offset:4640
    v_mfma_f32_16x16x32_bf16 a[116:119], v[184:187], v[148:151], a[116:119]
    buffer_load_dwordx4 v[52:55], v10, s[12:15], s21 offen offset:0
    ds_read_b64 v[88:89], v16 offset:6912
    v_mfma_f32_16x16x32_bf16 a[120:123], v[164:167], v[152:155], a[120:123]
    ds_read_b64 v[90:91], v16 offset:6944
    buffer_load_dwordx4 v[56:59], v10, s[12:15], s21 offen offset:128
    v_mfma_f32_16x16x32_bf16 a[124:127], v[168:171], v[152:155], a[124:127]
    ds_read_b64 v[92:93], v16 offset:9216
    ds_read_b64 v[94:95], v16 offset:9248
    v_mfma_f32_16x16x32_bf16 a[128:131], v[172:175], v[152:155], a[128:131]
    buffer_load_dwordx4 v[60:63], v10, s[12:15], s21 offen offset:256
    ds_read_b64 v[96:97], v16 offset:11520
    v_mfma_f32_16x16x32_bf16 a[132:135], v[176:179], v[152:155], a[132:135]
    ds_read_b64 v[98:99], v16 offset:11552
    buffer_load_dwordx4 v[64:67], v11, s[12:15], s21 offen offset:0
    v_mfma_f32_16x16x32_bf16 a[136:139], v[180:183], v[152:155], a[136:139]
    ds_read_b64 v[100:101], v16 offset:13824
    ds_read_b64 v[102:103], v16 offset:13856
    v_mfma_f32_16x16x32_bf16 a[140:143], v[184:187], v[152:155], a[140:143]
    buffer_load_dwordx4 v[68:71], v11, s[12:15], s21 offen offset:128
    ds_read_b64 v[104:105], v16 offset:16128
    v_mfma_f32_16x16x32_bf16 a[144:147], v[164:167], v[156:159], a[144:147]
    ds_read_b64 v[106:107], v16 offset:16160
    buffer_load_dwordx4 v[72:75], v11, s[12:15], s21 offen offset:256
    v_mfma_f32_16x16x32_bf16 a[148:151], v[168:171], v[156:159], a[148:151]
    v_mfma_f32_16x16x32_bf16 a[152:155], v[172:175], v[156:159], a[152:155]
    v_mfma_f32_16x16x32_bf16 a[156:159], v[176:179], v[156:159], a[156:159]
    v_mfma_f32_16x16x32_bf16 a[160:163], v[180:183], v[156:159], a[160:163]
    v_mfma_f32_16x16x32_bf16 a[164:167], v[184:187], v[156:159], a[164:167]
    v_mfma_f32_16x16x32_bf16 a[168:171], v[164:167], v[160:163], a[168:171]
    v_mfma_f32_16x16x32_bf16 a[172:175], v[168:171], v[160:163], a[172:175]
    v_mfma_f32_16x16x32_bf16 a[176:179], v[172:175], v[160:163], a[176:179]
    v_mfma_f32_16x16x32_bf16 a[180:183], v[176:179], v[160:163], a[180:183]
    v_mfma_f32_16x16x32_bf16 a[184:187], v[180:183], v[160:163], a[184:187]
    v_mfma_f32_16x16x32_bf16 a[188:191], v[184:187], v[160:163], a[188:191]
    s_add_u32 s20, s20, 128
    s_add_u32 s21, s21, 786432
    s_sub_u32 s22, s22, 1
    s_cmp_eq_u32 s22, 0
    s_waitcnt lgkmcnt(0)
    s_cbranch_scc0 mqkv_loop
mqkv_done:
    s_waitcnt vmcnt(0)
    s_nop 7
    s_cmp_lg_u32 s61, 0
    s_cbranch_scc1 if_skip_12
    s_mov_b64 exec, 1
    v_accvgpr_write_b32 a255, 1
    v_mov_b32 v3, 0
    s_nop 1
    buffer_atomic_add a255, v3, s[56:59], s75 offen sc0 sc1
    s_mov_b64 exec, -1
if_skip_12:
    v_and_b32 v60, 15, v0
    v_bfe_u32 v61, v0, 4, 2
    v_lshrrev_b32 v62, 7, v0
    v_bfe_u32 v63, v0, 6, 1
    v_lshl_add_u32 v64, v62, 7, v60
    s_mov_b32 s24, 12288
    v_mul_lo_u32 v64, v64, s24
    v_mul_u32_u24 v65, 192, v63
    v_lshl_add_u32 v66, v61, 3, v65
    v_add_u32 v66, v64, v66
    v_lshl_add_u32 v65, v61, 4, v65
    v_add_u32 v60, v64, v65
    v_accvgpr_read_b32 v148, a0
    v_accvgpr_read_b32 v149, a1
    v_accvgpr_read_b32 v150, a2
    v_accvgpr_read_b32 v151, a3
    v_cvt_pk_bf16_f32 v76, v148, v149
    v_cvt_pk_bf16_f32 v77, v150, v151
    v_accvgpr_read_b32 v152, a4
    v_accvgpr_read_b32 v153, a5
    v_accvgpr_read_b32 v154, a6
    v_accvgpr_read_b32 v155, a7
    v_cvt_pk_bf16_f32 v78, v152, v153
    v_cvt_pk_bf16_f32 v79, v154, v155
    s_nop 1
    v_permlane32_swap_b32 v76, v78
    v_permlane32_swap_b32 v77, v79
    s_nop 1
    v_permlane16_swap_b32 v76, v78
    v_permlane16_swap_b32 v77, v79
    buffer_store_dwordx4 v[76:79], v60, s[16:19], s23 offen offset:0 sc1
    v_accvgpr_read_b32 v148, a8
    v_accvgpr_read_b32 v149, a9
    v_accvgpr_read_b32 v150, a10
    v_accvgpr_read_b32 v151, a11
    v_cvt_pk_bf16_f32 v84, v148, v149
    v_cvt_pk_bf16_f32 v85, v150, v151
    v_accvgpr_read_b32 v152, a12
    v_accvgpr_read_b32 v153, a13
    v_accvgpr_read_b32 v154, a14
    v_accvgpr_read_b32 v155, a15
    v_cvt_pk_bf16_f32 v86, v152, v153
    v_cvt_pk_bf16_f32 v87, v154, v155
    s_nop 1
    v_permlane32_swap_b32 v84, v86
    v_permlane32_swap_b32 v85, v87
    s_nop 1
    v_permlane16_swap_b32 v84, v86
    v_permlane16_swap_b32 v85, v87
    buffer_store_dwordx4 v[84:87], v60, s[16:19], s23 offen offset:64 sc1
    v_accvgpr_read_b32 v148, a16
    v_accvgpr_read_b32 v149, a17
    v_accvgpr_read_b32 v150, a18
    v_accvgpr_read_b32 v151, a19
    v_cvt_pk_bf16_f32 v92, v148, v149
    v_cvt_pk_bf16_f32 v93, v150, v151
    v_accvgpr_read_b32 v152, a20
    v_accvgpr_read_b32 v153, a21
    v_accvgpr_read_b32 v154, a22
    v_accvgpr_read_b32 v155, a23
    v_cvt_pk_bf16_f32 v94, v152, v153
    v_cvt_pk_bf16_f32 v95, v154, v155
    s_nop 1
    v_permlane32_swap_b32 v92, v94
    v_permlane32_swap_b32 v93, v95
    s_nop 1
    v_permlane16_swap_b32 v92, v94
    v_permlane16_swap_b32 v93, v95
    buffer_store_dwordx4 v[92:95], v60, s[16:19], s23 offen offset:128 sc1
    v_add_u32 v60, 196608, v60
    v_accvgpr_read_b32 v148, a24
    v_accvgpr_read_b32 v149, a25
    v_accvgpr_read_b32 v150, a26
    v_accvgpr_read_b32 v151, a27
    v_cvt_pk_bf16_f32 v100, v148, v149
    v_cvt_pk_bf16_f32 v101, v150, v151
    v_accvgpr_read_b32 v152, a28
    v_accvgpr_read_b32 v153, a29
    v_accvgpr_read_b32 v154, a30
    v_accvgpr_read_b32 v155, a31
    v_cvt_pk_bf16_f32 v102, v152, v153
    v_cvt_pk_bf16_f32 v103, v154, v155
    s_nop 1
    v_permlane32_swap_b32 v100, v102
    v_permlane32_swap_b32 v101, v103
    s_nop 1
    v_permlane16_swap_b32 v100, v102
    v_permlane16_swap_b32 v101, v103
    buffer_store_dwordx4 v[100:103], v60, s[16:19], s23 offen offset:0 sc1
    v_accvgpr_read_b32 v148, a32
    v_accvgpr_read_b32 v149, a33
    v_accvgpr_read_b32 v150, a34
    v_accvgpr_read_b32 v151, a35
    v_cvt_pk_bf16_f32 v108, v148, v149
    v_cvt_pk_bf16_f32 v109, v150, v151
    v_accvgpr_read_b32 v152, a36
    v_accvgpr_read_b32 v153, a37
    v_accvgpr_read_b32 v154, a38
    v_accvgpr_read_b32 v155, a39
    v_cvt_pk_bf16_f32 v110, v152, v153
    v_cvt_pk_bf16_f32 v111, v154, v155
    s_nop 1
    v_permlane32_swap_b32 v108, v110
    v_permlane32_swap_b32 v109, v111
    s_nop 1
    v_permlane16_swap_b32 v108, v110
    v_permlane16_swap_b32 v109, v111
    buffer_store_dwordx4 v[108:111], v60, s[16:19], s23 offen offset:64 sc1
    v_accvgpr_read_b32 v148, a40
    v_accvgpr_read_b32 v149, a41
    v_accvgpr_read_b32 v150, a42
    v_accvgpr_read_b32 v151, a43
    v_cvt_pk_bf16_f32 v116, v148, v149
    v_cvt_pk_bf16_f32 v117, v150, v151
    v_accvgpr_read_b32 v152, a44
    v_accvgpr_read_b32 v153, a45
    v_accvgpr_read_b32 v154, a46
    v_accvgpr_read_b32 v155, a47
    v_cvt_pk_bf16_f32 v118, v152, v153
    v_cvt_pk_bf16_f32 v119, v154, v155
    s_nop 1
    v_permlane32_swap_b32 v116, v118
    v_permlane32_swap_b32 v117, v119
    s_nop 1
    v_permlane16_swap_b32 v116, v118
    v_permlane16_swap_b32 v117, v119
    buffer_store_dwordx4 v[116:119], v60, s[16:19], s23 offen offset:128 sc1
    v_add_u32 v60, 196608, v60
    v_accvgpr_read_b32 v148, a48
    v_accvgpr_read_b32 v149, a49
    v_accvgpr_read_b32 v150, a50
    v_accvgpr_read_b32 v151, a51
    v_cvt_pk_bf16_f32 v124, v148, v149
    v_cvt_pk_bf16_f32 v125, v150, v151
    v_accvgpr_read_b32 v152, a52
    v_accvgpr_read_b32 v153, a53
    v_accvgpr_read_b32 v154, a54
    v_accvgpr_read_b32 v155, a55
    v_cvt_pk_bf16_f32 v126, v152, v153
    v_cvt_pk_bf16_f32 v127, v154, v155
    s_nop 1
    v_permlane32_swap_b32 v124, v126
    v_permlane32_swap_b32 v125, v127
    s_nop 1
    v_permlane16_swap_b32 v124, v126
    v_permlane16_swap_b32 v125, v127
    buffer_store_dwordx4 v[124:127], v60, s[16:19], s23 offen offset:0 sc1
    v_accvgpr_read_b32 v148, a56
    v_accvgpr_read_b32 v149, a57
    v_accvgpr_read_b32 v150, a58
    v_accvgpr_read_b32 v151, a59
    v_cvt_pk_bf16_f32 v132, v148, v149
    v_cvt_pk_bf16_f32 v133, v150, v151
    v_accvgpr_read_b32 v152, a60
    v_accvgpr_read_b32 v153, a61
    v_accvgpr_read_b32 v154, a62
    v_accvgpr_read_b32 v155, a63
    v_cvt_pk_bf16_f32 v134, v152, v153
    v_cvt_pk_bf16_f32 v135, v154, v155
    s_nop 1
    v_permlane32_swap_b32 v132, v134
    v_permlane32_swap_b32 v133, v135
    s_nop 1
    v_permlane16_swap_b32 v132, v134
    v_permlane16_swap_b32 v133, v135
    buffer_store_dwordx4 v[132:135], v60, s[16:19], s23 offen offset:64 sc1
    v_accvgpr_read_b32 v148, a64
    v_accvgpr_read_b32 v149, a65
    v_accvgpr_read_b32 v150, a66
    v_accvgpr_read_b32 v151, a67
    v_cvt_pk_bf16_f32 v76, v148, v149
    v_cvt_pk_bf16_f32 v77, v150, v151
    v_accvgpr_read_b32 v152, a68
    v_accvgpr_read_b32 v153, a69
    v_accvgpr_read_b32 v154, a70
    v_accvgpr_read_b32 v155, a71
    v_cvt_pk_bf16_f32 v78, v152, v153
    v_cvt_pk_bf16_f32 v79, v154, v155
    s_nop 1
    v_permlane32_swap_b32 v76, v78
    v_permlane32_swap_b32 v77, v79
    s_nop 1
    v_permlane16_swap_b32 v76, v78
    v_permlane16_swap_b32 v77, v79
    buffer_store_dwordx4 v[76:79], v60, s[16:19], s23 offen offset:128 sc1
    v_add_u32 v60, 196608, v60
    v_accvgpr_read_b32 v148, a72
    v_accvgpr_read_b32 v149, a73
    v_accvgpr_read_b32 v150, a74
    v_accvgpr_read_b32 v151, a75
    v_cvt_pk_bf16_f32 v84, v148, v149
    v_cvt_pk_bf16_f32 v85, v150, v151
    v_accvgpr_read_b32 v152, a76
    v_accvgpr_read_b32 v153, a77
    v_accvgpr_read_b32 v154, a78
    v_accvgpr_read_b32 v155, a79
    v_cvt_pk_bf16_f32 v86, v152, v153
    v_cvt_pk_bf16_f32 v87, v154, v155
    s_nop 1
    v_permlane32_swap_b32 v84, v86
    v_permlane32_swap_b32 v85, v87
    s_nop 1
    v_permlane16_swap_b32 v84, v86
    v_permlane16_swap_b32 v85, v87
    buffer_store_dwordx4 v[84:87], v60, s[16:19], s23 offen offset:0 sc1
    v_accvgpr_read_b32 v148, a80
    v_accvgpr_read_b32 v149, a81
    v_accvgpr_read_b32 v150, a82
    v_accvgpr_read_b32 v151, a83
    v_cvt_pk_bf16_f32 v92, v148, v149
    v_cvt_pk_bf16_f32 v93, v150, v151
    v_accvgpr_read_b32 v152, a84
    v_accvgpr_read_b32 v153, a85
    v_accvgpr_read_b32 v154, a86
    v_accvgpr_read_b32 v155, a87
    v_cvt_pk_bf16_f32 v94, v152, v153
    v_cvt_pk_bf16_f32 v95, v154, v155
    s_nop 1
    v_permlane32_swap_b32 v92, v94
    v_permlane32_swap_b32 v93, v95
    s_nop 1
    v_permlane16_swap_b32 v92, v94
    v_permlane16_swap_b32 v93, v95
    buffer_store_dwordx4 v[92:95], v60, s[16:19], s23 offen offset:64 sc1
    v_accvgpr_read_b32 v148, a88
    v_accvgpr_read_b32 v149, a89
    v_accvgpr_read_b32 v150, a90
    v_accvgpr_read_b32 v151, a91
    v_cvt_pk_bf16_f32 v100, v148, v149
    v_cvt_pk_bf16_f32 v101, v150, v151
    v_accvgpr_read_b32 v152, a92
    v_accvgpr_read_b32 v153, a93
    v_accvgpr_read_b32 v154, a94
    v_accvgpr_read_b32 v155, a95
    v_cvt_pk_bf16_f32 v102, v152, v153
    v_cvt_pk_bf16_f32 v103, v154, v155
    s_nop 1
    v_permlane32_swap_b32 v100, v102
    v_permlane32_swap_b32 v101, v103
    s_nop 1
    v_permlane16_swap_b32 v100, v102
    v_permlane16_swap_b32 v101, v103
    buffer_store_dwordx4 v[100:103], v60, s[16:19], s23 offen offset:128 sc1
    v_add_u32 v60, 196608, v60
    v_accvgpr_read_b32 v148, a96
    v_accvgpr_read_b32 v149, a97
    v_accvgpr_read_b32 v150, a98
    v_accvgpr_read_b32 v151, a99
    v_cvt_pk_bf16_f32 v108, v148, v149
    v_cvt_pk_bf16_f32 v109, v150, v151
    v_accvgpr_read_b32 v152, a100
    v_accvgpr_read_b32 v153, a101
    v_accvgpr_read_b32 v154, a102
    v_accvgpr_read_b32 v155, a103
    v_cvt_pk_bf16_f32 v110, v152, v153
    v_cvt_pk_bf16_f32 v111, v154, v155
    s_nop 1
    v_permlane32_swap_b32 v108, v110
    v_permlane32_swap_b32 v109, v111
    s_nop 1
    v_permlane16_swap_b32 v108, v110
    v_permlane16_swap_b32 v109, v111
    buffer_store_dwordx4 v[108:111], v60, s[16:19], s23 offen offset:0 sc1
    v_accvgpr_read_b32 v148, a104
    v_accvgpr_read_b32 v149, a105
    v_accvgpr_read_b32 v150, a106
    v_accvgpr_read_b32 v151, a107
    v_cvt_pk_bf16_f32 v116, v148, v149
    v_cvt_pk_bf16_f32 v117, v150, v151
    v_accvgpr_read_b32 v152, a108
    v_accvgpr_read_b32 v153, a109
    v_accvgpr_read_b32 v154, a110
    v_accvgpr_read_b32 v155, a111
    v_cvt_pk_bf16_f32 v118, v152, v153
    v_cvt_pk_bf16_f32 v119, v154, v155
    s_nop 1
    v_permlane32_swap_b32 v116, v118
    v_permlane32_swap_b32 v117, v119
    s_nop 1
    v_permlane16_swap_b32 v116, v118
    v_permlane16_swap_b32 v117, v119
    buffer_store_dwordx4 v[116:119], v60, s[16:19], s23 offen offset:64 sc1
    v_accvgpr_read_b32 v148, a112
    v_accvgpr_read_b32 v149, a113
    v_accvgpr_read_b32 v150, a114
    v_accvgpr_read_b32 v151, a115
    v_cvt_pk_bf16_f32 v124, v148, v149
    v_cvt_pk_bf16_f32 v125, v150, v151
    v_accvgpr_read_b32 v152, a116
    v_accvgpr_read_b32 v153, a117
    v_accvgpr_read_b32 v154, a118
    v_accvgpr_read_b32 v155, a119
    v_cvt_pk_bf16_f32 v126, v152, v153
    v_cvt_pk_bf16_f32 v127, v154, v155
    s_nop 1
    v_permlane32_swap_b32 v124, v126
    v_permlane32_swap_b32 v125, v127
    s_nop 1
    v_permlane16_swap_b32 v124, v126
    v_permlane16_swap_b32 v125, v127
    buffer_store_dwordx4 v[124:127], v60, s[16:19], s23 offen offset:128 sc1
    v_add_u32 v60, 196608, v60
    v_accvgpr_read_b32 v148, a120
    v_accvgpr_read_b32 v149, a121
    v_accvgpr_read_b32 v150, a122
    v_accvgpr_read_b32 v151, a123
    v_cvt_pk_bf16_f32 v132, v148, v149
    v_cvt_pk_bf16_f32 v133, v150, v151
    v_accvgpr_read_b32 v152, a124
    v_accvgpr_read_b32 v153, a125
    v_accvgpr_read_b32 v154, a126
    v_accvgpr_read_b32 v155, a127
    v_cvt_pk_bf16_f32 v134, v152, v153
    v_cvt_pk_bf16_f32 v135, v154, v155
    s_nop 1
    v_permlane32_swap_b32 v132, v134
    v_permlane32_swap_b32 v133, v135
    s_nop 1
    v_permlane16_swap_b32 v132, v134
    v_permlane16_swap_b32 v133, v135
    buffer_store_dwordx4 v[132:135], v60, s[16:19], s23 offen offset:0 sc1
    v_accvgpr_read_b32 v148, a128
    v_accvgpr_read_b32 v149, a129
    v_accvgpr_read_b32 v150, a130
    v_accvgpr_read_b32 v151, a131
    v_cvt_pk_bf16_f32 v76, v148, v149
    v_cvt_pk_bf16_f32 v77, v150, v151
    v_accvgpr_read_b32 v152, a132
    v_accvgpr_read_b32 v153, a133
    v_accvgpr_read_b32 v154, a134
    v_accvgpr_read_b32 v155, a135
    v_cvt_pk_bf16_f32 v78, v152, v153
    v_cvt_pk_bf16_f32 v79, v154, v155
    s_nop 1
    v_permlane32_swap_b32 v76, v78
    v_permlane32_swap_b32 v77, v79
    s_nop 1
    v_permlane16_swap_b32 v76, v78
    v_permlane16_swap_b32 v77, v79
    buffer_store_dwordx4 v[76:79], v60, s[16:19], s23 offen offset:64 sc1
    v_accvgpr_read_b32 v148, a136
    v_accvgpr_read_b32 v149, a137
    v_accvgpr_read_b32 v150, a138
    v_accvgpr_read_b32 v151, a139
    v_cvt_pk_bf16_f32 v84, v148, v149
    v_cvt_pk_bf16_f32 v85, v150, v151
    v_accvgpr_read_b32 v152, a140
    v_accvgpr_read_b32 v153, a141
    v_accvgpr_read_b32 v154, a142
    v_accvgpr_read_b32 v155, a143
    v_cvt_pk_bf16_f32 v86, v152, v153
    v_cvt_pk_bf16_f32 v87, v154, v155
    s_nop 1
    v_permlane32_swap_b32 v84, v86
    v_permlane32_swap_b32 v85, v87
    s_nop 1
    v_permlane16_swap_b32 v84, v86
    v_permlane16_swap_b32 v85, v87
    buffer_store_dwordx4 v[84:87], v60, s[16:19], s23 offen offset:128 sc1
    v_add_u32 v60, 196608, v60
    v_accvgpr_read_b32 v148, a144
    v_accvgpr_read_b32 v149, a145
    v_accvgpr_read_b32 v150, a146
    v_accvgpr_read_b32 v151, a147
    v_cvt_pk_bf16_f32 v92, v148, v149
    v_cvt_pk_bf16_f32 v93, v150, v151
    v_accvgpr_read_b32 v152, a148
    v_accvgpr_read_b32 v153, a149
    v_accvgpr_read_b32 v154, a150
    v_accvgpr_read_b32 v155, a151
    v_cvt_pk_bf16_f32 v94, v152, v153
    v_cvt_pk_bf16_f32 v95, v154, v155
    s_nop 1
    v_permlane32_swap_b32 v92, v94
    v_permlane32_swap_b32 v93, v95
    s_nop 1
    v_permlane16_swap_b32 v92, v94
    v_permlane16_swap_b32 v93, v95
    buffer_store_dwordx4 v[92:95], v60, s[16:19], s23 offen offset:0 sc1
    v_accvgpr_read_b32 v148, a152
    v_accvgpr_read_b32 v149, a153
    v_accvgpr_read_b32 v150, a154
    v_accvgpr_read_b32 v151, a155
    v_cvt_pk_bf16_f32 v100, v148, v149
    v_cvt_pk_bf16_f32 v101, v150, v151
    v_accvgpr_read_b32 v152, a156
    v_accvgpr_read_b32 v153, a157
    v_accvgpr_read_b32 v154, a158
    v_accvgpr_read_b32 v155, a159
    v_cvt_pk_bf16_f32 v102, v152, v153
    v_cvt_pk_bf16_f32 v103, v154, v155
    s_nop 1
    v_permlane32_swap_b32 v100, v102
    v_permlane32_swap_b32 v101, v103
    s_nop 1
    v_permlane16_swap_b32 v100, v102
    v_permlane16_swap_b32 v101, v103
    buffer_store_dwordx4 v[100:103], v60, s[16:19], s23 offen offset:64 sc1
    v_accvgpr_read_b32 v148, a160
    v_accvgpr_read_b32 v149, a161
    v_accvgpr_read_b32 v150, a162
    v_accvgpr_read_b32 v151, a163
    v_cvt_pk_bf16_f32 v108, v148, v149
    v_cvt_pk_bf16_f32 v109, v150, v151
    v_accvgpr_read_b32 v152, a164
    v_accvgpr_read_b32 v153, a165
    v_accvgpr_read_b32 v154, a166
    v_accvgpr_read_b32 v155, a167
    v_cvt_pk_bf16_f32 v110, v152, v153
    v_cvt_pk_bf16_f32 v111, v154, v155
    s_nop 1
    v_permlane32_swap_b32 v108, v110
    v_permlane32_swap_b32 v109, v111
    s_nop 1
    v_permlane16_swap_b32 v108, v110
    v_permlane16_swap_b32 v109, v111
    buffer_store_dwordx4 v[108:111], v60, s[16:19], s23 offen offset:128 sc1
    v_add_u32 v60, 196608, v60
    v_accvgpr_read_b32 v148, a168
    v_accvgpr_read_b32 v149, a169
    v_accvgpr_read_b32 v150, a170
    v_accvgpr_read_b32 v151, a171
    v_cvt_pk_bf16_f32 v116, v148, v149
    v_cvt_pk_bf16_f32 v117, v150, v151
    v_accvgpr_read_b32 v152, a172
    v_accvgpr_read_b32 v153, a173
    v_accvgpr_read_b32 v154, a174
    v_accvgpr_read_b32 v155, a175
    v_cvt_pk_bf16_f32 v118, v152, v153
    v_cvt_pk_bf16_f32 v119, v154, v155
    s_nop 1
    v_permlane32_swap_b32 v116, v118
    v_permlane32_swap_b32 v117, v119
    s_nop 1
    v_permlane16_swap_b32 v116, v118
    v_permlane16_swap_b32 v117, v119
    buffer_store_dwordx4 v[116:119], v60, s[16:19], s23 offen offset:0 sc1
    v_accvgpr_read_b32 v148, a176
    v_accvgpr_read_b32 v149, a177
    v_accvgpr_read_b32 v150, a178
    v_accvgpr_read_b32 v151, a179
    v_cvt_pk_bf16_f32 v124, v148, v149
    v_cvt_pk_bf16_f32 v125, v150, v151
    v_accvgpr_read_b32 v152, a180
    v_accvgpr_read_b32 v153, a181
    v_accvgpr_read_b32 v154, a182
    v_accvgpr_read_b32 v155, a183
    v_cvt_pk_bf16_f32 v126, v152, v153
    v_cvt_pk_bf16_f32 v127, v154, v155
    s_nop 1
    v_permlane32_swap_b32 v124, v126
    v_permlane32_swap_b32 v125, v127
    s_nop 1
    v_permlane16_swap_b32 v124, v126
    v_permlane16_swap_b32 v125, v127
    buffer_store_dwordx4 v[124:127], v60, s[16:19], s23 offen offset:64 sc1
    v_accvgpr_read_b32 v148, a184
    v_accvgpr_read_b32 v149, a185
    v_accvgpr_read_b32 v150, a186
    v_accvgpr_read_b32 v151, a187
    v_cvt_pk_bf16_f32 v132, v148, v149
    v_cvt_pk_bf16_f32 v133, v150, v151
    v_accvgpr_read_b32 v152, a188
    v_accvgpr_read_b32 v153, a189
    v_accvgpr_read_b32 v154, a190
    v_accvgpr_read_b32 v155, a191
    v_cvt_pk_bf16_f32 v134, v152, v153
    v_cvt_pk_bf16_f32 v135, v154, v155
    s_nop 1
    v_permlane32_swap_b32 v132, v134
    v_permlane32_swap_b32 v133, v135
    s_nop 1
    v_permlane16_swap_b32 v132, v134
    v_permlane16_swap_b32 v133, v135
    buffer_store_dwordx4 v[132:135], v60, s[16:19], s23 offen offset:128 sc1
    s_waitcnt vmcnt(0)
    s_xor_b32 s66, s66, 16
    v_mov_b32 v3, 160000
    v_add_u32 v3, s66, v3
    s_cmp_lg_u32 s61, 0
    s_cbranch_scc1 fi1_13
    v_accvgpr_read_b32 v2, a255
    s_mov_b64 exec, 1
    ds_write_b32 v3, v2
    s_mov_b64 exec, -1
    s_waitcnt lgkmcnt(0)
fi1_13:
    s_barrier
    ds_read_b32 v4, v3
    s_cmp_lg_u32 s61, 0
    s_cbranch_scc1 fi2_14
    s_mov_b64 exec, 1
    v_mov_b32 v6, 1
    v_mov_b32 v7, 0
    buffer_atomic_add v6, v7, s[56:59], s74 offen sc1
    s_mov_b64 exec, -1
fi2_14:
    s_waitcnt lgkmcnt(0)
    v_readfirstlane_b32 s62, v4
    s_nop 3
    s_cmp_eq_u32 s63, 0
    s_cbranch_scc1 mega_decA
    s_branch mega_decB
blk_glu:
    s_load_dwordx4 s[32:35], s[0:1], 64
    s_mov_b32 s8, s64
    s_mov_b32 s9, s65
    s_mov_b32 s10, 2621440
    s_mov_b32 s11, 0x00020000
    s_add_u32 s16, s64, 188219392
    s_addc_u32 s17, s65, 0
    s_mov_b32 s18, 6291456
    s_mov_b32 s19, 0x00020000
    s_waitcnt lgkmcnt(0)
    s_mov_b32 s12, s32
    s_mov_b32 s13, s33
    s_mov_b32 s14, 1966080
    s_mov_b32 s15, 0x00020000
    s_mov_b32 s28, s34
    s_mov_b32 s29, s35
    s_mov_b32 s30, 1966080
    s_mov_b32 s31, 0x00020000
    s_mul_i32 s20, s70, 327680
    s_mul_i32 s21, s71, 192
    s_mul_i32 s23, s70, 786432
    s_add_u32 s23, s23, s21
    s_add_u32 s74, s70, 32
    s_lshl_b32 s74, s74, 7
    v_lshrrev_b32 v1, 3, v0
    v_and_b32 v60, 7, v0
    s_mov_b32 s24, 1280
    v_mul_lo_u32 v2, v1, s24
    v_lshl_add_u32 v2, v60, 4, v2
    v_add_u32 v3, 40960, v2
    v_add_u32 v4, 81920, v2
    v_add_u32 v5, 122880, v2
    v_add_u32 v6, 163840, v2
    v_add_u32 v7, 204800, v2
    v_add_u32 v8, 245760, v2
    v_add_u32 v9, 286720, v2
    v_mul_u32_u24 v12, 144, v1
    v_lshl_add_u32 v12, v60, 4, v12
    v_add_u32 v13, 63488, v12
    v_lshrrev_b32 v61, 2, v0
    v_and_b32 v62, 3, v0
    s_mov_b32 s24, 3072
    v_mul_lo_u32 v10, v61, s24
    v_lshl_add_u32 v10, v62, 4, v10
    v_mul_u32_u24 v14, 416, v61
    v_lshl_add_u32 v14, v62, 4, v14
    v_add_u32 v14, 36864, v14
    v_add_u32 v15, 63488, v14
    v_and_b32 v60, 15, v0
    v_bfe_u32 v61, v0, 4, 2
    v_lshrrev_b32 v62, 7, v0
    v_bfe_u32 v63, v0, 6, 1
    v_lshl_add_u32 v64, v62, 7, v60
    v_mul_u32_u24 v16, 144, v64
    v_lshl_add_u32 v16, v61, 3, v16
    v_add_u32 v17, 63488, v16
    v_lshrrev_b32 v64, 2, v60
    v_lshl_add_u32 v64, v61, 2, v64
    v_mul_u32_u24 v18, 416, v64
    v_and_b32 v64, 3, v60
    v_lshl_add_u32 v18, v64, 3, v18
    v_mul_u32_u24 v64, 96, v63
    v_add_u32 v18, v64, v18
    v_add_u32 v18, 36864, v18
    v_add_u32 v19, 63488, v18
    buffer_load_dwordx4 v[20:23], v2, s[8:11], s20 offen
    buffer_load_dwordx4 v[24:27], v3, s[8:11], s20 offen
    buffer_load_dwordx4 v[28:31], v4, s[8:11], s20 offen
    buffer_load_dwordx4 v[32:35], v5, s[8:11], s20 offen
    buffer_load_dwordx4 v[36:39], v6, s[8:11], s20 offen
    buffer_load_dwordx4 v[40:43], v7, s[8:11], s20 offen
    buffer_load_dwordx4 v[44:47], v8, s[8:11], s20 offen
    buffer_load_dwordx4 v[48:51], v9, s[8:11], s20 offen
    buffer_load_dwordx4 v[52:55], v10, s[12:15], s21 offen offset:0
    buffer_load_dwordx4 v[56:59], v10, s[12:15], s21 offen offset:64
    buffer_load_dwordx4 v[60:63], v10, s[12:15], s21 offen offset:128
    buffer_load_dwordx4 v[64:67], v10, s[28:31], s21 offen offset:0
    buffer_load_dwordx4 v[68:71], v10, s[28:31], s21 offen offset:64
    buffer_load_dwordx4 v[72:75], v10, s[28:31], s21 offen offset:128
    s_add_u32 s20, s20, 128
    s_add_u32 s21, s21, 196608
    buffer_load_dwordx4 v[188:191], v2, s[8:11], s20 offen
    buffer_load_dwordx4 v[192:195], v3, s[8:11], s20 offen
    buffer_load_dwordx4 v[196:199], v4, s[8:11], s20 offen
    buffer_load_dwordx4 v[200:203], v5, s[8:11], s20 offen
    buffer_load_dwordx4 v[204:207], v6, s[8:11], s20 offen
    buffer_load_dwordx4 v[208:211], v7, s[8:11], s20 offen
    buffer_load_dwordx4 v[212:215], v8, s[8:11], s20 offen
    buffer_load_dwordx4 v[216:219], v9, s[8:11], s20 offen
    buffer_load_dwordx4 v[220:223], v10, s[12:15], s21 offen offset:0
    buffer_load_dwordx4 v[224:227], v10, s[12:15], s21 offen offset:64
    buffer_load_dwordx4 v[228:231], v10, s[12:15], s21 offen offset:128
    buffer_load_dwordx4 v[232:235], v10, s[28:31], s21 offen offset:0
    buffer_load_dwordx4 v[236:239], v10, s[28:31], s21 offen offset:64
    buffer_load_dwordx4 v[240:243], v10, s[28:31], s21 offen offset:128
    s_add_u32 s20, s20, 128
    s_add_u32 s21, s21, 196608
    v_accvgpr_write_b32 a0, 0
    v_accvgpr_write_b32 a1, 0
    v_accvgpr_write_b32 a2, 0
    v_accvgpr_write_b32 a3, 0
    v_accvgpr_write_b32 a4, 0
    v_accvgpr_write_b32 a5, 0
    v_accvgpr_write_b32 a6, 0
    v_accvgpr_write_b32 a7, 0
    v_accvgpr_write_b32 a8, 0
    v_accvgpr_write_b32 a9, 0
    v_accvgpr_write_b32 a10, 0
    v_accvgpr_write_b32 a11, 0
    v_accvgpr_write_b32 a12, 0
    v_accvgpr_write_b32 a13, 0
    v_accvgpr_write_b32 a14, 0
    v_accvgpr_write_b32 a15, 0
    v_accvgpr_write_b32 a16, 0
    v_accvgpr_write_b32 a17, 0
    v_accvgpr_write_b32 a18, 0
    v_accvgpr_write_b32 a19, 0
    v_accvgpr_write_b32 a20, 0
    v_accvgpr_write_b32 a21, 0
    v_accvgpr_write_b32 a22, 0
    v_accvgpr_write_b32 a23, 0
    v_accvgpr_write_b32 a24, 0
    v_accvgpr_write_b32 a25, 0
    v_accvgpr_write_b32 a26, 0
    v_accvgpr_write_b32 a27, 0
    v_accvgpr_write_b32 a28, 0
    v_accvgpr_write_b32 a29, 0
    v_accvgpr_write_b32 a30, 0
    v_accvgpr_write_b32 a31, 0
    v_accvgpr_write_b32 a32, 0
    v_accvgpr_write_b32 a33, 0
    v_accvgpr_write_b32 a34, 0
    v_accvgpr_write_b32 a35, 0
    v_accvgpr_write_b32 a36, 0
    v_accvgpr_write_b32 a37, 0
    v_accvgpr_write_b32 a38, 0
    v_accvgpr_write_b32 a39, 0
    v_accvgpr_write_b32 a40, 0
    v_accvgpr_write_b32 a41, 0
    v_accvgpr_write_b32 a42, 0
    v_accvgpr_write_b32 a43, 0
    v_accvgpr_write_b32 a44, 0
    v_accvgpr_write_b32 a45, 0
    v_accvgpr_write_b32 a46, 0
    v_accvgpr_write_b32 a47, 0
    v_accvgpr_write_b32 a48, 0
    v_accvgpr_write_b32 a49, 0
    v_accvgpr_write_b32 a50, 0
    v_accvgpr_write_b32 a51, 0
    v_accvgpr_write_b32 a52, 0
    v_accvgpr_write_b32 a53, 0
    v_accvgpr_write_b32 a54, 0
    v_accvgpr_write_b32 a55, 0
    v_accvgpr_write_b32 a56, 0
    v_accvgpr_write_b32 a57, 0
    v_accvgpr_write_b32 a58, 0
    v_accvgpr_write_b32 a59, 0
    v_accvgpr_write_b32 a60, 0
    v_accvgpr_write_b32 a61, 0
    v_accvgpr_write_b32 a62, 0
    v_accvgpr_write_b32 a63, 0
    v_accvgpr_write_b32 a64, 0
    v_accvgpr_write_b32 a65, 0
    v_accvgpr_write_b32 a66, 0
    v_accvgpr_write_b32 a67, 0
    v_accvgpr_write_b32 a68, 0
    v_accvgpr_write_b32 a69, 0
    v_accvgpr_write_b32 a70, 0
    v_accvgpr_write_b32 a71, 0
    v_accvgpr_write_b32 a72, 0
    v_accvgpr_write_b32 a73, 0
    v_accvgpr_write_b32 a74, 0
    v_accvgpr_write_b32 a75, 0
    v_accvgpr_write_b32 a76, 0
    v_accvgpr_write_b32 a77, 0
    v_accvgpr_write_b32 a78, 0
    v_accvgpr_write_b32 a79, 0
    v_accvgpr_write_b32 a80, 0
    v_accvgpr_write_b32 a81, 0
    v_accvgpr_write_b32 a82, 0
    v_accvgpr_write_b32 a83, 0
    v_accvgpr_write_b32 a84, 0
    v_accvgpr_write_b32 a85, 0
    v_accvgpr_write_b32 a86, 0
    v_accvgpr_write_b32 a87, 0
    v_accvgpr_write_b32 a88, 0
    v_accvgpr_write_b32 a89, 0
    v_accvgpr_write_b32 a90, 0
    v_accvgpr_write_b32 a91, 0
    v_accvgpr_write_b32 a92, 0
    v_accvgpr_write_b32 a93, 0
    v_accvgpr_write_b32 a94, 0
    v_accvgpr_write_b32 a95, 0
    v_accvgpr_write_b32 a96, 0
    v_accvgpr_write_b32 a97, 0
    v_accvgpr_write_b32 a98, 0
    v_accvgpr_write_b32 a99, 0
    v_accvgpr_write_b32 a100, 0
    v_accvgpr_write_b32 a101, 0
    v_accvgpr_write_b32 a102, 0
    v_accvgpr_write_b32 a103, 0
    v_accvgpr_write_b32 a104, 0
    v_accvgpr_write_b32 a105, 0
    v_accvgpr_write_b32 a106, 0
    v_accvgpr_write_b32 a107, 0
    v_accvgpr_write_b32 a108, 0
    v_accvgpr_write_b32 a109, 0
    v_accvgpr_write_b32 a110, 0
    v_accvgpr_write_b32 a111, 0
    v_accvgpr_write_b32 a112, 0
    v_accvgpr_write_b32 a113, 0
    v_accvgpr_write_b32 a114, 0
    v_accvgpr_write_b32 a115, 0
    v_accvgpr_write_b32 a116, 0
    v_accvgpr_write_b32 a117, 0
    v_accvgpr_write_b32 a118, 0
    v_accvgpr_write_b32 a119, 0
    v_accvgpr_write_b32 a120, 0
    v_accvgpr_write_b32 a121, 0
    v_accvgpr_write_b32 a122, 0
    v_accvgpr_write_b32 a123, 0
    v_accvgpr_write_b32 a124, 0
    v_accvgpr_write_b32 a125, 0
    v_accvgpr_write_b32 a126, 0
    v_accvgpr_write_b32 a127, 0
    v_accvgpr_write_b32 a128, 0
    v_accvgpr_write_b32 a129, 0
    v_accvgpr_write_b32 a130, 0
    v_accvgpr_write_b32 a131, 0
    v_accvgpr_write_b32 a132, 0
    v_accvgpr_write_b32 a133, 0
    v_accvgpr_write_b32 a134, 0
    v_accvgpr_write_b32 a135, 0
    v_accvgpr_write_b32 a136, 0
    v_accvgpr_write_b32 a137, 0
    v_accvgpr_write_b32 a138, 0
    v_accvgpr_write_b32 a139, 0
    v_accvgpr_write_b32 a140, 0
    v_accvgpr_write_b32 a141, 0
    v_accvgpr_write_b32 a142, 0
    v_accvgpr_write_b32 a143, 0
    v_accvgpr_write_b32 a144, 0
    v_accvgpr_write_b32 a145, 0
    v_accvgpr_write_b32 a146, 0
    v_accvgpr_write_b32 a147, 0
    v_accvgpr_write_b32 a148, 0
    v_accvgpr_write_b32 a149, 0
    v_accvgpr_write_b32 a150, 0
    v_accvgpr_write_b32 a151, 0
    v_accvgpr_write_b32 a152, 0
    v_accvgpr_write_b32 a153, 0
    v_accvgpr_write_b32 a154, 0
    v_accvgpr_write_b32 a155, 0
    v_accvgpr_write_b32 a156, 0
    v_accvgpr_write_b32 a157, 0
    v_accvgpr_write_b32 a158, 0
    v_accvgpr_write_b32 a159, 0
    v_accvgpr_write_b32 a160, 0
    v_accvgpr_write_b32 a161, 0
    v_accvgpr_write_b32 a162, 0
    v_accvgpr_write_b32 a163, 0
    v_accvgpr_write_b32 a164, 0
    v_accvgpr_write_b32 a165, 0
    v_accvgpr_write_b32 a166, 0
    v_accvgpr_write_b32 a167, 0
    v_accvgpr_write_b32 a168, 0
    v_accvgpr_write_b32 a169, 0
    v_accvgpr_write_b32 a170, 0
    v_accvgpr_write_b32 a171, 0
    v_accvgpr_write_b32 a172, 0
    v_accvgpr_write_b32 a173, 0
    v_accvgpr_write_b32 a174, 0
    v_accvgpr_write_b32 a175, 0
    v_accvgpr_write_b32 a176, 0
    v_accvgpr_write_b32 a177, 0
    v_accvgpr_write_b32 a178, 0
    v_accvgpr_write_b32 a179, 0
    v_accvgpr_write_b32 a180, 0
    v_accvgpr_write_b32 a181, 0
    v_accvgpr_write_b32 a182, 0
    v_accvgpr_write_b32 a183, 0
    v_accvgpr_write_b32 a184, 0
    v_accvgpr_write_b32 a185, 0
    v_accvgpr_write_b32 a186, 0
    v_accvgpr_write_b32 a187, 0
    v_accvgpr_write_b32 a188, 0
    v_accvgpr_write_b32 a189, 0
    v_accvgpr_write_b32 a190, 0
    v_accvgpr_write_b32 a191, 0
    s_waitcnt vmcnt(14)
    ds_write_b128 v12, v[20:23] offset:0
    ds_write_b128 v12, v[24:27] offset:4608
    ds_write_b128 v12, v[28:31] offset:9216
    ds_write_b128 v12, v[32:35] offset:13824
    ds_write_b128 v12, v[36:39] offset:18432
    ds_write_b128 v12, v[40:43] offset:23040
    ds_write_b128 v12, v[44:47] offset:27648
    ds_write_b128 v12, v[48:51] offset:32256
    ds_write_b128 v14, v[52:55] offset:0
    ds_write_b128 v14, v[56:59] offset:64
    ds_write_b128 v14, v[60:63] offset:128
    ds_write_b128 v14, v[64:67] offset:192
    ds_write_b128 v14, v[68:71] offset:256
    ds_write_b128 v14, v[72:75] offset:320
    s_waitcnt lgkmcnt(0)
    buffer_load_dwordx4 v[20:23], v2, s[8:11], s20 offen
    buffer_load_dwordx4 v[24:27], v3, s[8:11], s20 offen
    buffer_load_dwordx4 v[28:31], v4, s[8:11], s20 offen
    buffer_load_dwordx4 v[32:35], v5, s[8:11], s20 offen
    buffer_load_dwordx4 v[36:39], v6, s[8:11], s20 offen
    buffer_load_dwordx4 v[40:43], v7, s[8:11], s20 offen
    buffer_load_dwordx4 v[44:47], v8, s[8:11], s20 offen
    buffer_load_dwordx4 v[48:51], v9, s[8:11], s20 offen
    buffer_load_dwordx4 v[52:55], v10, s[12:15], s21 offen offset:0
    buffer_load_dwordx4 v[56:59], v10, s[12:15], s21 offen offset:64
    buffer_load_dwordx4 v[60:63], v10, s[12:15], s21 offen offset:128
    buffer_load_dwordx4 v[64:67], v10, s[28:31], s21 offen offset:0
    buffer_load_dwordx4 v[68:71], v10, s[28:31], s21 offen offset:64
    buffer_load_dwordx4 v[72:75], v10, s[28:31], s21 offen offset:128
    s_add_u32 s20, s20, 128
    s_add_u32 s21, s21, 196608
    s_barrier
    ds_read_b64_tr_b16 v[108:109], v18 offset:0
    ds_read_b64_tr_b16 v[110:111], v18 offset:6656
    ds_read_b64_tr_b16 v[112:113], v18 offset:32
    ds_read_b64_tr_b16 v[114:115], v18 offset:6688
    ds_read_b64_tr_b16 v[116:117], v18 offset:64
    ds_read_b64_tr_b16 v[118:119], v18 offset:6720
    ds_read_b64_tr_b16 v[120:121], v18 offset:192
    ds_read_b64_tr_b16 v[122:123], v18 offset:6848
    ds_read_b64_tr_b16 v[124:125], v18 offset:224
    ds_read_b64_tr_b16 v[126:127], v18 offset:6880
    ds_read_b64_tr_b16 v[128:129], v18 offset:256
    ds_read_b64_tr_b16 v[130:131], v18 offset:6912
    ds_read_b64 v[76:77], v16 offset:0
    ds_read_b64 v[78:79], v16 offset:32
    ds_read_b64 v[80:81], v16 offset:2304
    ds_read_b64 v[82:83], v16 offset:2336
    ds_read_b64 v[84:85], v16 offset:4608
    ds_read_b64 v[86:87], v16 offset:4640
    ds_read_b64 v[88:89], v16 offset:6912
    ds_read_b64 v[90:91], v16 offset:6944
    ds_read_b64 v[92:93], v16 offset:9216
    ds_read_b64 v[94:95], v16 offset:9248
    ds_read_b64 v[96:97], v16 offset:11520
    ds_read_b64 v[98:99], v16 offset:11552
    ds_read_b64 v[100:101], v16 offset:13824
    ds_read_b64 v[102:103], v16 offset:13856
    ds_read_b64 v[104:105], v16 offset:16128
    ds_read_b64 v[106:107], v16 offset:16160
    s_mov_b32 s22, 10
    s_waitcnt lgkmcnt(0)
mglu_loop:
    v_mfma_f32_16x16x32_bf16 a[0:3], v[108:111], v[76:79], a[0:3]
    v_mfma_f32_16x16x32_bf16 a[4:7], v[112:115], v[76:79], a[4:7]
    ds_read_b64_tr_b16 v[164:165], v18 offset:13312
    v_mfma_f32_16x16x32_bf16 a[8:11], v[116:119], v[76:79], a[8:11]
    ds_read_b64_tr_b16 v[166:167], v18 offset:19968
    v_mfma_f32_16x16x32_bf16 a[12:15], v[120:123], v[76:79], a[12:15]
    ds_read_b64_tr_b16 v[168:169], v18 offset:13344
    v_mfma_f32_16x16x32_bf16 a[16:19], v[124:127], v[76:79], a[16:19]
    ds_read_b64_tr_b16 v[170:171], v18 offset:20000
    v_mfma_f32_16x16x32_bf16 a[20:23], v[128:131], v[76:79], a[20:23]
    ds_read_b64_tr_b16 v[172:173], v18 offset:13376
    v_mfma_f32_16x16x32_bf16 a[24:27], v[108:111], v[80:83], a[24:27]
    ds_read_b64_tr_b16 v[174:175], v18 offset:20032
    v_mfma_f32_16x16x32_bf16 a[28:31], v[112:115], v[80:83], a[28:31]
    ds_read_b64_tr_b16 v[176:177], v18 offset:13504
    v_mfma_f32_16x16x32_bf16 a[32:35], v[116:119], v[80:83], a[32:35]
    ds_read_b64_tr_b16 v[178:179], v18 offset:20160
    v_mfma_f32_16x16x32_bf16 a[36:39], v[120:123], v[80:83], a[36:39]
    ds_read_b64_tr_b16 v[180:181], v18 offset:13536
    v_mfma_f32_16x16x32_bf16 a[40:43], v[124:127], v[80:83], a[40:43]
    ds_read_b64_tr_b16 v[182:183], v18 offset:20192
    v_mfma_f32_16x16x32_bf16 a[44:47], v[128:131], v[80:83], a[44:47]
    ds_read_b64_tr_b16 v[184:185], v18 offset:13568
    v_mfma_f32_16x16x32_bf16 a[48:51], v[108:111], v[84:87], a[48:51]
    ds_read_b64_tr_b16 v[186:187], v18 offset:20224
    v_mfma_f32_16x16x32_bf16 a[52:55], v[112:115], v[84:87], a[52:55]
    ds_read_b64 v[132:133], v16 offset:64
    v_mfma_f32_16x16x32_bf16 a[56:59], v[116:119], v[84:87], a[56:59]
    ds_read_b64 v[134:135], v16 offset:96
    v_mfma_f32_16x16x32_bf16 a[60:63], v[120:123], v[84:87], a[60:63]
    ds_read_b64 v[136:137], v16 offset:2368
    v_mfma_f32_16x16x32_bf16 a[64:67], v[124:127], v[84:87], a[64:67]
    ds_read_b64 v[138:139], v16 offset:2400
    v_mfma_f32_16x16x32_bf16 a[68:71], v[128:131], v[84:87], a[68:71]
    ds_read_b64 v[140:141], v16 offset:4672
    v_mfma_f32_16x16x32_bf16 a[72:75], v[108:111], v[88:91], a[72:75]
    ds_read_b64 v[142:143], v16 offset:4704
    v_mfma_f32_16x16x32_bf16 a[76:79], v[112:115], v[88:91], a[76:79]
    ds_read_b64 v[144:145], v16 offset:6976
    v_mfma_f32_16x16x32_bf16 a[80:83], v[116:119], v[88:91], a[80:83]
    ds_read_b64 v[146:147], v16 offset:7008
    v_mfma_f32_16x16x32_bf16 a[84:87], v[120:123], v[88:91], a[84:87]
    ds_read_b64 v[148:149], v16 offset:9280
    v_mfma_f32_16x16x32_bf16 a[88:91], v[124:127], v[88:91], a[88:91]
    ds_read_b64 v[150:151], v16 offset:9312
    v_mfma_f32_16x16x32_bf16 a[92:95], v[128:131], v[88:91], a[92:95]
    ds_read_b64 v[152:153], v16 offset:11584
    v_mfma_f32_16x16x32_bf16 a[96:99], v[108:111], v[92:95], a[96:99]
    ds_read_b64 v[154:155], v16 offset:11616
    v_mfma_f32_16x16x32_bf16 a[100:103], v[112:115], v[92:95], a[100:103]
    ds_read_b64 v[156:157], v16 offset:13888
    v_mfma_f32_16x16x32_bf16 a[104:107], v[116:119], v[92:95], a[104:107]
    ds_read_b64 v[158:159], v16 offset:13920
    v_mfma_f32_16x16x32_bf16 a[108:111], v[120:123], v[92:95], a[108:111]
    ds_read_b64 v[160:161], v16 offset:16192
    v_mfma_f32_16x16x32_bf16 a[112:115], v[124:127], v[92:95], a[112:115]
    ds_read_b64 v[162:163], v16 offset:16224
    v_mfma_f32_16x16x32_bf16 a[116:119], v[128:131], v[92:95], a[116:119]
    v_mfma_f32_16x16x32_bf16 a[120:123], v[108:111], v[96:99], a[120:123]
    v_mfma_f32_16x16x32_bf16 a[124:127], v[112:115], v[96:99], a[124:127]
    v_mfma_f32_16x16x32_bf16 a[128:131], v[116:119], v[96:99], a[128:131]
    v_mfma_f32_16x16x32_bf16 a[132:135], v[120:123], v[96:99], a[132:135]
    v_mfma_f32_16x16x32_bf16 a[136:139], v[124:127], v[96:99], a[136:139]
    v_mfma_f32_16x16x32_bf16 a[140:143], v[128:131], v[96:99], a[140:143]
    v_mfma_f32_16x16x32_bf16 a[144:147], v[108:111], v[100:103], a[144:147]
    v_mfma_f32_16x16x32_bf16 a[148:151], v[112:115], v[100:103], a[148:151]
    v_mfma_f32_16x16x32_bf16 a[152:155], v[116:119], v[100:103], a[152:155]
    v_mfma_f32_16x16x32_bf16 a[156:159], v[120:123], v[100:103], a[156:159]
    v_mfma_f32_16x16x32_bf16 a[160:163], v[124:127], v[100:103], a[160:163]
    v_mfma_f32_16x16x32_bf16 a[164:167], v[128:131], v[100:103], a[164:167]
    v_mfma_f32_16x16x32_bf16 a[168:171], v[108:111], v[104:107], a[168:171]
    v_mfma_f32_16x16x32_bf16 a[172:175], v[112:115], v[104:107], a[172:175]
    v_mfma_f32_16x16x32_bf16 a[176:179], v[116:119], v[104:107], a[176:179]
    v_mfma_f32_16x16x32_bf16 a[180:183], v[120:123], v[104:107], a[180:183]
    v_mfma_f32_16x16x32_bf16 a[184:187], v[124:127], v[104:107], a[184:187]
    v_mfma_f32_16x16x32_bf16 a[188:191], v[128:131], v[104:107], a[188:191]
    s_waitcnt lgkmcnt(0)
    s_waitcnt vmcnt(14)
    v_mfma_f32_16x16x32_bf16 a[0:3], v[164:167], v[132:135], a[0:3]
    ds_write_b128 v13, v[188:191] offset:0
    v_mfma_f32_16x16x32_bf16 a[4:7], v[168:171], v[132:135], a[4:7]
    ds_write_b128 v13, v[192:195] offset:4608
    v_mfma_f32_16x16x32_bf16 a[8:11], v[172:175], v[132:135], a[8:11]
    ds_write_b128 v13, v[196:199] offset:9216
    v_mfma_f32_16x16x32_bf16 a[12:15], v[176:179], v[132:135], a[12:15]
    ds_write_b128 v13, v[200:203] offset:13824
    v_mfma_f32_16x16x32_bf16 a[16:19], v[180:183], v[132:135], a[16:19]
    ds_write_b128 v13, v[204:207] offset:18432
    v_mfma_f32_16x16x32_bf16 a[20:23], v[184:187], v[132:135], a[20:23]
    ds_write_b128 v13, v[208:211] offset:23040
    v_mfma_f32_16x16x32_bf16 a[24:27], v[164:167], v[136:139], a[24:27]
    ds_write_b128 v13, v[212:215] offset:27648
    v_mfma_f32_16x16x32_bf16 a[28:31], v[168:171], v[136:139], a[28:31]
    ds_write_b128 v13, v[216:219] offset:32256
    v_mfma_f32_16x16x32_bf16 a[32:35], v[172:175], v[136:139], a[32:35]
    ds_write_b128 v15, v[220:223] offset:0
    v_mfma_f32_16x16x32_bf16 a[36:39], v[176:179], v[136:139], a[36:39]
    ds_write_b128 v15, v[224:227] offset:64
    v_mfma_f32_16x16x32_bf16 a[40:43], v[180:183], v[136:139], a[40:43]
    ds_write_b128 v15, v[228:231] offset:128
    v_mfma_f32_16x16x32_bf16 a[44:47], v[184:187], v[136:139], a[44:47]
    ds_write_b128 v15, v[232:235] offset:192
    v_mfma_f32_16x16x32_bf16 a[48:51], v[164:167], v[140:143], a[48:51]
    ds_write_b128 v15, v[236:239] offset:256
    v_mfma_f32_16x16x32_bf16 a[52:55], v[168:171], v[140:143], a[52:55]
    ds_write_b128 v15, v[240:243] offset:320
    v_mfma_f32_16x16x32_bf16 a[56:59], v[172:175], v[140:143], a[56:59]
    v_mfma_f32_16x16x32_bf16 a[60:63], v[176:179], v[140:143], a[60:63]
    s_waitcnt lgkmcnt(0)
    s_barrier
    v_mfma_f32_16x16x32_bf16 a[64:67], v[180:183], v[140:143], a[64:67]
    ds_read_b64_tr_b16 v[108:109], v19 offset:0
    ds_read_b64_tr_b16 v[110:111], v19 offset:6656
    v_mfma_f32_16x16x32_bf16 a[68:71], v[184:187], v[140:143], a[68:71]
    buffer_load_dwordx4 v[188:191], v2, s[8:11], s20 offen
    ds_read_b64_tr_b16 v[112:113], v19 offset:32
    v_mfma_f32_16x16x32_bf16 a[72:75], v[164:167], v[144:147], a[72:75]
    ds_read_b64_tr_b16 v[114:115], v19 offset:6688
    buffer_load_dwordx4 v[192:195], v3, s[8:11], s20 offen
    v_mfma_f32_16x16x32_bf16 a[76:79], v[168:171], v[144:147], a[76:79]
    ds_read_b64_tr_b16 v[116:117], v19 offset:64
    ds_read_b64_tr_b16 v[118:119], v19 offset:6720
    v_mfma_f32_16x16x32_bf16 a[80:83], v[172:175], v[144:147], a[80:83]
    buffer_load_dwordx4 v[196:199], v4, s[8:11], s20 offen
    ds_read_b64_tr_b16 v[120:121], v19 offset:192
    v_mfma_f32_16x16x32_bf16 a[84:87], v[176:179], v[144:147], a[84:87]
    ds_read_b64_tr_b16 v[122:123], v19 offset:6848
    buffer_load_dwordx4 v[200:203], v5, s[8:11], s20 offen
    v_mfma_f32_16x16x32_bf16 a[88:91], v[180:183], v[144:147], a[88:91]
    ds_read_b64_tr_b16 v[124:125], v19 offset:224
    ds_read_b64_tr_b16 v[126:127], v19 offset:6880
    v_mfma_f32_16x16x32_bf16 a[92:95], v[184:187], v[144:147], a[92:95]
    buffer_load_dwordx4 v[204:207], v6, s[8:11], s20 offen
    ds_read_b64_tr_b16 v[128:129], v19 offset:256
    v_mfma_f32_16x16x32_bf16 a[96:99], v[164:167], v[148:151], a[96:99]
    ds_read_b64_tr_b16 v[130:131], v19 offset:6912
    buffer_load_dwordx4 v[208:211], v7, s[8:11], s20 offen
    v_mfma_f32_16x16x32_bf16 a[100:103], v[168:171], v[148:151], a[100:103]
    ds_read_b64 v[76:77], v17 offset:0
    ds_read_b64 v[78:79], v17 offset:32
    v_mfma_f32_16x16x32_bf16 a[104:107], v[172:175], v[148:151], a[104:107]
    buffer_load_dwordx4 v[212:215], v8, s[8:11], s20 offen
    ds_read_b64 v[80:81], v17 offset:2304
    v_mfma_f32_16x16x32_bf16 a[108:111], v[176:179], v[148:151], a[108:111]
    ds_read_b64 v[82:83], v17 offset:2336
    buffer_load_dwordx4 v[216:219], v9, s[8:11], s20 offen
    v_mfma_f32_16x16x32_bf16 a[112:115], v[180:183], v[148:151], a[112:115]
    ds_read_b64 v[84:85], v17 offset:4608
    ds_read_b64 v[86:87], v17 offset:4640
    v_mfma_f32_16x16x32_bf16 a[116:119], v[184:187], v[148:151], a[116:119]
    buffer_load_dwordx4 v[220:223], v10, s[12:15], s21 offen offset:0
    ds_read_b64 v[88:89], v17 offset:6912
    v_mfma_f32_16x16x32_bf16 a[120:123], v[164:167], v[152:155], a[120:123]
    ds_read_b64 v[90:91], v17 offset:6944
    buffer_load_dwordx4 v[224:227], v10, s[12:15], s21 offen offset:64
    v_mfma_f32_16x16x32_bf16 a[124:127], v[168:171], v[152:155], a[124:127]
    ds_read_b64 v[92:93], v17 offset:9216
    ds_read_b64 v[94:95], v17 offset:9248
    v_mfma_f32_16x16x32_bf16 a[128:131], v[172:175], v[152:155], a[128:131]
    buffer_load_dwordx4 v[228:231], v10, s[12:15], s21 offen offset:128
    ds_read_b64 v[96:97], v17 offset:11520
    v_mfma_f32_16x16x32_bf16 a[132:135], v[176:179], v[152:155], a[132:135]
    ds_read_b64 v[98:99], v17 offset:11552
    buffer_load_dwordx4 v[232:235], v10, s[28:31], s21 offen offset:0
    v_mfma_f32_16x16x32_bf16 a[136:139], v[180:183], v[152:155], a[136:139]
    ds_read_b64 v[100:101], v17 offset:13824
    ds_read_b64 v[102:103], v17 offset:13856
    v_mfma_f32_16x16x32_bf16 a[140:143], v[184:187], v[152:155], a[140:143]
    buffer_load_dwordx4 v[236:239], v10, s[28:31], s21 offen offset:64
    ds_read_b64 v[104:105], v17 offset:16128
    v_mfma_f32_16x16x32_bf16 a[144:147], v[164:167], v[156:159], a[144:147]
    ds_read_b64 v[106:107], v17 offset:16160
    buffer_load_dwordx4 v[240:243], v10, s[28:31], s21 offen offset:128
    v_mfma_f32_16x16x32_bf16 a[148:151], v[168:171], v[156:159], a[148:151]
    v_mfma_f32_16x16x32_bf16 a[152:155], v[172:175], v[156:159], a[152:155]
    v_mfma_f32_16x16x32_bf16 a[156:159], v[176:179], v[156:159], a[156:159]
    v_mfma_f32_16x16x32_bf16 a[160:163], v[180:183], v[156:159], a[160:163]
    v_mfma_f32_16x16x32_bf16 a[164:167], v[184:187], v[156:159], a[164:167]
    v_mfma_f32_16x16x32_bf16 a[168:171], v[164:167], v[160:163], a[168:171]
    v_mfma_f32_16x16x32_bf16 a[172:175], v[168:171], v[160:163], a[172:175]
    v_mfma_f32_16x16x32_bf16 a[176:179], v[172:175], v[160:163], a[176:179]
    v_mfma_f32_16x16x32_bf16 a[180:183], v[176:179], v[160:163], a[180:183]
    v_mfma_f32_16x16x32_bf16 a[184:187], v[180:183], v[160:163], a[184:187]
    v_mfma_f32_16x16x32_bf16 a[188:191], v[184:187], v[160:163], a[188:191]
    s_add_u32 s20, s20, 128
    s_add_u32 s21, s21, 196608
    s_sub_u32 s22, s22, 1
    s_cmp_eq_u32 s22, 0
    s_waitcnt lgkmcnt(0)
    s_cbranch_scc1 mglu_done
    v_mfma_f32_16x16x32_bf16 a[0:3], v[108:111], v[76:79], a[0:3]
    v_mfma_f32_16x16x32_bf16 a[4:7], v[112:115], v[76:79], a[4:7]
    ds_read_b64_tr_b16 v[164:165], v19 offset:13312
    v_mfma_f32_16x16x32_bf16 a[8:11], v[116:119], v[76:79], a[8:11]
    ds_read_b64_tr_b16 v[166:167], v19 offset:19968
    v_mfma_f32_16x16x32_bf16 a[12:15], v[120:123], v[76:79], a[12:15]
    ds_read_b64_tr_b16 v[168:169], v19 offset:13344
    v_mfma_f32_16x16x32_bf16 a[16:19], v[124:127], v[76:79], a[16:19]
    ds_read_b64_tr_b16 v[170:171], v19 offset:20000
    v_mfma_f32_16x16x32_bf16 a[20:23], v[128:131], v[76:79], a[20:23]
    ds_read_b64_tr_b16 v[172:173], v19 offset:13376
    v_mfma_f32_16x16x32_bf16 a[24:27], v[108:111], v[80:83], a[24:27]
    ds_read_b64_tr_b16 v[174:175], v19 offset:20032
    v_mfma_f32_16x16x32_bf16 a[28:31], v[112:115], v[80:83], a[28:31]
    ds_read_b64_tr_b16 v[176:177], v19 offset:13504
    v_mfma_f32_16x16x32_bf16 a[32:35], v[116:119], v[80:83], a[32:35]
    ds_read_b64_tr_b16 v[178:179], v19 offset:20160
    v_mfma_f32_16x16x32_bf16 a[36:39], v[120:123], v[80:83], a[36:39]
    ds_read_b64_tr_b16 v[180:181], v19 offset:13536
    v_mfma_f32_16x16x32_bf16 a[40:43], v[124:127], v[80:83], a[40:43]
    ds_read_b64_tr_b16 v[182:183], v19 offset:20192
    v_mfma_f32_16x16x32_bf16 a[44:47], v[128:131], v[80:83], a[44:47]
    ds_read_b64_tr_b16 v[184:185], v19 offset:13568
    v_mfma_f32_16x16x32_bf16 a[48:51], v[108:111], v[84:87], a[48:51]
    ds_read_b64_tr_b16 v[186:187], v19 offset:20224
    v_mfma_f32_16x16x32_bf16 a[52:55], v[112:115], v[84:87], a[52:55]
    ds_read_b64 v[132:133], v17 offset:64
    v_mfma_f32_16x16x32_bf16 a[56:59], v[116:119], v[84:87], a[56:59]
    ds_read_b64 v[134:135], v17 offset:96
    v_mfma_f32_16x16x32_bf16 a[60:63], v[120:123], v[84:87], a[60:63]
    ds_read_b64 v[136:137], v17 offset:2368
    v_mfma_f32_16x16x32_bf16 a[64:67], v[124:127], v[84:87], a[64:67]
    ds_read_b64 v[138:139], v17 offset:2400
    v_mfma_f32_16x16x32_bf16 a[68:71], v[128:131], v[84:87], a[68:71]
    ds_read_b64 v[140:141], v17 offset:4672
    v_mfma_f32_16x16x32_bf16 a[72:75], v[108:111], v[88:91], a[72:75]
    ds_read_b64 v[142:143], v17 offset:4704
    v_mfma_f32_16x16x32_bf16 a[76:79], v[112:115], v[88:91], a[76:79]
    ds_read_b64 v[144:145], v17 offset:6976
    v_mfma_f32_16x16x32_bf16 a[80:83], v[116:119], v[88:91], a[80:83]
    ds_read_b64 v[146:147], v17 offset:7008
    v_mfma_f32_16x16x32_bf16 a[84:87], v[120:123], v[88:91], a[84:87]
    ds_read_b64 v[148:149], v17 offset:9280
    v_mfma_f32_16x16x32_bf16 a[88:91], v[124:127], v[88:91], a[88:91]
    ds_read_b64 v[150:151], v17 offset:9312
    v_mfma_f32_16x16x32_bf16 a[92:95], v[128:131], v[88:91], a[92:95]
    ds_read_b64 v[152:153], v17 offset:11584
    v_mfma_f32_16x16x32_bf16 a[96:99], v[108:111], v[92:95], a[96:99]
    ds_read_b64 v[154:155], v17 offset:11616
    v_mfma_f32_16x16x32_bf16 a[100:103], v[112:115], v[92:95], a[100:103]
    ds_read_b64 v[156:157], v17 offset:13888
    v_mfma_f32_16x16x32_bf16 a[104:107], v[116:119], v[92:95], a[104:107]
    ds_read_b64 v[158:159], v17 offset:13920
    v_mfma_f32_16x16x32_bf16 a[108:111], v[120:123], v[92:95], a[108:111]
    ds_read_b64 v[160:161], v17 offset:16192
    v_mfma_f32_16x16x32_bf16 a[112:115], v[124:127], v[92:95], a[112:115]
    ds_read_b64 v[162:163], v17 offset:16224
    v_mfma_f32_16x16x32_bf16 a[116:119], v[128:131], v[92:95], a[116:119]
    v_mfma_f32_16x16x32_bf16 a[120:123], v[108:111], v[96:99], a[120:123]
    v_mfma_f32_16x16x32_bf16 a[124:127], v[112:115], v[96:99], a[124:127]
    v_mfma_f32_16x16x32_bf16 a[128:131], v[116:119], v[96:99], a[128:131]
    v_mfma_f32_16x16x32_bf16 a[132:135], v[120:123], v[96:99], a[132:135]
    v_mfma_f32_16x16x32_bf16 a[136:139], v[124:127], v[96:99], a[136:139]
    v_mfma_f32_16x16x32_bf16 a[140:143], v[128:131], v[96:99], a[140:143]
    v_mfma_f32_16x16x32_bf16 a[144:147], v[108:111], v[100:103], a[144:147]
    v_mfma_f32_16x16x32_bf16 a[148:151], v[112:115], v[100:103], a[148:151]
    v_mfma_f32_16x16x32_bf16 a[152:155], v[116:119], v[100:103], a[152:155]
    v_mfma_f32_16x16x32_bf16 a[156:159], v[120:123], v[100:103], a[156:159]
    v_mfma_f32_16x16x32_bf16 a[160:163], v[124:127], v[100:103], a[160:163]
    v_mfma_f32_16x16x32_bf16 a[164:167], v[128:131], v[100:103], a[164:167]
    v_mfma_f32_16x16x32_bf16 a[168:171], v[108:111], v[104:107], a[168:171]
    v_mfma_f32_16x16x32_bf16 a[172:175], v[112:115], v[104:107], a[172:175]
    v_mfma_f32_16x16x32_bf16 a[176:179], v[116:119], v[104:107], a[176:179]
    v_mfma_f32_16x16x32_bf16 a[180:183], v[120:123], v[104:107], a[180:183]
    v_mfma_f32_16x16x32_bf16 a[184:187], v[124:127], v[104:107], a[184:187]
    v_mfma_f32_16x16x32_bf16 a[188:191], v[128:131], v[104:107], a[188:191]
    s_waitcnt lgkmcnt(0)
    s_waitcnt vmcnt(14)
    v_mfma_f32_16x16x32_bf16 a[0:3], v[164:167], v[132:135], a[0:3]
    ds_write_b128 v12, v[20:23] offset:0
    v_mfma_f32_16x16x32_bf16 a[4:7], v[168:171], v[132:135], a[4:7]
    ds_write_b128 v12, v[24:27] offset:4608
    v_mfma_f32_16x16x32_bf16 a[8:11], v[172:175], v[132:135], a[8:11]
    ds_write_b128 v12, v[28:31] offset:9216
    v_mfma_f32_16x16x32_bf16 a[12:15], v[176:179], v[132:135], a[12:15]
    ds_write_b128 v12, v[32:35] offset:13824
    v_mfma_f32_16x16x32_bf16 a[16:19], v[180:183], v[132:135], a[16:19]
    ds_write_b128 v12, v[36:39] offset:18432
    v_mfma_f32_16x16x32_bf16 a[20:23], v[184:187], v[132:135], a[20:23]
    ds_write_b128 v12, v[40:43] offset:23040
    v_mfma_f32_16x16x32_bf16 a[24:27], v[164:167], v[136:139], a[24:27]
    ds_write_b128 v12, v[44:47] offset:27648
    v_mfma_f32_16x16x32_bf16 a[28:31], v[168:171], v[136:139], a[28:31]
    ds_write_b128 v12, v[48:51] offset:32256
    v_mfma_f32_16x16x32_bf16 a[32:35], v[172:175], v[136:139], a[32:35]
    ds_write_b128 v14, v[52:55] offset:0
    v_mfma_f32_16x16x32_bf16 a[36:39], v[176:179], v[136:139], a[36:39]
    ds_write_b128 v14, v[56:59] offset:64
    v_mfma_f32_16x16x32_bf16 a[40:43], v[180:183], v[136:139], a[40:43]
    ds_write_b128 v14, v[60:63] offset:128
    v_mfma_f32_16x16x32_bf16 a[44:47], v[184:187], v[136:139], a[44:47]
    ds_write_b128 v14, v[64:67] offset:192
    v_mfma_f32_16x16x32_bf16 a[48:51], v[164:167], v[140:143], a[48:51]
    ds_write_b128 v14, v[68:71] offset:256
    v_mfma_f32_16x16x32_bf16 a[52:55], v[168:171], v[140:143], a[52:55]
    ds_write_b128 v14, v[72:75] offset:320
    v_mfma_f32_16x16x32_bf16 a[56:59], v[172:175], v[140:143], a[56:59]
    v_mfma_f32_16x16x32_bf16 a[60:63], v[176:179], v[140:143], a[60:63]
    s_waitcnt lgkmcnt(0)
    s_barrier
    v_mfma_f32_16x16x32_bf16 a[64:67], v[180:183], v[140:143], a[64:67]
    ds_read_b64_tr_b16 v[108:109], v18 offset:0
    ds_read_b64_tr_b16 v[110:111], v18 offset:6656
    v_mfma_f32_16x16x32_bf16 a[68:71], v[184:187], v[140:143], a[68:71]
    buffer_load_dwordx4 v[20:23], v2, s[8:11], s20 offen
    ds_read_b64_tr_b16 v[112:113], v18 offset:32
    v_mfma_f32_16x16x32_bf16 a[72:75], v[164:167], v[144:147], a[72:75]
    ds_read_b64_tr_b16 v[114:115], v18 offset:6688
    buffer_load_dwordx4 v[24:27], v3, s[8:11], s20 offen
    v_mfma_f32_16x16x32_bf16 a[76:79], v[168:171], v[144:147], a[76:79]
    ds_read_b64_tr_b16 v[116:117], v18 offset:64
    ds_read_b64_tr_b16 v[118:119], v18 offset:6720
    v_mfma_f32_16x16x32_bf16 a[80:83], v[172:175], v[144:147], a[80:83]
    buffer_load_dwordx4 v[28:31], v4, s[8:11], s20 offen
    ds_read_b64_tr_b16 v[120:121], v18 offset:192
    v_mfma_f32_16x16x32_bf16 a[84:87], v[176:179], v[144:147], a[84:87]
    ds_read_b64_tr_b16 v[122:123], v18 offset:6848
    buffer_load_dwordx4 v[32:35], v5, s[8:11], s20 offen
    v_mfma_f32_16x16x32_bf16 a[88:91], v[180:183], v[144:147], a[88:91]
    ds_read_b64_tr_b16 v[124:125], v18 offset:224
    ds_read_b64_tr_b16 v[126:127], v18 offset:6880
    v_mfma_f32_16x16x32_bf16 a[92:95], v[184:187], v[144:147], a[92:95]
    buffer_load_dwordx4 v[36:39], v6, s[8:11], s20 offen
    ds_read_b64_tr_b16 v[128:129], v18 offset:256
    v_mfma_f32_16x16x32_bf16 a[96:99], v[164:167], v[148:151], a[96:99]
    ds_read_b64_tr_b16 v[130:131], v18 offset:6912
    buffer_load_dwordx4 v[40:43], v7, s[8:11], s20 offen
    v_mfma_f32_16x16x32_bf16 a[100:103], v[168:171], v[148:151], a[100:103]
    ds_read_b64 v[76:77], v16 offset:0
    ds_read_b64 v[78:79], v16 offset:32
    v_mfma_f32_16x16x32_bf16 a[104:107], v[172:175], v[148:151], a[104:107]
    buffer_load_dwordx4 v[44:47], v8, s[8:11], s20 offen
    ds_read_b64 v[80:81], v16 offset:2304
    v_mfma_f32_16x16x32_bf16 a[108:111], v[176:179], v[148:151], a[108:111]
    ds_read_b64 v[82:83], v16 offset:2336
    buffer_load_dwordx4 v[48:51], v9, s[8:11], s20 offen
    v_mfma_f32_16x16x32_bf16 a[112:115], v[180:183], v[148:151], a[112:115]
    ds_read_b64 v[84:85], v16 offset:4608
    ds_read_b64 v[86:87], v16 offset:4640
    v_mfma_f32_16x16x32_bf16 a[116:119], v[184:187], v[148:151], a[116:119]
    buffer_load_dwordx4 v[52:55], v10, s[12:15], s21 offen offset:0
    ds_read_b64 v[88:89], v16 offset:6912
    v_mfma_f32_16x16x32_bf16 a[120:123], v[164:167], v[152:155], a[120:123]
    ds_read_b64 v[90:91], v16 offset:6944
    buffer_load_dwordx4 v[56:59], v10, s[12:15], s21 offen offset:64
    v_mfma_f32_16x16x32_bf16 a[124:127], v[168:171], v[152:155], a[124:127]
    ds_read_b64 v[92:93], v16 offset:9216
    ds_read_b64 v[94:95], v16 offset:9248
    v_mfma_f32_16x16x32_bf16 a[128:131], v[172:175], v[152:155], a[128:131]
    buffer_load_dwordx4 v[60:63], v10, s[12:15], s21 offen offset:128
    ds_read_b64 v[96:97], v16 offset:11520
    v_mfma_f32_16x16x32_bf16 a[132:135], v[176:179], v[152:155], a[132:135]
    ds_read_b64 v[98:99], v16 offset:11552
    buffer_load_dwordx4 v[64:67], v10, s[28:31], s21 offen offset:0
    v_mfma_f32_16x16x32_bf16 a[136:139], v[180:183], v[152:155], a[136:139]
    ds_read_b64 v[100:101], v16 offset:13824
    ds_read_b64 v[102:103], v16 offset:13856
    v_mfma_f32_16x16x32_bf16 a[140:143], v[184:187], v[152:155], a[140:143]
    buffer_load_dwordx4 v[68:71], v10, s[28:31], s21 offen offset:64
    ds_read_b64 v[104:105], v16 offset:16128
    v_mfma_f32_16x16x32_bf16 a[144:147], v[164:167], v[156:159], a[144:147]
    ds_read_b64 v[106:107], v16 offset:16160
    buffer_load_dwordx4 v[72:75], v10, s[28:31], s21 offen offset:128
    v_mfma_f32_16x16x32_bf16 a[148:151], v[168:171], v[156:159], a[148:151]
    v_mfma_f32_16x16x32_bf16 a[152:155], v[172:175], v[156:159], a[152:155]
    v_mfma_f32_16x16x32_bf16 a[156:159], v[176:179], v[156:159], a[156:159]
    v_mfma_f32_16x16x32_bf16 a[160:163], v[180:183], v[156:159], a[160:163]
    v_mfma_f32_16x16x32_bf16 a[164:167], v[184:187], v[156:159], a[164:167]
    v_mfma_f32_16x16x32_bf16 a[168:171], v[164:167], v[160:163], a[168:171]
    v_mfma_f32_16x16x32_bf16 a[172:175], v[168:171], v[160:163], a[172:175]
    v_mfma_f32_16x16x32_bf16 a[176:179], v[172:175], v[160:163], a[176:179]
    v_mfma_f32_16x16x32_bf16 a[180:183], v[176:179], v[160:163], a[180:183]
    v_mfma_f32_16x16x32_bf16 a[184:187], v[180:183], v[160:163], a[184:187]
    v_mfma_f32_16x16x32_bf16 a[188:191], v[184:187], v[160:163], a[188:191]
    s_add_u32 s20, s20, 128
    s_add_u32 s21, s21, 196608
    s_sub_u32 s22, s22, 1
    s_cmp_eq_u32 s22, 0
    s_waitcnt lgkmcnt(0)
    s_cbranch_scc0 mglu_loop
mglu_done:
    s_waitcnt vmcnt(0)
    s_nop 7
    s_cmp_lg_u32 s61, 0
    s_cbranch_scc1 if_skip_15
    s_mov_b64 exec, 1
    v_accvgpr_write_b32 a255, 1
    v_mov_b32 v3, 0
    s_nop 1
    buffer_atomic_add a255, v3, s[56:59], s75 offen sc0 sc1
    s_mov_b64 exec, -1
if_skip_15:
    v_and_b32 v60, 15, v0
    v_bfe_u32 v61, v0, 4, 2
    v_lshrrev_b32 v62, 7, v0
    v_bfe_u32 v63, v0, 6, 1
    v_lshl_add_u32 v64, v62, 7, v60
    s_mov_b32 s24, 3072
    v_mul_lo_u32 v64, v64, s24
    v_mul_u32_u24 v65, 96, v63
    v_add_u32 v66, v64, v65
    v_lshl_add_u32 v60, v61, 4, v66
    v_lshl_add_u32 v67, v61, 3, v66
    v_accvgpr_read_b32 v148, a0
    v_accvgpr_read_b32 v152, a12
    v_accvgpr_read_b32 v149, a1
    v_accvgpr_read_b32 v153, a13
    v_accvgpr_read_b32 v150, a2
    v_accvgpr_read_b32 v154, a14
    v_accvgpr_read_b32 v151, a3
    v_accvgpr_read_b32 v155, a15
    v_cvt_pk_bf16_f32 v156, v148, v149
    v_cvt_pk_bf16_f32 v157, v150, v151
    v_cvt_pk_bf16_f32 v158, v152, v153
    v_cvt_pk_bf16_f32 v159, v154, v155
    v_lshlrev_b32 v148, 16, v156
    v_and_b32 v149, 0xffff0000, v156
    v_lshlrev_b32 v152, 16, v158
    v_and_b32 v153, 0xffff0000, v158
    v_lshlrev_b32 v150, 16, v157
    v_and_b32 v151, 0xffff0000, v157
    v_lshlrev_b32 v154, 16, v159
    v_and_b32 v155, 0xffff0000, v159
    v_cmp_lt_f32 vcc, 0, v148
    s_nop 1
    v_cndmask_b32 v156, 0, 1.0, vcc
    v_mul_f32 v148, v148, v156
    v_mul_f32 v148, v148, v152
    v_cmp_lt_f32 vcc, 0, v149
    s_nop 1
    v_cndmask_b32 v156, 0, 1.0, vcc
    v_mul_f32 v149, v149, v156
    v_mul_f32 v149, v149, v153
    v_cmp_lt_f32 vcc, 0, v150
    s_nop 1
    v_cndmask_b32 v156, 0, 1.0, vcc
    v_mul_f32 v150, v150, v156
    v_mul_f32 v150, v150, v154
    v_cmp_lt_f32 vcc, 0, v151
    s_nop 1
    v_cndmask_b32 v156, 0, 1.0, vcc
    v_mul_f32 v151, v151, v156
    v_mul_f32 v151, v151, v155
    v_cvt_pk_bf16_f32 v76, v148, v149
    v_cvt_pk_bf16_f32 v77, v150, v151
    v_accvgpr_read_b32 v148, a4
    v_accvgpr_read_b32 v152, a16
    v_accvgpr_read_b32 v149, a5
    v_accvgpr_read_b32 v153, a17
    v_accvgpr_read_b32 v150, a6
    v_accvgpr_read_b32 v154, a18
    v_accvgpr_read_b32 v151, a7
    v_accvgpr_read_b32 v155, a19
    v_cvt_pk_bf16_f32 v156, v148, v149
    v_cvt_pk_bf16_f32 v157, v150, v151
    v_cvt_pk_bf16_f32 v158, v152, v153
    v_cvt_pk_bf16_f32 v159, v154, v155
    v_lshlrev_b32 v148, 16, v156
    v_and_b32 v149, 0xffff0000, v156
    v_lshlrev_b32 v152, 16, v158
    v_and_b32 v153, 0xffff0000, v158
    v_lshlrev_b32 v150, 16, v157
    v_and_b32 v151, 0xffff0000, v157
    v_lshlrev_b32 v154, 16, v159
    v_and_b32 v155, 0xffff0000, v159
    v_cmp_lt_f32 vcc, 0, v148
    s_nop 1
    v_cndmask_b32 v156, 0, 1.0, vcc
    v_mul_f32 v148, v148, v156
    v_mul_f32 v148, v148, v152
    v_cmp_lt_f32 vcc, 0, v149
    s_nop 1
    v_cndmask_b32 v156, 0, 1.0, vcc
    v_mul_f32 v149, v149, v156
    v_mul_f32 v149, v149, v153
    v_cmp_lt_f32 vcc, 0, v150
    s_nop 1
    v_cndmask_b32 v156, 0, 1.0, vcc
    v_mul_f32 v150, v150, v156
    v_mul_f32 v150, v150, v154
    v_cmp_lt_f32 vcc, 0, v151
    s_nop 1
    v_cndmask_b32 v156, 0, 1.0, vcc
    v_mul_f32 v151, v151, v156
    v_mul_f32 v151, v151, v155
    v_cvt_pk_bf16_f32 v78, v148, v149
    v_cvt_pk_bf16_f32 v79, v150, v151
    v_accvgpr_read_b32 v148, a8
    v_accvgpr_read_b32 v152, a20
    v_accvgpr_read_b32 v149, a9
    v_accvgpr_read_b32 v153, a21
    v_accvgpr_read_b32 v150, a10
    v_accvgpr_read_b32 v154, a22
    v_accvgpr_read_b32 v151, a11
    v_accvgpr_read_b32 v155, a23
    v_cvt_pk_bf16_f32 v156, v148, v149
    v_cvt_pk_bf16_f32 v157, v150, v151
    v_cvt_pk_bf16_f32 v158, v152, v153
    v_cvt_pk_bf16_f32 v159, v154, v155
    v_lshlrev_b32 v148, 16, v156
    v_and_b32 v149, 0xffff0000, v156
    v_lshlrev_b32 v152, 16, v158
    v_and_b32 v153, 0xffff0000, v158
    v_lshlrev_b32 v150, 16, v157
    v_and_b32 v151, 0xffff0000, v157
    v_lshlrev_b32 v154, 16, v159
    v_and_b32 v155, 0xffff0000, v159
    v_cmp_lt_f32 vcc, 0, v148
    s_nop 1
    v_cndmask_b32 v156, 0, 1.0, vcc
    v_mul_f32 v148, v148, v156
    v_mul_f32 v148, v148, v152
    v_cmp_lt_f32 vcc, 0, v149
    s_nop 1
    v_cndmask_b32 v156, 0, 1.0, vcc
    v_mul_f32 v149, v149, v156
    v_mul_f32 v149, v149, v153
    v_cmp_lt_f32 vcc, 0, v150
    s_nop 1
    v_cndmask_b32 v156, 0, 1.0, vcc
    v_mul_f32 v150, v150, v156
    v_mul_f32 v150, v150, v154
    v_cmp_lt_f32 vcc, 0, v151
    s_nop 1
    v_cndmask_b32 v156, 0, 1.0, vcc
    v_mul_f32 v151, v151, v156
    v_mul_f32 v151, v151, v155
    v_cvt_pk_bf16_f32 v80, v148, v149
    v_cvt_pk_bf16_f32 v81, v150, v151
    s_nop 1
    v_permlane32_swap_b32 v76, v78
    v_permlane32_swap_b32 v77, v79
    s_nop 1
    v_permlane16_swap_b32 v76, v78
    v_permlane16_swap_b32 v77, v79
    buffer_store_dwordx4 v[76:79], v60, s[16:19], s23 offen sc1
    buffer_store_dwordx2 v[80:81], v67, s[16:19], s23 offen offset:64 sc1
    v_add_u32 v60, 49152, v60
    v_add_u32 v67, 49152, v67
    v_accvgpr_read_b32 v148, a24
    v_accvgpr_read_b32 v152, a36
    v_accvgpr_read_b32 v149, a25
    v_accvgpr_read_b32 v153, a37
    v_accvgpr_read_b32 v150, a26
    v_accvgpr_read_b32 v154, a38
    v_accvgpr_read_b32 v151, a27
    v_accvgpr_read_b32 v155, a39
    v_cvt_pk_bf16_f32 v156, v148, v149
    v_cvt_pk_bf16_f32 v157, v150, v151
    v_cvt_pk_bf16_f32 v158, v152, v153
    v_cvt_pk_bf16_f32 v159, v154, v155
    v_lshlrev_b32 v148, 16, v156
    v_and_b32 v149, 0xffff0000, v156
    v_lshlrev_b32 v152, 16, v158
    v_and_b32 v153, 0xffff0000, v158
    v_lshlrev_b32 v150, 16, v157
    v_and_b32 v151, 0xffff0000, v157
    v_lshlrev_b32 v154, 16, v159
    v_and_b32 v155, 0xffff0000, v159
    v_cmp_lt_f32 vcc, 0, v148
    s_nop 1
    v_cndmask_b32 v156, 0, 1.0, vcc
    v_mul_f32 v148, v148, v156
    v_mul_f32 v148, v148, v152
    v_cmp_lt_f32 vcc, 0, v149
    s_nop 1
    v_cndmask_b32 v156, 0, 1.0, vcc
    v_mul_f32 v149, v149, v156
    v_mul_f32 v149, v149, v153
    v_cmp_lt_f32 vcc, 0, v150
    s_nop 1
    v_cndmask_b32 v156, 0, 1.0, vcc
    v_mul_f32 v150, v150, v156
    v_mul_f32 v150, v150, v154
    v_cmp_lt_f32 vcc, 0, v151
    s_nop 1
    v_cndmask_b32 v156, 0, 1.0, vcc
    v_mul_f32 v151, v151, v156
    v_mul_f32 v151, v151, v155
    v_cvt_pk_bf16_f32 v84, v148, v149
    v_cvt_pk_bf16_f32 v85, v150, v151
    v_accvgpr_read_b32 v148, a28
    v_accvgpr_read_b32 v152, a40
    v_accvgpr_read_b32 v149, a29
    v_accvgpr_read_b32 v153, a41
    v_accvgpr_read_b32 v150, a30
    v_accvgpr_read_b32 v154, a42
    v_accvgpr_read_b32 v151, a31
    v_accvgpr_read_b32 v155, a43
    v_cvt_pk_bf16_f32 v156, v148, v149
    v_cvt_pk_bf16_f32 v157, v150, v151
    v_cvt_pk_bf16_f32 v158, v152, v153
    v_cvt_pk_bf16_f32 v159, v154, v155
    v_lshlrev_b32 v148, 16, v156
    v_and_b32 v149, 0xffff0000, v156
    v_lshlrev_b32 v152, 16, v158
    v_and_b32 v153, 0xffff0000, v158
    v_lshlrev_b32 v150, 16, v157
    v_and_b32 v151, 0xffff0000, v157
    v_lshlrev_b32 v154, 16, v159
    v_and_b32 v155, 0xffff0000, v159
    v_cmp_lt_f32 vcc, 0, v148
    s_nop 1
    v_cndmask_b32 v156, 0, 1.0, vcc
    v_mul_f32 v148, v148, v156
    v_mul_f32 v148, v148, v152
    v_cmp_lt_f32 vcc, 0, v149
    s_nop 1
    v_cndmask_b32 v156, 0, 1.0, vcc
    v_mul_f32 v149, v149, v156
    v_mul_f32 v149, v149, v153
    v_cmp_lt_f32 vcc, 0, v150
    s_nop 1
    v_cndmask_b32 v156, 0, 1.0, vcc
    v_mul_f32 v150, v150, v156
    v_mul_f32 v150, v150, v154
    v_cmp_lt_f32 vcc, 0, v151
    s_nop 1
    v_cndmask_b32 v156, 0, 1.0, vcc
    v_mul_f32 v151, v151, v156
    v_mul_f32 v151, v151, v155
    v_cvt_pk_bf16_f32 v86, v148, v149
    v_cvt_pk_bf16_f32 v87, v150, v151
    v_accvgpr_read_b32 v148, a32
    v_accvgpr_read_b32 v152, a44
    v_accvgpr_read_b32 v149, a33
    v_accvgpr_read_b32 v153, a45
    v_accvgpr_read_b32 v150, a34
    v_accvgpr_read_b32 v154, a46
    v_accvgpr_read_b32 v151, a35
    v_accvgpr_read_b32 v155, a47
    v_cvt_pk_bf16_f32 v156, v148, v149
    v_cvt_pk_bf16_f32 v157, v150, v151
    v_cvt_pk_bf16_f32 v158, v152, v153
    v_cvt_pk_bf16_f32 v159, v154, v155
    v_lshlrev_b32 v148, 16, v156
    v_and_b32 v149, 0xffff0000, v156
    v_lshlrev_b32 v152, 16, v158
    v_and_b32 v153, 0xffff0000, v158
    v_lshlrev_b32 v150, 16, v157
    v_and_b32 v151, 0xffff0000, v157
    v_lshlrev_b32 v154, 16, v159
    v_and_b32 v155, 0xffff0000, v159
    v_cmp_lt_f32 vcc, 0, v148
    s_nop 1
    v_cndmask_b32 v156, 0, 1.0, vcc
    v_mul_f32 v148, v148, v156
    v_mul_f32 v148, v148, v152
    v_cmp_lt_f32 vcc, 0, v149
    s_nop 1
    v_cndmask_b32 v156, 0, 1.0, vcc
    v_mul_f32 v149, v149, v156
    v_mul_f32 v149, v149, v153
    v_cmp_lt_f32 vcc, 0, v150
    s_nop 1
    v_cndmask_b32 v156, 0, 1.0, vcc
    v_mul_f32 v150, v150, v156
    v_mul_f32 v150, v150, v154
    v_cmp_lt_f32 vcc, 0, v151
    s_nop 1
    v_cndmask_b32 v156, 0, 1.0, vcc
    v_mul_f32 v151, v151, v156
    v_mul_f32 v151, v151, v155
    v_cvt_pk_bf16_f32 v88, v148, v149
    v_cvt_pk_bf16_f32 v89, v150, v151
    s_nop 1
    v_permlane32_swap_b32 v84, v86
    v_permlane32_swap_b32 v85, v87
    s_nop 1
    v_permlane16_swap_b32 v84, v86
    v_permlane16_swap_b32 v85, v87
    buffer_store_dwordx4 v[84:87], v60, s[16:19], s23 offen sc1
    buffer_store_dwordx2 v[88:89], v67, s[16:19], s23 offen offset:64 sc1
    v_add_u32 v60, 49152, v60
    v_add_u32 v67, 49152, v67
    v_accvgpr_read_b32 v148, a48
    v_accvgpr_read_b32 v152, a60
    v_accvgpr_read_b32 v149, a49
    v_accvgpr_read_b32 v153, a61
    v_accvgpr_read_b32 v150, a50
    v_accvgpr_read_b32 v154, a62
    v_accvgpr_read_b32 v151, a51
    v_accvgpr_read_b32 v155, a63
    v_cvt_pk_bf16_f32 v156, v148, v149
    v_cvt_pk_bf16_f32 v157, v150, v151
    v_cvt_pk_bf16_f32 v158, v152, v153
    v_cvt_pk_bf16_f32 v159, v154, v155
    v_lshlrev_b32 v148, 16, v156
    v_and_b32 v149, 0xffff0000, v156
    v_lshlrev_b32 v152, 16, v158
    v_and_b32 v153, 0xffff0000, v158
    v_lshlrev_b32 v150, 16, v157
    v_and_b32 v151, 0xffff0000, v157
    v_lshlrev_b32 v154, 16, v159
    v_and_b32 v155, 0xffff0000, v159
    v_cmp_lt_f32 vcc, 0, v148
    s_nop 1
    v_cndmask_b32 v156, 0, 1.0, vcc
    v_mul_f32 v148, v148, v156
    v_mul_f32 v148, v148, v152
    v_cmp_lt_f32 vcc, 0, v149
    s_nop 1
    v_cndmask_b32 v156, 0, 1.0, vcc
    v_mul_f32 v149, v149, v156
    v_mul_f32 v149, v149, v153
    v_cmp_lt_f32 vcc, 0, v150
    s_nop 1
    v_cndmask_b32 v156, 0, 1.0, vcc
    v_mul_f32 v150, v150, v156
    v_mul_f32 v150, v150, v154
    v_cmp_lt_f32 vcc, 0, v151
    s_nop 1
    v_cndmask_b32 v156, 0, 1.0, vcc
    v_mul_f32 v151, v151, v156
    v_mul_f32 v151, v151, v155
    v_cvt_pk_bf16_f32 v92, v148, v149
    v_cvt_pk_bf16_f32 v93, v150, v151
    v_accvgpr_read_b32 v148, a52
    v_accvgpr_read_b32 v152, a64
    v_accvgpr_read_b32 v149, a53
    v_accvgpr_read_b32 v153, a65
    v_accvgpr_read_b32 v150, a54
    v_accvgpr_read_b32 v154, a66
    v_accvgpr_read_b32 v151, a55
    v_accvgpr_read_b32 v155, a67
    v_cvt_pk_bf16_f32 v156, v148, v149
    v_cvt_pk_bf16_f32 v157, v150, v151
    v_cvt_pk_bf16_f32 v158, v152, v153
    v_cvt_pk_bf16_f32 v159, v154, v155
    v_lshlrev_b32 v148, 16, v156
    v_and_b32 v149, 0xffff0000, v156
    v_lshlrev_b32 v152, 16, v158
    v_and_b32 v153, 0xffff0000, v158
    v_lshlrev_b32 v150, 16, v157
    v_and_b32 v151, 0xffff0000, v157
    v_lshlrev_b32 v154, 16, v159
    v_and_b32 v155, 0xffff0000, v159
    v_cmp_lt_f32 vcc, 0, v148
    s_nop 1
    v_cndmask_b32 v156, 0, 1.0, vcc
    v_mul_f32 v148, v148, v156
    v_mul_f32 v148, v148, v152
    v_cmp_lt_f32 vcc, 0, v149
    s_nop 1
    v_cndmask_b32 v156, 0, 1.0, vcc
    v_mul_f32 v149, v149, v156
    v_mul_f32 v149, v149, v153
    v_cmp_lt_f32 vcc, 0, v150
    s_nop 1
    v_cndmask_b32 v156, 0, 1.0, vcc
    v_mul_f32 v150, v150, v156
    v_mul_f32 v150, v150, v154
    v_cmp_lt_f32 vcc, 0, v151
    s_nop 1
    v_cndmask_b32 v156, 0, 1.0, vcc
    v_mul_f32 v151, v151, v156
    v_mul_f32 v151, v151, v155
    v_cvt_pk_bf16_f32 v94, v148, v149
    v_cvt_pk_bf16_f32 v95, v150, v151
    v_accvgpr_read_b32 v148, a56
    v_accvgpr_read_b32 v152, a68
    v_accvgpr_read_b32 v149, a57
    v_accvgpr_read_b32 v153, a69
    v_accvgpr_read_b32 v150, a58
    v_accvgpr_read_b32 v154, a70
    v_accvgpr_read_b32 v151, a59
    v_accvgpr_read_b32 v155, a71
    v_cvt_pk_bf16_f32 v156, v148, v149
    v_cvt_pk_bf16_f32 v157, v150, v151
    v_cvt_pk_bf16_f32 v158, v152, v153
    v_cvt_pk_bf16_f32 v159, v154, v155
    v_lshlrev_b32 v148, 16, v156
    v_and_b32 v149, 0xffff0000, v156
    v_lshlrev_b32 v152, 16, v158
    v_and_b32 v153, 0xffff0000, v158
    v_lshlrev_b32 v150, 16, v157
    v_and_b32 v151, 0xffff0000, v157
    v_lshlrev_b32 v154, 16, v159
    v_and_b32 v155, 0xffff0000, v159
    v_cmp_lt_f32 vcc, 0, v148
    s_nop 1
    v_cndmask_b32 v156, 0, 1.0, vcc
    v_mul_f32 v148, v148, v156
    v_mul_f32 v148, v148, v152
    v_cmp_lt_f32 vcc, 0, v149
    s_nop 1
    v_cndmask_b32 v156, 0, 1.0, vcc
    v_mul_f32 v149, v149, v156
    v_mul_f32 v149, v149, v153
    v_cmp_lt_f32 vcc, 0, v150
    s_nop 1
    v_cndmask_b32 v156, 0, 1.0, vcc
    v_mul_f32 v150, v150, v156
    v_mul_f32 v150, v150, v154
    v_cmp_lt_f32 vcc, 0, v151
    s_nop 1
    v_cndmask_b32 v156, 0, 1.0, vcc
    v_mul_f32 v151, v151, v156
    v_mul_f32 v151, v151, v155
    v_cvt_pk_bf16_f32 v96, v148, v149
    v_cvt_pk_bf16_f32 v97, v150, v151
    s_nop 1
    v_permlane32_swap_b32 v92, v94
    v_permlane32_swap_b32 v93, v95
    s_nop 1
    v_permlane16_swap_b32 v92, v94
    v_permlane16_swap_b32 v93, v95
    buffer_store_dwordx4 v[92:95], v60, s[16:19], s23 offen sc1
    buffer_store_dwordx2 v[96:97], v67, s[16:19], s23 offen offset:64 sc1
    v_add_u32 v60, 49152, v60
    v_add_u32 v67, 49152, v67
    v_accvgpr_read_b32 v148, a72
    v_accvgpr_read_b32 v152, a84
    v_accvgpr_read_b32 v149, a73
    v_accvgpr_read_b32 v153, a85
    v_accvgpr_read_b32 v150, a74
    v_accvgpr_read_b32 v154, a86
    v_accvgpr_read_b32 v151, a75
    v_accvgpr_read_b32 v155, a87
    v_cvt_pk_bf16_f32 v156, v148, v149
    v_cvt_pk_bf16_f32 v157, v150, v151
    v_cvt_pk_bf16_f32 v158, v152, v153
    v_cvt_pk_bf16_f32 v159, v154, v155
    v_lshlrev_b32 v148, 16, v156
    v_and_b32 v149, 0xffff0000, v156
    v_lshlrev_b32 v152, 16, v158
    v_and_b32 v153, 0xffff0000, v158
    v_lshlrev_b32 v150, 16, v157
    v_and_b32 v151, 0xffff0000, v157
    v_lshlrev_b32 v154, 16, v159
    v_and_b32 v155, 0xffff0000, v159
    v_cmp_lt_f32 vcc, 0, v148
    s_nop 1
    v_cndmask_b32 v156, 0, 1.0, vcc
    v_mul_f32 v148, v148, v156
    v_mul_f32 v148, v148, v152
    v_cmp_lt_f32 vcc, 0, v149
    s_nop 1
    v_cndmask_b32 v156, 0, 1.0, vcc
    v_mul_f32 v149, v149, v156
    v_mul_f32 v149, v149, v153
    v_cmp_lt_f32 vcc, 0, v150
    s_nop 1
    v_cndmask_b32 v156, 0, 1.0, vcc
    v_mul_f32 v150, v150, v156
    v_mul_f32 v150, v150, v154
    v_cmp_lt_f32 vcc, 0, v151
    s_nop 1
    v_cndmask_b32 v156, 0, 1.0, vcc
    v_mul_f32 v151, v151, v156
    v_mul_f32 v151, v151, v155
    v_cvt_pk_bf16_f32 v100, v148, v149
    v_cvt_pk_bf16_f32 v101, v150, v151
    v_accvgpr_read_b32 v148, a76
    v_accvgpr_read_b32 v152, a88
    v_accvgpr_read_b32 v149, a77
    v_accvgpr_read_b32 v153, a89
    v_accvgpr_read_b32 v150, a78
    v_accvgpr_read_b32 v154, a90
    v_accvgpr_read_b32 v151, a79
    v_accvgpr_read_b32 v155, a91
    v_cvt_pk_bf16_f32 v156, v148, v149
    v_cvt_pk_bf16_f32 v157, v150, v151
    v_cvt_pk_bf16_f32 v158, v152, v153
    v_cvt_pk_bf16_f32 v159, v154, v155
    v_lshlrev_b32 v148, 16, v156
    v_and_b32 v149, 0xffff0000, v156
    v_lshlrev_b32 v152, 16, v158
    v_and_b32 v153, 0xffff0000, v158
    v_lshlrev_b32 v150, 16, v157
    v_and_b32 v151, 0xffff0000, v157
    v_lshlrev_b32 v154, 16, v159
    v_and_b32 v155, 0xffff0000, v159
    v_cmp_lt_f32 vcc, 0, v148
    s_nop 1
    v_cndmask_b32 v156, 0, 1.0, vcc
    v_mul_f32 v148, v148, v156
    v_mul_f32 v148, v148, v152
    v_cmp_lt_f32 vcc, 0, v149
    s_nop 1
    v_cndmask_b32 v156, 0, 1.0, vcc
    v_mul_f32 v149, v149, v156
    v_mul_f32 v149, v149, v153
    v_cmp_lt_f32 vcc, 0, v150
    s_nop 1
    v_cndmask_b32 v156, 0, 1.0, vcc
    v_mul_f32 v150, v150, v156
    v_mul_f32 v150, v150, v154
    v_cmp_lt_f32 vcc, 0, v151
    s_nop 1
    v_cndmask_b32 v156, 0, 1.0, vcc
    v_mul_f32 v151, v151, v156
    v_mul_f32 v151, v151, v155
    v_cvt_pk_bf16_f32 v102, v148, v149
    v_cvt_pk_bf16_f32 v103, v150, v151
    v_accvgpr_read_b32 v148, a80
    v_accvgpr_read_b32 v152, a92
    v_accvgpr_read_b32 v149, a81
    v_accvgpr_read_b32 v153, a93
    v_accvgpr_read_b32 v150, a82
    v_accvgpr_read_b32 v154, a94
    v_accvgpr_read_b32 v151, a83
    v_accvgpr_read_b32 v155, a95
    v_cvt_pk_bf16_f32 v156, v148, v149
    v_cvt_pk_bf16_f32 v157, v150, v151
    v_cvt_pk_bf16_f32 v158, v152, v153
    v_cvt_pk_bf16_f32 v159, v154, v155
    v_lshlrev_b32 v148, 16, v156
    v_and_b32 v149, 0xffff0000, v156
    v_lshlrev_b32 v152, 16, v158
    v_and_b32 v153, 0xffff0000, v158
    v_lshlrev_b32 v150, 16, v157
    v_and_b32 v151, 0xffff0000, v157
    v_lshlrev_b32 v154, 16, v159
    v_and_b32 v155, 0xffff0000, v159
    v_cmp_lt_f32 vcc, 0, v148
    s_nop 1
    v_cndmask_b32 v156, 0, 1.0, vcc
    v_mul_f32 v148, v148, v156
    v_mul_f32 v148, v148, v152
    v_cmp_lt_f32 vcc, 0, v149
    s_nop 1
    v_cndmask_b32 v156, 0, 1.0, vcc
    v_mul_f32 v149, v149, v156
    v_mul_f32 v149, v149, v153
    v_cmp_lt_f32 vcc, 0, v150
    s_nop 1
    v_cndmask_b32 v156, 0, 1.0, vcc
    v_mul_f32 v150, v150, v156
    v_mul_f32 v150, v150, v154
    v_cmp_lt_f32 vcc, 0, v151
    s_nop 1
    v_cndmask_b32 v156, 0, 1.0, vcc
    v_mul_f32 v151, v151, v156
    v_mul_f32 v151, v151, v155
    v_cvt_pk_bf16_f32 v104, v148, v149
    v_cvt_pk_bf16_f32 v105, v150, v151
    s_nop 1
    v_permlane32_swap_b32 v100, v102
    v_permlane32_swap_b32 v101, v103
    s_nop 1
    v_permlane16_swap_b32 v100, v102
    v_permlane16_swap_b32 v101, v103
    buffer_store_dwordx4 v[100:103], v60, s[16:19], s23 offen sc1
    buffer_store_dwordx2 v[104:105], v67, s[16:19], s23 offen offset:64 sc1
    v_add_u32 v60, 49152, v60
    v_add_u32 v67, 49152, v67
    v_accvgpr_read_b32 v148, a96
    v_accvgpr_read_b32 v152, a108
    v_accvgpr_read_b32 v149, a97
    v_accvgpr_read_b32 v153, a109
    v_accvgpr_read_b32 v150, a98
    v_accvgpr_read_b32 v154, a110
    v_accvgpr_read_b32 v151, a99
    v_accvgpr_read_b32 v155, a111
    v_cvt_pk_bf16_f32 v156, v148, v149
    v_cvt_pk_bf16_f32 v157, v150, v151
    v_cvt_pk_bf16_f32 v158, v152, v153
    v_cvt_pk_bf16_f32 v159, v154, v155
    v_lshlrev_b32 v148, 16, v156
    v_and_b32 v149, 0xffff0000, v156
    v_lshlrev_b32 v152, 16, v158
    v_and_b32 v153, 0xffff0000, v158
    v_lshlrev_b32 v150, 16, v157
    v_and_b32 v151, 0xffff0000, v157
    v_lshlrev_b32 v154, 16, v159
    v_and_b32 v155, 0xffff0000, v159
    v_cmp_lt_f32 vcc, 0, v148
    s_nop 1
    v_cndmask_b32 v156, 0, 1.0, vcc
    v_mul_f32 v148, v148, v156
    v_mul_f32 v148, v148, v152
    v_cmp_lt_f32 vcc, 0, v149
    s_nop 1
    v_cndmask_b32 v156, 0, 1.0, vcc
    v_mul_f32 v149, v149, v156
    v_mul_f32 v149, v149, v153
    v_cmp_lt_f32 vcc, 0, v150
    s_nop 1
    v_cndmask_b32 v156, 0, 1.0, vcc
    v_mul_f32 v150, v150, v156
    v_mul_f32 v150, v150, v154
    v_cmp_lt_f32 vcc, 0, v151
    s_nop 1
    v_cndmask_b32 v156, 0, 1.0, vcc
    v_mul_f32 v151, v151, v156
    v_mul_f32 v151, v151, v155
    v_cvt_pk_bf16_f32 v76, v148, v149
    v_cvt_pk_bf16_f32 v77, v150, v151
    v_accvgpr_read_b32 v148, a100
    v_accvgpr_read_b32 v152, a112
    v_accvgpr_read_b32 v149, a101
    v_accvgpr_read_b32 v153, a113
    v_accvgpr_read_b32 v150, a102
    v_accvgpr_read_b32 v154, a114
    v_accvgpr_read_b32 v151, a103
    v_accvgpr_read_b32 v155, a115
    v_cvt_pk_bf16_f32 v156, v148, v149
    v_cvt_pk_bf16_f32 v157, v150, v151
    v_cvt_pk_bf16_f32 v158, v152, v153
    v_cvt_pk_bf16_f32 v159, v154, v155
    v_lshlrev_b32 v148, 16, v156
    v_and_b32 v149, 0xffff0000, v156
    v_lshlrev_b32 v152, 16, v158
    v_and_b32 v153, 0xffff0000, v158
    v_lshlrev_b32 v150, 16, v157
    v_and_b32 v151, 0xffff0000, v157
    v_lshlrev_b32 v154, 16, v159
    v_and_b32 v155, 0xffff0000, v159
    v_cmp_lt_f32 vcc, 0, v148
    s_nop 1
    v_cndmask_b32 v156, 0, 1.0, vcc
    v_mul_f32 v148, v148, v156
    v_mul_f32 v148, v148, v152
    v_cmp_lt_f32 vcc, 0, v149
    s_nop 1
    v_cndmask_b32 v156, 0, 1.0, vcc
    v_mul_f32 v149, v149, v156
    v_mul_f32 v149, v149, v153
    v_cmp_lt_f32 vcc, 0, v150
    s_nop 1
    v_cndmask_b32 v156, 0, 1.0, vcc
    v_mul_f32 v150, v150, v156
    v_mul_f32 v150, v150, v154
    v_cmp_lt_f32 vcc, 0, v151
    s_nop 1
    v_cndmask_b32 v156, 0, 1.0, vcc
    v_mul_f32 v151, v151, v156
    v_mul_f32 v151, v151, v155
    v_cvt_pk_bf16_f32 v78, v148, v149
    v_cvt_pk_bf16_f32 v79, v150, v151
    v_accvgpr_read_b32 v148, a104
    v_accvgpr_read_b32 v152, a116
    v_accvgpr_read_b32 v149, a105
    v_accvgpr_read_b32 v153, a117
    v_accvgpr_read_b32 v150, a106
    v_accvgpr_read_b32 v154, a118
    v_accvgpr_read_b32 v151, a107
    v_accvgpr_read_b32 v155, a119
    v_cvt_pk_bf16_f32 v156, v148, v149
    v_cvt_pk_bf16_f32 v157, v150, v151
    v_cvt_pk_bf16_f32 v158, v152, v153
    v_cvt_pk_bf16_f32 v159, v154, v155
    v_lshlrev_b32 v148, 16, v156
    v_and_b32 v149, 0xffff0000, v156
    v_lshlrev_b32 v152, 16, v158
    v_and_b32 v153, 0xffff0000, v158
    v_lshlrev_b32 v150, 16, v157
    v_and_b32 v151, 0xffff0000, v157
    v_lshlrev_b32 v154, 16, v159
    v_and_b32 v155, 0xffff0000, v159
    v_cmp_lt_f32 vcc, 0, v148
    s_nop 1
    v_cndmask_b32 v156, 0, 1.0, vcc
    v_mul_f32 v148, v148, v156
    v_mul_f32 v148, v148, v152
    v_cmp_lt_f32 vcc, 0, v149
    s_nop 1
    v_cndmask_b32 v156, 0, 1.0, vcc
    v_mul_f32 v149, v149, v156
    v_mul_f32 v149, v149, v153
    v_cmp_lt_f32 vcc, 0, v150
    s_nop 1
    v_cndmask_b32 v156, 0, 1.0, vcc
    v_mul_f32 v150, v150, v156
    v_mul_f32 v150, v150, v154
    v_cmp_lt_f32 vcc, 0, v151
    s_nop 1
    v_cndmask_b32 v156, 0, 1.0, vcc
    v_mul_f32 v151, v151, v156
    v_mul_f32 v151, v151, v155
    v_cvt_pk_bf16_f32 v80, v148, v149
    v_cvt_pk_bf16_f32 v81, v150, v151
    s_nop 1
    v_permlane32_swap_b32 v76, v78
    v_permlane32_swap_b32 v77, v79
    s_nop 1
    v_permlane16_swap_b32 v76, v78
    v_permlane16_swap_b32 v77, v79
    buffer_store_dwordx4 v[76:79], v60, s[16:19], s23 offen sc1
    buffer_store_dwordx2 v[80:81], v67, s[16:19], s23 offen offset:64 sc1
    v_add_u32 v60, 49152, v60
    v_add_u32 v67, 49152, v67
    v_accvgpr_read_b32 v148, a120
    v_accvgpr_read_b32 v152, a132
    v_accvgpr_read_b32 v149, a121
    v_accvgpr_read_b32 v153, a133
    v_accvgpr_read_b32 v150, a122
    v_accvgpr_read_b32 v154, a134
    v_accvgpr_read_b32 v151, a123
    v_accvgpr_read_b32 v155, a135
    v_cvt_pk_bf16_f32 v156, v148, v149
    v_cvt_pk_bf16_f32 v157, v150, v151
    v_cvt_pk_bf16_f32 v158, v152, v153
    v_cvt_pk_bf16_f32 v159, v154, v155
    v_lshlrev_b32 v148, 16, v156
    v_and_b32 v149, 0xffff0000, v156
    v_lshlrev_b32 v152, 16, v158
    v_and_b32 v153, 0xffff0000, v158
    v_lshlrev_b32 v150, 16, v157
    v_and_b32 v151, 0xffff0000, v157
    v_lshlrev_b32 v154, 16, v159
    v_and_b32 v155, 0xffff0000, v159
    v_cmp_lt_f32 vcc, 0, v148
    s_nop 1
    v_cndmask_b32 v156, 0, 1.0, vcc
    v_mul_f32 v148, v148, v156
    v_mul_f32 v148, v148, v152
    v_cmp_lt_f32 vcc, 0, v149
    s_nop 1
    v_cndmask_b32 v156, 0, 1.0, vcc
    v_mul_f32 v149, v149, v156
    v_mul_f32 v149, v149, v153
    v_cmp_lt_f32 vcc, 0, v150
    s_nop 1
    v_cndmask_b32 v156, 0, 1.0, vcc
    v_mul_f32 v150, v150, v156
    v_mul_f32 v150, v150, v154
    v_cmp_lt_f32 vcc, 0, v151
    s_nop 1
    v_cndmask_b32 v156, 0, 1.0, vcc
    v_mul_f32 v151, v151, v156
    v_mul_f32 v151, v151, v155
    v_cvt_pk_bf16_f32 v84, v148, v149
    v_cvt_pk_bf16_f32 v85, v150, v151
    v_accvgpr_read_b32 v148, a124
    v_accvgpr_read_b32 v152, a136
    v_accvgpr_read_b32 v149, a125
    v_accvgpr_read_b32 v153, a137
    v_accvgpr_read_b32 v150, a126
    v_accvgpr_read_b32 v154, a138
    v_accvgpr_read_b32 v151, a127
    v_accvgpr_read_b32 v155, a139
    v_cvt_pk_bf16_f32 v156, v148, v149
    v_cvt_pk_bf16_f32 v157, v150, v151
    v_cvt_pk_bf16_f32 v158, v152, v153
    v_cvt_pk_bf16_f32 v159, v154, v155
    v_lshlrev_b32 v148, 16, v156
    v_and_b32 v149, 0xffff0000, v156
    v_lshlrev_b32 v152, 16, v158
    v_and_b32 v153, 0xffff0000, v158
    v_lshlrev_b32 v150, 16, v157
    v_and_b32 v151, 0xffff0000, v157
    v_lshlrev_b32 v154, 16, v159
    v_and_b32 v155, 0xffff0000, v159
    v_cmp_lt_f32 vcc, 0, v148
    s_nop 1
    v_cndmask_b32 v156, 0, 1.0, vcc
    v_mul_f32 v148, v148, v156
    v_mul_f32 v148, v148, v152
    v_cmp_lt_f32 vcc, 0, v149
    s_nop 1
    v_cndmask_b32 v156, 0, 1.0, vcc
    v_mul_f32 v149, v149, v156
    v_mul_f32 v149, v149, v153
    v_cmp_lt_f32 vcc, 0, v150
    s_nop 1
    v_cndmask_b32 v156, 0, 1.0, vcc
    v_mul_f32 v150, v150, v156
    v_mul_f32 v150, v150, v154
    v_cmp_lt_f32 vcc, 0, v151
    s_nop 1
    v_cndmask_b32 v156, 0, 1.0, vcc
    v_mul_f32 v151, v151, v156
    v_mul_f32 v151, v151, v155
    v_cvt_pk_bf16_f32 v86, v148, v149
    v_cvt_pk_bf16_f32 v87, v150, v151
    v_accvgpr_read_b32 v148, a128
    v_accvgpr_read_b32 v152, a140
    v_accvgpr_read_b32 v149, a129
    v_accvgpr_read_b32 v153, a141
    v_accvgpr_read_b32 v150, a130
    v_accvgpr_read_b32 v154, a142
    v_accvgpr_read_b32 v151, a131
    v_accvgpr_read_b32 v155, a143
    v_cvt_pk_bf16_f32 v156, v148, v149
    v_cvt_pk_bf16_f32 v157, v150, v151
    v_cvt_pk_bf16_f32 v158, v152, v153
    v_cvt_pk_bf16_f32 v159, v154, v155
    v_lshlrev_b32 v148, 16, v156
    v_and_b32 v149, 0xffff0000, v156
    v_lshlrev_b32 v152, 16, v158
    v_and_b32 v153, 0xffff0000, v158
    v_lshlrev_b32 v150, 16, v157
    v_and_b32 v151, 0xffff0000, v157
    v_lshlrev_b32 v154, 16, v159
    v_and_b32 v155, 0xffff0000, v159
    v_cmp_lt_f32 vcc, 0, v148
    s_nop 1
    v_cndmask_b32 v156, 0, 1.0, vcc
    v_mul_f32 v148, v148, v156
    v_mul_f32 v148, v148, v152
    v_cmp_lt_f32 vcc, 0, v149
    s_nop 1
    v_cndmask_b32 v156, 0, 1.0, vcc
    v_mul_f32 v149, v149, v156
    v_mul_f32 v149, v149, v153
    v_cmp_lt_f32 vcc, 0, v150
    s_nop 1
    v_cndmask_b32 v156, 0, 1.0, vcc
    v_mul_f32 v150, v150, v156
    v_mul_f32 v150, v150, v154
    v_cmp_lt_f32 vcc, 0, v151
    s_nop 1
    v_cndmask_b32 v156, 0, 1.0, vcc
    v_mul_f32 v151, v151, v156
    v_mul_f32 v151, v151, v155
    v_cvt_pk_bf16_f32 v88, v148, v149
    v_cvt_pk_bf16_f32 v89, v150, v151
    s_nop 1
    v_permlane32_swap_b32 v84, v86
    v_permlane32_swap_b32 v85, v87
    s_nop 1
    v_permlane16_swap_b32 v84, v86
    v_permlane16_swap_b32 v85, v87
    buffer_store_dwordx4 v[84:87], v60, s[16:19], s23 offen sc1
    buffer_store_dwordx2 v[88:89], v67, s[16:19], s23 offen offset:64 sc1
    v_add_u32 v60, 49152, v60
    v_add_u32 v67, 49152, v67
    v_accvgpr_read_b32 v148, a144
    v_accvgpr_read_b32 v152, a156
    v_accvgpr_read_b32 v149, a145
    v_accvgpr_read_b32 v153, a157
    v_accvgpr_read_b32 v150, a146
    v_accvgpr_read_b32 v154, a158
    v_accvgpr_read_b32 v151, a147
    v_accvgpr_read_b32 v155, a159
    v_cvt_pk_bf16_f32 v156, v148, v149
    v_cvt_pk_bf16_f32 v157, v150, v151
    v_cvt_pk_bf16_f32 v158, v152, v153
    v_cvt_pk_bf16_f32 v159, v154, v155
    v_lshlrev_b32 v148, 16, v156
    v_and_b32 v149, 0xffff0000, v156
    v_lshlrev_b32 v152, 16, v158
    v_and_b32 v153, 0xffff0000, v158
    v_lshlrev_b32 v150, 16, v157
    v_and_b32 v151, 0xffff0000, v157
    v_lshlrev_b32 v154, 16, v159
    v_and_b32 v155, 0xffff0000, v159
    v_cmp_lt_f32 vcc, 0, v148
    s_nop 1
    v_cndmask_b32 v156, 0, 1.0, vcc
    v_mul_f32 v148, v148, v156
    v_mul_f32 v148, v148, v152
    v_cmp_lt_f32 vcc, 0, v149
    s_nop 1
    v_cndmask_b32 v156, 0, 1.0, vcc
    v_mul_f32 v149, v149, v156
    v_mul_f32 v149, v149, v153
    v_cmp_lt_f32 vcc, 0, v150
    s_nop 1
    v_cndmask_b32 v156, 0, 1.0, vcc
    v_mul_f32 v150, v150, v156
    v_mul_f32 v150, v150, v154
    v_cmp_lt_f32 vcc, 0, v151
    s_nop 1
    v_cndmask_b32 v156, 0, 1.0, vcc
    v_mul_f32 v151, v151, v156
    v_mul_f32 v151, v151, v155
    v_cvt_pk_bf16_f32 v92, v148, v149
    v_cvt_pk_bf16_f32 v93, v150, v151
    v_accvgpr_read_b32 v148, a148
    v_accvgpr_read_b32 v152, a160
    v_accvgpr_read_b32 v149, a149
    v_accvgpr_read_b32 v153, a161
    v_accvgpr_read_b32 v150, a150
    v_accvgpr_read_b32 v154, a162
    v_accvgpr_read_b32 v151, a151
    v_accvgpr_read_b32 v155, a163
    v_cvt_pk_bf16_f32 v156, v148, v149
    v_cvt_pk_bf16_f32 v157, v150, v151
    v_cvt_pk_bf16_f32 v158, v152, v153
    v_cvt_pk_bf16_f32 v159, v154, v155
    v_lshlrev_b32 v148, 16, v156
    v_and_b32 v149, 0xffff0000, v156
    v_lshlrev_b32 v152, 16, v158
    v_and_b32 v153, 0xffff0000, v158
    v_lshlrev_b32 v150, 16, v157
    v_and_b32 v151, 0xffff0000, v157
    v_lshlrev_b32 v154, 16, v159
    v_and_b32 v155, 0xffff0000, v159
    v_cmp_lt_f32 vcc, 0, v148
    s_nop 1
    v_cndmask_b32 v156, 0, 1.0, vcc
    v_mul_f32 v148, v148, v156
    v_mul_f32 v148, v148, v152
    v_cmp_lt_f32 vcc, 0, v149
    s_nop 1
    v_cndmask_b32 v156, 0, 1.0, vcc
    v_mul_f32 v149, v149, v156
    v_mul_f32 v149, v149, v153
    v_cmp_lt_f32 vcc, 0, v150
    s_nop 1
    v_cndmask_b32 v156, 0, 1.0, vcc
    v_mul_f32 v150, v150, v156
    v_mul_f32 v150, v150, v154
    v_cmp_lt_f32 vcc, 0, v151
    s_nop 1
    v_cndmask_b32 v156, 0, 1.0, vcc
    v_mul_f32 v151, v151, v156
    v_mul_f32 v151, v151, v155
    v_cvt_pk_bf16_f32 v94, v148, v149
    v_cvt_pk_bf16_f32 v95, v150, v151
    v_accvgpr_read_b32 v148, a152
    v_accvgpr_read_b32 v152, a164
    v_accvgpr_read_b32 v149, a153
    v_accvgpr_read_b32 v153, a165
    v_accvgpr_read_b32 v150, a154
    v_accvgpr_read_b32 v154, a166
    v_accvgpr_read_b32 v151, a155
    v_accvgpr_read_b32 v155, a167
    v_cvt_pk_bf16_f32 v156, v148, v149
    v_cvt_pk_bf16_f32 v157, v150, v151
    v_cvt_pk_bf16_f32 v158, v152, v153
    v_cvt_pk_bf16_f32 v159, v154, v155
    v_lshlrev_b32 v148, 16, v156
    v_and_b32 v149, 0xffff0000, v156
    v_lshlrev_b32 v152, 16, v158
    v_and_b32 v153, 0xffff0000, v158
    v_lshlrev_b32 v150, 16, v157
    v_and_b32 v151, 0xffff0000, v157
    v_lshlrev_b32 v154, 16, v159
    v_and_b32 v155, 0xffff0000, v159
    v_cmp_lt_f32 vcc, 0, v148
    s_nop 1
    v_cndmask_b32 v156, 0, 1.0, vcc
    v_mul_f32 v148, v148, v156
    v_mul_f32 v148, v148, v152
    v_cmp_lt_f32 vcc, 0, v149
    s_nop 1
    v_cndmask_b32 v156, 0, 1.0, vcc
    v_mul_f32 v149, v149, v156
    v_mul_f32 v149, v149, v153
    v_cmp_lt_f32 vcc, 0, v150
    s_nop 1
    v_cndmask_b32 v156, 0, 1.0, vcc
    v_mul_f32 v150, v150, v156
    v_mul_f32 v150, v150, v154
    v_cmp_lt_f32 vcc, 0, v151
    s_nop 1
    v_cndmask_b32 v156, 0, 1.0, vcc
    v_mul_f32 v151, v151, v156
    v_mul_f32 v151, v151, v155
    v_cvt_pk_bf16_f32 v96, v148, v149
    v_cvt_pk_bf16_f32 v97, v150, v151
    s_nop 1
    v_permlane32_swap_b32 v92, v94
    v_permlane32_swap_b32 v93, v95
    s_nop 1
    v_permlane16_swap_b32 v92, v94
    v_permlane16_swap_b32 v93, v95
    buffer_store_dwordx4 v[92:95], v60, s[16:19], s23 offen sc1
    buffer_store_dwordx2 v[96:97], v67, s[16:19], s23 offen offset:64 sc1
    v_add_u32 v60, 49152, v60
    v_add_u32 v67, 49152, v67
    v_accvgpr_read_b32 v148, a168
    v_accvgpr_read_b32 v152, a180
    v_accvgpr_read_b32 v149, a169
    v_accvgpr_read_b32 v153, a181
    v_accvgpr_read_b32 v150, a170
    v_accvgpr_read_b32 v154, a182
    v_accvgpr_read_b32 v151, a171
    v_accvgpr_read_b32 v155, a183
    v_cvt_pk_bf16_f32 v156, v148, v149
    v_cvt_pk_bf16_f32 v157, v150, v151
    v_cvt_pk_bf16_f32 v158, v152, v153
    v_cvt_pk_bf16_f32 v159, v154, v155
    v_lshlrev_b32 v148, 16, v156
    v_and_b32 v149, 0xffff0000, v156
    v_lshlrev_b32 v152, 16, v158
    v_and_b32 v153, 0xffff0000, v158
    v_lshlrev_b32 v150, 16, v157
    v_and_b32 v151, 0xffff0000, v157
    v_lshlrev_b32 v154, 16, v159
    v_and_b32 v155, 0xffff0000, v159
    v_cmp_lt_f32 vcc, 0, v148
    s_nop 1
    v_cndmask_b32 v156, 0, 1.0, vcc
    v_mul_f32 v148, v148, v156
    v_mul_f32 v148, v148, v152
    v_cmp_lt_f32 vcc, 0, v149
    s_nop 1
    v_cndmask_b32 v156, 0, 1.0, vcc
    v_mul_f32 v149, v149, v156
    v_mul_f32 v149, v149, v153
    v_cmp_lt_f32 vcc, 0, v150
    s_nop 1
    v_cndmask_b32 v156, 0, 1.0, vcc
    v_mul_f32 v150, v150, v156
    v_mul_f32 v150, v150, v154
    v_cmp_lt_f32 vcc, 0, v151
    s_nop 1
    v_cndmask_b32 v156, 0, 1.0, vcc
    v_mul_f32 v151, v151, v156
    v_mul_f32 v151, v151, v155
    v_cvt_pk_bf16_f32 v100, v148, v149
    v_cvt_pk_bf16_f32 v101, v150, v151
    v_accvgpr_read_b32 v148, a172
    v_accvgpr_read_b32 v152, a184
    v_accvgpr_read_b32 v149, a173
    v_accvgpr_read_b32 v153, a185
    v_accvgpr_read_b32 v150, a174
    v_accvgpr_read_b32 v154, a186
    v_accvgpr_read_b32 v151, a175
    v_accvgpr_read_b32 v155, a187
    v_cvt_pk_bf16_f32 v156, v148, v149
    v_cvt_pk_bf16_f32 v157, v150, v151
    v_cvt_pk_bf16_f32 v158, v152, v153
    v_cvt_pk_bf16_f32 v159, v154, v155
    v_lshlrev_b32 v148, 16, v156
    v_and_b32 v149, 0xffff0000, v156
    v_lshlrev_b32 v152, 16, v158
    v_and_b32 v153, 0xffff0000, v158
    v_lshlrev_b32 v150, 16, v157
    v_and_b32 v151, 0xffff0000, v157
    v_lshlrev_b32 v154, 16, v159
    v_and_b32 v155, 0xffff0000, v159
    v_cmp_lt_f32 vcc, 0, v148
    s_nop 1
    v_cndmask_b32 v156, 0, 1.0, vcc
    v_mul_f32 v148, v148, v156
    v_mul_f32 v148, v148, v152
    v_cmp_lt_f32 vcc, 0, v149
    s_nop 1
    v_cndmask_b32 v156, 0, 1.0, vcc
    v_mul_f32 v149, v149, v156
    v_mul_f32 v149, v149, v153
    v_cmp_lt_f32 vcc, 0, v150
    s_nop 1
    v_cndmask_b32 v156, 0, 1.0, vcc
    v_mul_f32 v150, v150, v156
    v_mul_f32 v150, v150, v154
    v_cmp_lt_f32 vcc, 0, v151
    s_nop 1
    v_cndmask_b32 v156, 0, 1.0, vcc
    v_mul_f32 v151, v151, v156
    v_mul_f32 v151, v151, v155
    v_cvt_pk_bf16_f32 v102, v148, v149
    v_cvt_pk_bf16_f32 v103, v150, v151
    v_accvgpr_read_b32 v148, a176
    v_accvgpr_read_b32 v152, a188
    v_accvgpr_read_b32 v149, a177
    v_accvgpr_read_b32 v153, a189
    v_accvgpr_read_b32 v150, a178
    v_accvgpr_read_b32 v154, a190
    v_accvgpr_read_b32 v151, a179
    v_accvgpr_read_b32 v155, a191
    v_cvt_pk_bf16_f32 v156, v148, v149
    v_cvt_pk_bf16_f32 v157, v150, v151
    v_cvt_pk_bf16_f32 v158, v152, v153
    v_cvt_pk_bf16_f32 v159, v154, v155
    v_lshlrev_b32 v148, 16, v156
    v_and_b32 v149, 0xffff0000, v156
    v_lshlrev_b32 v152, 16, v158
    v_and_b32 v153, 0xffff0000, v158
    v_lshlrev_b32 v150, 16, v157
    v_and_b32 v151, 0xffff0000, v157
    v_lshlrev_b32 v154, 16, v159
    v_and_b32 v155, 0xffff0000, v159
    v_cmp_lt_f32 vcc, 0, v148
    s_nop 1
    v_cndmask_b32 v156, 0, 1.0, vcc
    v_mul_f32 v148, v148, v156
    v_mul_f32 v148, v148, v152
    v_cmp_lt_f32 vcc, 0, v149
    s_nop 1
    v_cndmask_b32 v156, 0, 1.0, vcc
    v_mul_f32 v149, v149, v156
    v_mul_f32 v149, v149, v153
    v_cmp_lt_f32 vcc, 0, v150
    s_nop 1
    v_cndmask_b32 v156, 0, 1.0, vcc
    v_mul_f32 v150, v150, v156
    v_mul_f32 v150, v150, v154
    v_cmp_lt_f32 vcc, 0, v151
    s_nop 1
    v_cndmask_b32 v156, 0, 1.0, vcc
    v_mul_f32 v151, v151, v156
    v_mul_f32 v151, v151, v155
    v_cvt_pk_bf16_f32 v104, v148, v149
    v_cvt_pk_bf16_f32 v105, v150, v151
    s_nop 1
    v_permlane32_swap_b32 v100, v102
    v_permlane32_swap_b32 v101, v103
    s_nop 1
    v_permlane16_swap_b32 v100, v102
    v_permlane16_swap_b32 v101, v103
    buffer_store_dwordx4 v[100:103], v60, s[16:19], s23 offen sc1
    buffer_store_dwordx2 v[104:105], v67, s[16:19], s23 offen offset:64 sc1
    s_waitcnt vmcnt(0)
    s_xor_b32 s66, s66, 16
    v_mov_b32 v3, 160000
    v_add_u32 v3, s66, v3
    s_cmp_lg_u32 s61, 0
    s_cbranch_scc1 fi1_16
    v_accvgpr_read_b32 v2, a255
    s_mov_b64 exec, 1
    ds_write_b32 v3, v2
    s_mov_b64 exec, -1
    s_waitcnt lgkmcnt(0)
fi1_16:
    s_barrier
    ds_read_b32 v4, v3
    s_cmp_lg_u32 s61, 0
    s_cbranch_scc1 fi2_17
    s_mov_b64 exec, 1
    v_mov_b32 v6, 1
    v_mov_b32 v7, 0
    buffer_atomic_add v6, v7, s[56:59], s74 offen sc1
    s_mov_b64 exec, -1
fi2_17:
    s_waitcnt lgkmcnt(0)
    v_readfirstlane_b32 s62, v4
    s_nop 3
    s_cmp_eq_u32 s63, 0
    s_cbranch_scc1 mega_decA
    s_branch mega_decB
blk_vu:
    s_load_dwordx4 s[32:35], s[0:1], 32
    s_mov_b32 s8, s64
    s_mov_b32 s9, s65
    s_mov_b32 s10, 2621440
    s_mov_b32 s11, 0x00020000
    s_add_u32 s16, s64, 104333312
    s_addc_u32 s17, s65, 0
    s_mov_b32 s18, 83886080
    s_mov_b32 s19, 0x00020000
    s_waitcnt lgkmcnt(0)
    s_mov_b32 s12, s32
    s_mov_b32 s13, s33
    s_mov_b32 s14, 7864320
    s_mov_b32 s15, 0x00020000
    s_mov_b32 s28, s34
    s_mov_b32 s29, s35
    s_mov_b32 s30, 7864320
    s_mov_b32 s31, 0x00020000
    s_mul_i32 s20, s70, 327680
    s_mul_i32 s21, s71, 384
    s_lshl_b32 s23, s70, 8
    s_add_u32 s23, s23, s71
    s_mul_i32 s23, s23, 640
    s_lshl_b32 s23, s23, 6
    s_lshl_b32 s24, s72, 13
    s_add_u32 s23, s23, s24
    s_mul_i32 s76, s71, 245760
    s_lshl_b32 s24, s72, 8
    s_add_u32 s76, s76, s24
    s_add_u32 s74, s70, 16
    s_lshl_b32 s74, s74, 7
    v_lshrrev_b32 v1, 3, v0
    v_and_b32 v60, 7, v0
    s_mov_b32 s24, 1280
    v_mul_lo_u32 v2, v1, s24
    v_lshl_add_u32 v2, v60, 4, v2
    v_add_u32 v3, 40960, v2
    v_add_u32 v4, 81920, v2
    v_add_u32 v5, 122880, v2
    v_add_u32 v6, 163840, v2
    v_add_u32 v7, 204800, v2
    v_add_u32 v8, 245760, v2
    v_add_u32 v9, 286720, v2
    v_mul_u32_u24 v12, 144, v1
    v_lshl_add_u32 v12, v60, 4, v12
    v_add_u32 v13, 63488, v12
    s_mov_b32 s24, 12288
    v_mul_lo_u32 v10, v1, s24
    v_lshl_add_u32 v10, v60, 4, v10
    v_add_u32 v11, 393216, v10
    v_mul_u32_u24 v14, 416, v1
    v_lshl_add_u32 v14, v60, 4, v14
    v_add_u32 v14, 36864, v14
    v_add_u32 v15, 63488, v14
    v_and_b32 v60, 15, v0
    v_bfe_u32 v61, v0, 4, 2
    v_lshrrev_b32 v62, 7, v0
    v_bfe_u32 v63, v0, 6, 1
    v_lshl_add_u32 v64, v62, 7, v60
    v_mul_u32_u24 v16, 144, v64
    v_lshl_add_u32 v16, v61, 3, v16
    v_add_u32 v17, 63488, v16
    v_lshrrev_b32 v64, 2, v60
    v_lshl_add_u32 v64, v61, 2, v64
    v_mul_u32_u24 v18, 416, v64
    v_and_b32 v64, 3, v60
    v_lshl_add_u32 v18, v64, 3, v18
    v_mul_u32_u24 v64, 192, v63
    v_add_u32 v18, v64, v18
    v_add_u32 v18, 36864, v18
    v_add_u32 v19, 63488, v18
    buffer_load_dwordx4 v[20:23], v2, s[8:11], s20 offen
    buffer_load_dwordx4 v[24:27], v3, s[8:11], s20 offen
    buffer_load_dwordx4 v[28:31], v4, s[8:11], s20 offen
    buffer_load_dwordx4 v[32:35], v5, s[8:11], s20 offen
    buffer_load_dwordx4 v[36:39], v6, s[8:11], s20 offen
    buffer_load_dwordx4 v[40:43], v7, s[8:11], s20 offen
    buffer_load_dwordx4 v[44:47], v8, s[8:11], s20 offen
    buffer_load_dwordx4 v[48:51], v9, s[8:11], s20 offen
    buffer_load_dwordx4 v[52:55], v10, s[12:15], s21 offen offset:0
    buffer_load_dwordx4 v[56:59], v10, s[12:15], s21 offen offset:128
    buffer_load_dwordx4 v[60:63], v10, s[12:15], s21 offen offset:256
    buffer_load_dwordx4 v[64:67], v11, s[12:15], s21 offen offset:0
    buffer_load_dwordx4 v[68:71], v11, s[12:15], s21 offen offset:128
    buffer_load_dwordx4 v[72:75], v11, s[12:15], s21 offen offset:256
    s_add_u32 s20, s20, 128
    s_add_u32 s21, s21, 786432
    buffer_load_dwordx4 v[188:191], v2, s[8:11], s20 offen
    buffer_load_dwordx4 v[192:195], v3, s[8:11], s20 offen
    buffer_load_dwordx4 v[196:199], v4, s[8:11], s20 offen
    buffer_load_dwordx4 v[200:203], v5, s[8:11], s20 offen
    buffer_load_dwordx4 v[204:207], v6, s[8:11], s20 offen
    buffer_load_dwordx4 v[208:211], v7, s[8:11], s20 offen
    buffer_load_dwordx4 v[212:215], v8, s[8:11], s20 offen
    buffer_load_dwordx4 v[216:219], v9, s[8:11], s20 offen
    buffer_load_dwordx4 v[220:223], v10, s[12:15], s21 offen offset:0
    buffer_load_dwordx4 v[224:227], v10, s[12:15], s21 offen offset:128
    buffer_load_dwordx4 v[228:231], v10, s[12:15], s21 offen offset:256
    buffer_load_dwordx4 v[232:235], v11, s[12:15], s21 offen offset:0
    buffer_load_dwordx4 v[236:239], v11, s[12:15], s21 offen offset:128
    buffer_load_dwordx4 v[240:243], v11, s[12:15], s21 offen offset:256
    s_add_u32 s20, s20, 128
    s_add_u32 s21, s21, 786432
    v_accvgpr_write_b32 a0, 0
    v_accvgpr_write_b32 a1, 0
    v_accvgpr_write_b32 a2, 0
    v_accvgpr_write_b32 a3, 0
    v_accvgpr_write_b32 a4, 0
    v_accvgpr_write_b32 a5, 0
    v_accvgpr_write_b32 a6, 0
    v_accvgpr_write_b32 a7, 0
    v_accvgpr_write_b32 a8, 0
    v_accvgpr_write_b32 a9, 0
    v_accvgpr_write_b32 a10, 0
    v_accvgpr_write_b32 a11, 0
    v_accvgpr_write_b32 a12, 0
    v_accvgpr_write_b32 a13, 0
    v_accvgpr_write_b32 a14, 0
    v_accvgpr_write_b32 a15, 0
    v_accvgpr_write_b32 a16, 0
    v_accvgpr_write_b32 a17, 0
    v_accvgpr_write_b32 a18, 0
    v_accvgpr_write_b32 a19, 0
    v_accvgpr_write_b32 a20, 0
    v_accvgpr_write_b32 a21, 0
    v_accvgpr_write_b32 a22, 0
    v_accvgpr_write_b32 a23, 0
    v_accvgpr_write_b32 a24, 0
    v_accvgpr_write_b32 a25, 0
    v_accvgpr_write_b32 a26, 0
    v_accvgpr_write_b32 a27, 0
    v_accvgpr_write_b32 a28, 0
    v_accvgpr_write_b32 a29, 0
    v_accvgpr_write_b32 a30, 0
    v_accvgpr_write_b32 a31, 0
    v_accvgpr_write_b32 a32, 0
    v_accvgpr_write_b32 a33, 0
    v_accvgpr_write_b32 a34, 0
    v_accvgpr_write_b32 a35, 0
    v_accvgpr_write_b32 a36, 0
    v_accvgpr_write_b32 a37, 0
    v_accvgpr_write_b32 a38, 0
    v_accvgpr_write_b32 a39, 0
    v_accvgpr_write_b32 a40, 0
    v_accvgpr_write_b32 a41, 0
    v_accvgpr_write_b32 a42, 0
    v_accvgpr_write_b32 a43, 0
    v_accvgpr_write_b32 a44, 0
    v_accvgpr_write_b32 a45, 0
    v_accvgpr_write_b32 a46, 0
    v_accvgpr_write_b32 a47, 0
    v_accvgpr_write_b32 a48, 0
    v_accvgpr_write_b32 a49, 0
    v_accvgpr_write_b32 a50, 0
    v_accvgpr_write_b32 a51, 0
    v_accvgpr_write_b32 a52, 0
    v_accvgpr_write_b32 a53, 0
    v_accvgpr_write_b32 a54, 0
    v_accvgpr_write_b32 a55, 0
    v_accvgpr_write_b32 a56, 0
    v_accvgpr_write_b32 a57, 0
    v_accvgpr_write_b32 a58, 0
    v_accvgpr_write_b32 a59, 0
    v_accvgpr_write_b32 a60, 0
    v_accvgpr_write_b32 a61, 0
    v_accvgpr_write_b32 a62, 0
    v_accvgpr_write_b32 a63, 0
    v_accvgpr_write_b32 a64, 0
    v_accvgpr_write_b32 a65, 0
    v_accvgpr_write_b32 a66, 0
    v_accvgpr_write_b32 a67, 0
    v_accvgpr_write_b32 a68, 0
    v_accvgpr_write_b32 a69, 0
    v_accvgpr_write_b32 a70, 0
    v_accvgpr_write_b32 a71, 0
    v_accvgpr_write_b32 a72, 0
    v_accvgpr_write_b32 a73, 0
    v_accvgpr_write_b32 a74, 0
    v_accvgpr_write_b32 a75, 0
    v_accvgpr_write_b32 a76, 0
    v_accvgpr_write_b32 a77, 0
    v_accvgpr_write_b32 a78, 0
    v_accvgpr_write_b32 a79, 0
    v_accvgpr_write_b32 a80, 0
    v_accvgpr_write_b32 a81, 0
    v_accvgpr_write_b32 a82, 0
    v_accvgpr_write_b32 a83, 0
    v_accvgpr_write_b32 a84, 0
    v_accvgpr_write_b32 a85, 0
    v_accvgpr_write_b32 a86, 0
    v_accvgpr_write_b32 a87, 0
    v_accvgpr_write_b32 a88, 0
    v_accvgpr_write_b32 a89, 0
    v_accvgpr_write_b32 a90, 0
    v_accvgpr_write_b32 a91, 0
    v_accvgpr_write_b32 a92, 0
    v_accvgpr_write_b32 a93, 0
    v_accvgpr_write_b32 a94, 0
    v_accvgpr_write_b32 a95, 0
    v_accvgpr_write_b32 a96, 0
    v_accvgpr_write_b32 a97, 0
    v_accvgpr_write_b32 a98, 0
    v_accvgpr_write_b32 a99, 0
    v_accvgpr_write_b32 a100, 0
    v_accvgpr_write_b32 a101, 0
    v_accvgpr_write_b32 a102, 0
    v_accvgpr_write_b32 a103, 0
    v_accvgpr_write_b32 a104, 0
    v_accvgpr_write_b32 a105, 0
    v_accvgpr_write_b32 a106, 0
    v_accvgpr_write_b32 a107, 0
    v_accvgpr_write_b32 a108, 0
    v_accvgpr_write_b32 a109, 0
    v_accvgpr_write_b32 a110, 0
    v_accvgpr_write_b32 a111, 0
    v_accvgpr_write_b32 a112, 0
    v_accvgpr_write_b32 a113, 0
    v_accvgpr_write_b32 a114, 0
    v_accvgpr_write_b32 a115, 0
    v_accvgpr_write_b32 a116, 0
    v_accvgpr_write_b32 a117, 0
    v_accvgpr_write_b32 a118, 0
    v_accvgpr_write_b32 a119, 0
    v_accvgpr_write_b32 a120, 0
    v_accvgpr_write_b32 a121, 0
    v_accvgpr_write_b32 a122, 0
    v_accvgpr_write_b32 a123, 0
    v_accvgpr_write_b32 a124, 0
    v_accvgpr_write_b32 a125, 0
    v_accvgpr_write_b32 a126, 0
    v_accvgpr_write_b32 a127, 0
    v_accvgpr_write_b32 a128, 0
    v_accvgpr_write_b32 a129, 0
    v_accvgpr_write_b32 a130, 0
    v_accvgpr_write_b32 a131, 0
    v_accvgpr_write_b32 a132, 0
    v_accvgpr_write_b32 a133, 0
    v_accvgpr_write_b32 a134, 0
    v_accvgpr_write_b32 a135, 0
    v_accvgpr_write_b32 a136, 0
    v_accvgpr_write_b32 a137, 0
    v_accvgpr_write_b32 a138, 0
    v_accvgpr_write_b32 a139, 0
    v_accvgpr_write_b32 a140, 0
    v_accvgpr_write_b32 a141, 0
    v_accvgpr_write_b32 a142, 0
    v_accvgpr_write_b32 a143, 0
    v_accvgpr_write_b32 a144, 0
    v_accvgpr_write_b32 a145, 0
    v_accvgpr_write_b32 a146, 0
    v_accvgpr_write_b32 a147, 0
    v_accvgpr_write_b32 a148, 0
    v_accvgpr_write_b32 a149, 0
    v_accvgpr_write_b32 a150, 0
    v_accvgpr_write_b32 a151, 0
    v_accvgpr_write_b32 a152, 0
    v_accvgpr_write_b32 a153, 0
    v_accvgpr_write_b32 a154, 0
    v_accvgpr_write_b32 a155, 0
    v_accvgpr_write_b32 a156, 0
    v_accvgpr_write_b32 a157, 0
    v_accvgpr_write_b32 a158, 0
    v_accvgpr_write_b32 a159, 0
    v_accvgpr_write_b32 a160, 0
    v_accvgpr_write_b32 a161, 0
    v_accvgpr_write_b32 a162, 0
    v_accvgpr_write_b32 a163, 0
    v_accvgpr_write_b32 a164, 0
    v_accvgpr_write_b32 a165, 0
    v_accvgpr_write_b32 a166, 0
    v_accvgpr_write_b32 a167, 0
    v_accvgpr_write_b32 a168, 0
    v_accvgpr_write_b32 a169, 0
    v_accvgpr_write_b32 a170, 0
    v_accvgpr_write_b32 a171, 0
    v_accvgpr_write_b32 a172, 0
    v_accvgpr_write_b32 a173, 0
    v_accvgpr_write_b32 a174, 0
    v_accvgpr_write_b32 a175, 0
    v_accvgpr_write_b32 a176, 0
    v_accvgpr_write_b32 a177, 0
    v_accvgpr_write_b32 a178, 0
    v_accvgpr_write_b32 a179, 0
    v_accvgpr_write_b32 a180, 0
    v_accvgpr_write_b32 a181, 0
    v_accvgpr_write_b32 a182, 0
    v_accvgpr_write_b32 a183, 0
    v_accvgpr_write_b32 a184, 0
    v_accvgpr_write_b32 a185, 0
    v_accvgpr_write_b32 a186, 0
    v_accvgpr_write_b32 a187, 0
    v_accvgpr_write_b32 a188, 0
    v_accvgpr_write_b32 a189, 0
    v_accvgpr_write_b32 a190, 0
    v_accvgpr_write_b32 a191, 0
    s_waitcnt vmcnt(14)
    ds_write_b128 v12, v[20:23] offset:0
    ds_write_b128 v12, v[24:27] offset:4608
    ds_write_b128 v12, v[28:31] offset:9216
    ds_write_b128 v12, v[32:35] offset:13824
    ds_write_b128 v12, v[36:39] offset:18432
    ds_write_b128 v12, v[40:43] offset:23040
    ds_write_b128 v12, v[44:47] offset:27648
    ds_write_b128 v12, v[48:51] offset:32256
    ds_write_b128 v14, v[52:55] offset:0
    ds_write_b128 v14, v[56:59] offset:128
    ds_write_b128 v14, v[60:63] offset:256
    ds_write_b128 v14, v[64:67] offset:13312
    ds_write_b128 v14, v[68:71] offset:13440
    ds_write_b128 v14, v[72:75] offset:13568
    s_waitcnt lgkmcnt(0)
    buffer_load_dwordx4 v[20:23], v2, s[8:11], s20 offen
    buffer_load_dwordx4 v[24:27], v3, s[8:11], s20 offen
    buffer_load_dwordx4 v[28:31], v4, s[8:11], s20 offen
    buffer_load_dwordx4 v[32:35], v5, s[8:11], s20 offen
    buffer_load_dwordx4 v[36:39], v6, s[8:11], s20 offen
    buffer_load_dwordx4 v[40:43], v7, s[8:11], s20 offen
    buffer_load_dwordx4 v[44:47], v8, s[8:11], s20 offen
    buffer_load_dwordx4 v[48:51], v9, s[8:11], s20 offen
    buffer_load_dwordx4 v[52:55], v10, s[12:15], s21 offen offset:0
    buffer_load_dwordx4 v[56:59], v10, s[12:15], s21 offen offset:128
    buffer_load_dwordx4 v[60:63], v10, s[12:15], s21 offen offset:256
    buffer_load_dwordx4 v[64:67], v11, s[12:15], s21 offen offset:0
    buffer_load_dwordx4 v[68:71], v11, s[12:15], s21 offen offset:128
    buffer_load_dwordx4 v[72:75], v11, s[12:15], s21 offen offset:256
    s_add_u32 s20, s20, 128
    s_add_u32 s21, s21, 786432
    s_barrier
    ds_read_b64_tr_b16 v[108:109], v18 offset:0
    ds_read_b64_tr_b16 v[110:111], v18 offset:6656
    ds_read_b64_tr_b16 v[112:113], v18 offset:32
    ds_read_b64_tr_b16 v[114:115], v18 offset:6688
    ds_read_b64_tr_b16 v[116:117], v18 offset:64
    ds_read_b64_tr_b16 v[118:119], v18 offset:6720
    ds_read_b64_tr_b16 v[120:121], v18 offset:96
    ds_read_b64_tr_b16 v[122:123], v18 offset:6752
    ds_read_b64_tr_b16 v[124:125], v18 offset:128
    ds_read_b64_tr_b16 v[126:127], v18 offset:6784
    ds_read_b64_tr_b16 v[128:129], v18 offset:160
    ds_read_b64_tr_b16 v[130:131], v18 offset:6816
    ds_read_b64 v[76:77], v16 offset:0
    ds_read_b64 v[78:79], v16 offset:32
    ds_read_b64 v[80:81], v16 offset:2304
    ds_read_b64 v[82:83], v16 offset:2336
    ds_read_b64 v[84:85], v16 offset:4608
    ds_read_b64 v[86:87], v16 offset:4640
    ds_read_b64 v[88:89], v16 offset:6912
    ds_read_b64 v[90:91], v16 offset:6944
    ds_read_b64 v[92:93], v16 offset:9216
    ds_read_b64 v[94:95], v16 offset:9248
    ds_read_b64 v[96:97], v16 offset:11520
    ds_read_b64 v[98:99], v16 offset:11552
    ds_read_b64 v[100:101], v16 offset:13824
    ds_read_b64 v[102:103], v16 offset:13856
    ds_read_b64 v[104:105], v16 offset:16128
    ds_read_b64 v[106:107], v16 offset:16160
    s_mov_b32 s22, 10
    s_waitcnt lgkmcnt(0)
mvu_loop:
    v_mfma_f32_16x16x32_bf16 a[0:3], v[108:111], v[76:79], a[0:3]
    v_mfma_f32_16x16x32_bf16 a[4:7], v[112:115], v[76:79], a[4:7]
    ds_read_b64_tr_b16 v[164:165], v18 offset:13312
    v_mfma_f32_16x16x32_bf16 a[8:11], v[116:119], v[76:79], a[8:11]
    ds_read_b64_tr_b16 v[166:167], v18 offset:19968
    v_mfma_f32_16x16x32_bf16 a[12:15], v[120:123], v[76:79], a[12:15]
    ds_read_b64_tr_b16 v[168:169], v18 offset:13344
    v_mfma_f32_16x16x32_bf16 a[16:19], v[124:127], v[76:79], a[16:19]
    ds_read_b64_tr_b16 v[170:171], v18 offset:20000
    v_mfma_f32_16x16x32_bf16 a[20:23], v[128:131], v[76:79], a[20:23]
    ds_read_b64_tr_b16 v[172:173], v18 offset:13376
    v_mfma_f32_16x16x32_bf16 a[24:27], v[108:111], v[80:83], a[24:27]
    ds_read_b64_tr_b16 v[174:175], v18 offset:20032
    v_mfma_f32_16x16x32_bf16 a[28:31], v[112:115], v[80:83], a[28:31]
    ds_read_b64_tr_b16 v[176:177], v18 offset:13408
    v_mfma_f32_16x16x32_bf16 a[32:35], v[116:119], v[80:83], a[32:35]
    ds_read_b64_tr_b16 v[178:179], v18 offset:20064
    v_mfma_f32_16x16x32_bf16 a[36:39], v[120:123], v[80:83], a[36:39]
    ds_read_b64_tr_b16 v[180:181], v18 offset:13440
    v_mfma_f32_16x16x32_bf16 a[40:43], v[124:127], v[80:83], a[40:43]
    ds_read_b64_tr_b16 v[182:183], v18 offset:20096
    v_mfma_f32_16x16x32_bf16 a[44:47], v[128:131], v[80:83], a[44:47]
    ds_read_b64_tr_b16 v[184:185], v18 offset:13472
    v_mfma_f32_16x16x32_bf16 a[48:51], v[108:111], v[84:87], a[48:51]
    ds_read_b64_tr_b16 v[186:187], v18 offset:20128
    v_mfma_f32_16x16x32_bf16 a[52:55], v[112:115], v[84:87], a[52:55]
    ds_read_b64 v[132:133], v16 offset:64
    v_mfma_f32_16x16x32_bf16 a[56:59], v[116:119], v[84:87], a[56:59]
    ds_read_b64 v[134:135], v16 offset:96
    v_mfma_f32_16x16x32_bf16 a[60:63], v[120:123], v[84:87], a[60:63]
    ds_read_b64 v[136:137], v16 offset:2368
    v_mfma_f32_16x16x32_bf16 a[64:67], v[124:127], v[84:87], a[64:67]
    ds_read_b64 v[138:139], v16 offset:2400
    v_mfma_f32_16x16x32_bf16 a[68:71], v[128:131], v[84:87], a[68:71]
    ds_read_b64 v[140:141], v16 offset:4672
    v_mfma_f32_16x16x32_bf16 a[72:75], v[108:111], v[88:91], a[72:75]
    ds_read_b64 v[142:143], v16 offset:4704
    v_mfma_f32_16x16x32_bf16 a[76:79], v[112:115], v[88:91], a[76:79]
    ds_read_b64 v[144:145], v16 offset:6976
    v_mfma_f32_16x16x32_bf16 a[80:83], v[116:119], v[88:91], a[80:83]
    ds_read_b64 v[146:147], v16 offset:7008
    v_mfma_f32_16x16x32_bf16 a[84:87], v[120:123], v[88:91], a[84:87]
    ds_read_b64 v[148:149], v16 offset:9280
    v_mfma_f32_16x16x32_bf16 a[88:91], v[124:127], v[88:91], a[88:91]
    ds_read_b64 v[150:151], v16 offset:9312
    v_mfma_f32_16x16x32_bf16 a[92:95], v[128:131], v[88:91], a[92:95]
    ds_read_b64 v[152:153], v16 offset:11584
    v_mfma_f32_16x16x32_bf16 a[96:99], v[108:111], v[92:95], a[96:99]
    ds_read_b64 v[154:155], v16 offset:11616
    v_mfma_f32_16x16x32_bf16 a[100:103], v[112:115], v[92:95], a[100:103]
    ds_read_b64 v[156:157], v16 offset:13888
    v_mfma_f32_16x16x32_bf16 a[104:107], v[116:119], v[92:95], a[104:107]
    ds_read_b64 v[158:159], v16 offset:13920
    v_mfma_f32_16x16x32_bf16 a[108:111], v[120:123], v[92:95], a[108:111]
    ds_read_b64 v[160:161], v16 offset:16192
    v_mfma_f32_16x16x32_bf16 a[112:115], v[124:127], v[92:95], a[112:115]
    ds_read_b64 v[162:163], v16 offset:16224
    v_mfma_f32_16x16x32_bf16 a[116:119], v[128:131], v[92:95], a[116:119]
    v_mfma_f32_16x16x32_bf16 a[120:123], v[108:111], v[96:99], a[120:123]
    v_mfma_f32_16x16x32_bf16 a[124:127], v[112:115], v[96:99], a[124:127]
    v_mfma_f32_16x16x32_bf16 a[128:131], v[116:119], v[96:99], a[128:131]
    v_mfma_f32_16x16x32_bf16 a[132:135], v[120:123], v[96:99], a[132:135]
    v_mfma_f32_16x16x32_bf16 a[136:139], v[124:127], v[96:99], a[136:139]
    v_mfma_f32_16x16x32_bf16 a[140:143], v[128:131], v[96:99], a[140:143]
    v_mfma_f32_16x16x32_bf16 a[144:147], v[108:111], v[100:103], a[144:147]
    v_mfma_f32_16x16x32_bf16 a[148:151], v[112:115], v[100:103], a[148:151]
    v_mfma_f32_16x16x32_bf16 a[152:155], v[116:119], v[100:103], a[152:155]
    v_mfma_f32_16x16x32_bf16 a[156:159], v[120:123], v[100:103], a[156:159]
    v_mfma_f32_16x16x32_bf16 a[160:163], v[124:127], v[100:103], a[160:163]
    v_mfma_f32_16x16x32_bf16 a[164:167], v[128:131], v[100:103], a[164:167]
    v_mfma_f32_16x16x32_bf16 a[168:171], v[108:111], v[104:107], a[168:171]
    v_mfma_f32_16x16x32_bf16 a[172:175], v[112:115], v[104:107], a[172:175]
    v_mfma_f32_16x16x32_bf16 a[176:179], v[116:119], v[104:107], a[176:179]
    v_mfma_f32_16x16x32_bf16 a[180:183], v[120:123], v[104:107], a[180:183]
    v_mfma_f32_16x16x32_bf16 a[184:187], v[124:127], v[104:107], a[184:187]
    v_mfma_f32_16x16x32_bf16 a[188:191], v[128:131], v[104:107], a[188:191]
    s_waitcnt lgkmcnt(0)
    s_waitcnt vmcnt(14)
    v_mfma_f32_16x16x32_bf16 a[0:3], v[164:167], v[132:135], a[0:3]
    ds_write_b128 v13, v[188:191] offset:0
    v_mfma_f32_16x16x32_bf16 a[4:7], v[168:171], v[132:135], a[4:7]
    ds_write_b128 v13, v[192:195] offset:4608
    v_mfma_f32_16x16x32_bf16 a[8:11], v[172:175], v[132:135], a[8:11]
    ds_write_b128 v13, v[196:199] offset:9216
    v_mfma_f32_16x16x32_bf16 a[12:15], v[176:179], v[132:135], a[12:15]
    ds_write_b128 v13, v[200:203] offset:13824
    v_mfma_f32_16x16x32_bf16 a[16:19], v[180:183], v[132:135], a[16:19]
    ds_write_b128 v13, v[204:207] offset:18432
    v_mfma_f32_16x16x32_bf16 a[20:23], v[184:187], v[132:135], a[20:23]
    ds_write_b128 v13, v[208:211] offset:23040
    v_mfma_f32_16x16x32_bf16 a[24:27], v[164:167], v[136:139], a[24:27]
    ds_write_b128 v13, v[212:215] offset:27648
    v_mfma_f32_16x16x32_bf16 a[28:31], v[168:171], v[136:139], a[28:31]
    ds_write_b128 v13, v[216:219] offset:32256
    v_mfma_f32_16x16x32_bf16 a[32:35], v[172:175], v[136:139], a[32:35]
    ds_write_b128 v15, v[220:223] offset:0
    v_mfma_f32_16x16x32_bf16 a[36:39], v[176:179], v[136:139], a[36:39]
    ds_write_b128 v15, v[224:227] offset:128
    v_mfma_f32_16x16x32_bf16 a[40:43], v[180:183], v[136:139], a[40:43]
    ds_write_b128 v15, v[228:231] offset:256
    v_mfma_f32_16x16x32_bf16 a[44:47], v[184:187], v[136:139], a[44:47]
    ds_write_b128 v15, v[232:235] offset:13312
    v_mfma_f32_16x16x32_bf16 a[48:51], v[164:167], v[140:143], a[48:51]
    ds_write_b128 v15, v[236:239] offset:13440
    v_mfma_f32_16x16x32_bf16 a[52:55], v[168:171], v[140:143], a[52:55]
    ds_write_b128 v15, v[240:243] offset:13568
    v_mfma_f32_16x16x32_bf16 a[56:59], v[172:175], v[140:143], a[56:59]
    v_mfma_f32_16x16x32_bf16 a[60:63], v[176:179], v[140:143], a[60:63]
    s_waitcnt lgkmcnt(0)
    s_barrier
    v_mfma_f32_16x16x32_bf16 a[64:67], v[180:183], v[140:143], a[64:67]
    ds_read_b64_tr_b16 v[108:109], v19 offset:0
    ds_read_b64_tr_b16 v[110:111], v19 offset:6656
    v_mfma_f32_16x16x32_bf16 a[68:71], v[184:187], v[140:143], a[68:71]
    buffer_load_dwordx4 v[188:191], v2, s[8:11], s20 offen
    ds_read_b64_tr_b16 v[112:113], v19 offset:32
    v_mfma_f32_16x16x32_bf16 a[72:75], v[164:167], v[144:147], a[72:75]
    ds_read_b64_tr_b16 v[114:115], v19 offset:6688
    buffer_load_dwordx4 v[192:195], v3, s[8:11], s20 offen
    v_mfma_f32_16x16x32_bf16 a[76:79], v[168:171], v[144:147], a[76:79]
    ds_read_b64_tr_b16 v[116:117], v19 offset:64
    ds_read_b64_tr_b16 v[118:119], v19 offset:6720
    v_mfma_f32_16x16x32_bf16 a[80:83], v[172:175], v[144:147], a[80:83]
    buffer_load_dwordx4 v[196:199], v4, s[8:11], s20 offen
    ds_read_b64_tr_b16 v[120:121], v19 offset:96
    v_mfma_f32_16x16x32_bf16 a[84:87], v[176:179], v[144:147], a[84:87]
    ds_read_b64_tr_b16 v[122:123], v19 offset:6752
    buffer_load_dwordx4 v[200:203], v5, s[8:11], s20 offen
    v_mfma_f32_16x16x32_bf16 a[88:91], v[180:183], v[144:147], a[88:91]
    ds_read_b64_tr_b16 v[124:125], v19 offset:128
    ds_read_b64_tr_b16 v[126:127], v19 offset:6784
    v_mfma_f32_16x16x32_bf16 a[92:95], v[184:187], v[144:147], a[92:95]
    buffer_load_dwordx4 v[204:207], v6, s[8:11], s20 offen
    ds_read_b64_tr_b16 v[128:129], v19 offset:160
    v_mfma_f32_16x16x32_bf16 a[96:99], v[164:167], v[148:151], a[96:99]
    ds_read_b64_tr_b16 v[130:131], v19 offset:6816
    buffer_load_dwordx4 v[208:211], v7, s[8:11], s20 offen
    v_mfma_f32_16x16x32_bf16 a[100:103], v[168:171], v[148:151], a[100:103]
    ds_read_b64 v[76:77], v17 offset:0
    ds_read_b64 v[78:79], v17 offset:32
    v_mfma_f32_16x16x32_bf16 a[104:107], v[172:175], v[148:151], a[104:107]
    buffer_load_dwordx4 v[212:215], v8, s[8:11], s20 offen
    ds_read_b64 v[80:81], v17 offset:2304
    v_mfma_f32_16x16x32_bf16 a[108:111], v[176:179], v[148:151], a[108:111]
    ds_read_b64 v[82:83], v17 offset:2336
    buffer_load_dwordx4 v[216:219], v9, s[8:11], s20 offen
    v_mfma_f32_16x16x32_bf16 a[112:115], v[180:183], v[148:151], a[112:115]
    ds_read_b64 v[84:85], v17 offset:4608
    ds_read_b64 v[86:87], v17 offset:4640
    v_mfma_f32_16x16x32_bf16 a[116:119], v[184:187], v[148:151], a[116:119]
    buffer_load_dwordx4 v[220:223], v10, s[12:15], s21 offen offset:0
    ds_read_b64 v[88:89], v17 offset:6912
    v_mfma_f32_16x16x32_bf16 a[120:123], v[164:167], v[152:155], a[120:123]
    ds_read_b64 v[90:91], v17 offset:6944
    buffer_load_dwordx4 v[224:227], v10, s[12:15], s21 offen offset:128
    v_mfma_f32_16x16x32_bf16 a[124:127], v[168:171], v[152:155], a[124:127]
    ds_read_b64 v[92:93], v17 offset:9216
    ds_read_b64 v[94:95], v17 offset:9248
    v_mfma_f32_16x16x32_bf16 a[128:131], v[172:175], v[152:155], a[128:131]
    buffer_load_dwordx4 v[228:231], v10, s[12:15], s21 offen offset:256
    ds_read_b64 v[96:97], v17 offset:11520
    v_mfma_f32_16x16x32_bf16 a[132:135], v[176:179], v[152:155], a[132:135]
    ds_read_b64 v[98:99], v17 offset:11552
    buffer_load_dwordx4 v[232:235], v11, s[12:15], s21 offen offset:0
    v_mfma_f32_16x16x32_bf16 a[136:139], v[180:183], v[152:155], a[136:139]
    ds_read_b64 v[100:101], v17 offset:13824
    ds_read_b64 v[102:103], v17 offset:13856
    v_mfma_f32_16x16x32_bf16 a[140:143], v[184:187], v[152:155], a[140:143]
    buffer_load_dwordx4 v[236:239], v11, s[12:15], s21 offen offset:128
    ds_read_b64 v[104:105], v17 offset:16128
    v_mfma_f32_16x16x32_bf16 a[144:147], v[164:167], v[156:159], a[144:147]
    ds_read_b64 v[106:107], v17 offset:16160
    buffer_load_dwordx4 v[240:243], v11, s[12:15], s21 offen offset:256
    v_mfma_f32_16x16x32_bf16 a[148:151], v[168:171], v[156:159], a[148:151]
    v_mfma_f32_16x16x32_bf16 a[152:155], v[172:175], v[156:159], a[152:155]
    v_mfma_f32_16x16x32_bf16 a[156:159], v[176:179], v[156:159], a[156:159]
    v_mfma_f32_16x16x32_bf16 a[160:163], v[180:183], v[156:159], a[160:163]
    v_mfma_f32_16x16x32_bf16 a[164:167], v[184:187], v[156:159], a[164:167]
    v_mfma_f32_16x16x32_bf16 a[168:171], v[164:167], v[160:163], a[168:171]
    v_mfma_f32_16x16x32_bf16 a[172:175], v[168:171], v[160:163], a[172:175]
    v_mfma_f32_16x16x32_bf16 a[176:179], v[172:175], v[160:163], a[176:179]
    v_mfma_f32_16x16x32_bf16 a[180:183], v[176:179], v[160:163], a[180:183]
    v_mfma_f32_16x16x32_bf16 a[184:187], v[180:183], v[160:163], a[184:187]
    v_mfma_f32_16x16x32_bf16 a[188:191], v[184:187], v[160:163], a[188:191]
    s_add_u32 s20, s20, 128
    s_add_u32 s21, s21, 786432
    s_sub_u32 s22, s22, 1
    s_cmp_eq_u32 s22, 0
    s_waitcnt lgkmcnt(0)
    s_cbranch_scc1 mvu_done
    v_mfma_f32_16x16x32_bf16 a[0:3], v[108:111], v[76:79], a[0:3]
    v_mfma_f32_16x16x32_bf16 a[4:7], v[112:115], v[76:79], a[4:7]
    ds_read_b64_tr_b16 v[164:165], v19 offset:13312
    v_mfma_f32_16x16x32_bf16 a[8:11], v[116:119], v[76:79], a[8:11]
    ds_read_b64_tr_b16 v[166:167], v19 offset:19968
    v_mfma_f32_16x16x32_bf16 a[12:15], v[120:123], v[76:79], a[12:15]
    ds_read_b64_tr_b16 v[168:169], v19 offset:13344
    v_mfma_f32_16x16x32_bf16 a[16:19], v[124:127], v[76:79], a[16:19]
    ds_read_b64_tr_b16 v[170:171], v19 offset:20000
    v_mfma_f32_16x16x32_bf16 a[20:23], v[128:131], v[76:79], a[20:23]
    ds_read_b64_tr_b16 v[172:173], v19 offset:13376
    v_mfma_f32_16x16x32_bf16 a[24:27], v[108:111], v[80:83], a[24:27]
    ds_read_b64_tr_b16 v[174:175], v19 offset:20032
    v_mfma_f32_16x16x32_bf16 a[28:31], v[112:115], v[80:83], a[28:31]
    ds_read_b64_tr_b16 v[176:177], v19 offset:13408
    v_mfma_f32_16x16x32_bf16 a[32:35], v[116:119], v[80:83], a[32:35]
    ds_read_b64_tr_b16 v[178:179], v19 offset:20064
    v_mfma_f32_16x16x32_bf16 a[36:39], v[120:123], v[80:83], a[36:39]
    ds_read_b64_tr_b16 v[180:181], v19 offset:13440
    v_mfma_f32_16x16x32_bf16 a[40:43], v[124:127], v[80:83], a[40:43]
    ds_read_b64_tr_b16 v[182:183], v19 offset:20096
    v_mfma_f32_16x16x32_bf16 a[44:47], v[128:131], v[80:83], a[44:47]
    ds_read_b64_tr_b16 v[184:185], v19 offset:13472
    v_mfma_f32_16x16x32_bf16 a[48:51], v[108:111], v[84:87], a[48:51]
    ds_read_b64_tr_b16 v[186:187], v19 offset:20128
    v_mfma_f32_16x16x32_bf16 a[52:55], v[112:115], v[84:87], a[52:55]
    ds_read_b64 v[132:133], v17 offset:64
    v_mfma_f32_16x16x32_bf16 a[56:59], v[116:119], v[84:87], a[56:59]
    ds_read_b64 v[134:135], v17 offset:96
    v_mfma_f32_16x16x32_bf16 a[60:63], v[120:123], v[84:87], a[60:63]
    ds_read_b64 v[136:137], v17 offset:2368
    v_mfma_f32_16x16x32_bf16 a[64:67], v[124:127], v[84:87], a[64:67]
    ds_read_b64 v[138:139], v17 offset:2400
    v_mfma_f32_16x16x32_bf16 a[68:71], v[128:131], v[84:87], a[68:71]
    ds_read_b64 v[140:141], v17 offset:4672
    v_mfma_f32_16x16x32_bf16 a[72:75], v[108:111], v[88:91], a[72:75]
    ds_read_b64 v[142:143], v17 offset:4704
    v_mfma_f32_16x16x32_bf16 a[76:79], v[112:115], v[88:91], a[76:79]
    ds_read_b64 v[144:145], v17 offset:6976
    v_mfma_f32_16x16x32_bf16 a[80:83], v[116:119], v[88:91], a[80:83]
    ds_read_b64 v[146:147], v17 offset:7008
    v_mfma_f32_16x16x32_bf16 a[84:87], v[120:123], v[88:91], a[84:87]
    ds_read_b64 v[148:149], v17 offset:9280
    v_mfma_f32_16x16x32_bf16 a[88:91], v[124:127], v[88:91], a[88:91]
    ds_read_b64 v[150:151], v17 offset:9312
    v_mfma_f32_16x16x32_bf16 a[92:95], v[128:131], v[88:91], a[92:95]
    ds_read_b64 v[152:153], v17 offset:11584
    v_mfma_f32_16x16x32_bf16 a[96:99], v[108:111], v[92:95], a[96:99]
    ds_read_b64 v[154:155], v17 offset:11616
    v_mfma_f32_16x16x32_bf16 a[100:103], v[112:115], v[92:95], a[100:103]
    ds_read_b64 v[156:157], v17 offset:13888
    v_mfma_f32_16x16x32_bf16 a[104:107], v[116:119], v[92:95], a[104:107]
    ds_read_b64 v[158:159], v17 offset:13920
    v_mfma_f32_16x16x32_bf16 a[108:111], v[120:123], v[92:95], a[108:111]
    ds_read_b64 v[160:161], v17 offset:16192
    v_mfma_f32_16x16x32_bf16 a[112:115], v[124:127], v[92:95], a[112:115]
    ds_read_b64 v[162:163], v17 offset:16224
    v_mfma_f32_16x16x32_bf16 a[116:119], v[128:131], v[92:95], a[116:119]
    v_mfma_f32_16x16x32_bf16 a[120:123], v[108:111], v[96:99], a[120:123]
    v_mfma_f32_16x16x32_bf16 a[124:127], v[112:115], v[96:99], a[124:127]
    v_mfma_f32_16x16x32_bf16 a[128:131], v[116:119], v[96:99], a[128:131]
    v_mfma_f32_16x16x32_bf16 a[132:135], v[120:123], v[96:99], a[132:135]
    v_mfma_f32_16x16x32_bf16 a[136:139], v[124:127], v[96:99], a[136:139]
    v_mfma_f32_16x16x32_bf16 a[140:143], v[128:131], v[96:99], a[140:143]
    v_mfma_f32_16x16x32_bf16 a[144:147], v[108:111], v[100:103], a[144:147]
    v_mfma_f32_16x16x32_bf16 a[148:151], v[112:115], v[100:103], a[148:151]
    v_mfma_f32_16x16x32_bf16 a[152:155], v[116:119], v[100:103], a[152:155]
    v_mfma_f32_16x16x32_bf16 a[156:159], v[120:123], v[100:103], a[156:159]
    v_mfma_f32_16x16x32_bf16 a[160:163], v[124:127], v[100:103], a[160:163]
    v_mfma_f32_16x16x32_bf16 a[164:167], v[128:131], v[100:103], a[164:167]
    v_mfma_f32_16x16x32_bf16 a[168:171], v[108:111], v[104:107], a[168:171]
    v_mfma_f32_16x16x32_bf16 a[172:175], v[112:115], v[104:107], a[172:175]
    v_mfma_f32_16x16x32_bf16 a[176:179], v[116:119], v[104:107], a[176:179]
    v_mfma_f32_16x16x32_bf16 a[180:183], v[120:123], v[104:107], a[180:183]
    v_mfma_f32_16x16x32_bf16 a[184:187], v[124:127], v[104:107], a[184:187]
    v_mfma_f32_16x16x32_bf16 a[188:191], v[128:131], v[104:107], a[188:191]
    s_waitcnt lgkmcnt(0)
    s_waitcnt vmcnt(14)
    v_mfma_f32_16x16x32_bf16 a[0:3], v[164:167], v[132:135], a[0:3]
    ds_write_b128 v12, v[20:23] offset:0
    v_mfma_f32_16x16x32_bf16 a[4:7], v[168:171], v[132:135], a[4:7]
    ds_write_b128 v12, v[24:27] offset:4608
    v_mfma_f32_16x16x32_bf16 a[8:11], v[172:175], v[132:135], a[8:11]
    ds_write_b128 v12, v[28:31] offset:9216
    v_mfma_f32_16x16x32_bf16 a[12:15], v[176:179], v[132:135], a[12:15]
    ds_write_b128 v12, v[32:35] offset:13824
    v_mfma_f32_16x16x32_bf16 a[16:19], v[180:183], v[132:135], a[16:19]
    ds_write_b128 v12, v[36:39] offset:18432
    v_mfma_f32_16x16x32_bf16 a[20:23], v[184:187], v[132:135], a[20:23]
    ds_write_b128 v12, v[40:43] offset:23040
    v_mfma_f32_16x16x32_bf16 a[24:27], v[164:167], v[136:139], a[24:27]
    ds_write_b128 v12, v[44:47] offset:27648
    v_mfma_f32_16x16x32_bf16 a[28:31], v[168:171], v[136:139], a[28:31]
    ds_write_b128 v12, v[48:51] offset:32256
    v_mfma_f32_16x16x32_bf16 a[32:35], v[172:175], v[136:139], a[32:35]
    ds_write_b128 v14, v[52:55] offset:0
    v_mfma_f32_16x16x32_bf16 a[36:39], v[176:179], v[136:139], a[36:39]
    ds_write_b128 v14, v[56:59] offset:128
    v_mfma_f32_16x16x32_bf16 a[40:43], v[180:183], v[136:139], a[40:43]
    ds_write_b128 v14, v[60:63] offset:256
    v_mfma_f32_16x16x32_bf16 a[44:47], v[184:187], v[136:139], a[44:47]
    ds_write_b128 v14, v[64:67] offset:13312
    v_mfma_f32_16x16x32_bf16 a[48:51], v[164:167], v[140:143], a[48:51]
    ds_write_b128 v14, v[68:71] offset:13440
    v_mfma_f32_16x16x32_bf16 a[52:55], v[168:171], v[140:143], a[52:55]
    ds_write_b128 v14, v[72:75] offset:13568
    v_mfma_f32_16x16x32_bf16 a[56:59], v[172:175], v[140:143], a[56:59]
    v_mfma_f32_16x16x32_bf16 a[60:63], v[176:179], v[140:143], a[60:63]
    s_waitcnt lgkmcnt(0)
    s_barrier
    v_mfma_f32_16x16x32_bf16 a[64:67], v[180:183], v[140:143], a[64:67]
    ds_read_b64_tr_b16 v[108:109], v18 offset:0
    ds_read_b64_tr_b16 v[110:111], v18 offset:6656
    v_mfma_f32_16x16x32_bf16 a[68:71], v[184:187], v[140:143], a[68:71]
    buffer_load_dwordx4 v[20:23], v2, s[8:11], s20 offen
    ds_read_b64_tr_b16 v[112:113], v18 offset:32
    v_mfma_f32_16x16x32_bf16 a[72:75], v[164:167], v[144:147], a[72:75]
    ds_read_b64_tr_b16 v[114:115], v18 offset:6688
    buffer_load_dwordx4 v[24:27], v3, s[8:11], s20 offen
    v_mfma_f32_16x16x32_bf16 a[76:79], v[168:171], v[144:147], a[76:79]
    ds_read_b64_tr_b16 v[116:117], v18 offset:64
    ds_read_b64_tr_b16 v[118:119], v18 offset:6720
    v_mfma_f32_16x16x32_bf16 a[80:83], v[172:175], v[144:147], a[80:83]
    buffer_load_dwordx4 v[28:31], v4, s[8:11], s20 offen
    ds_read_b64_tr_b16 v[120:121], v18 offset:96
    v_mfma_f32_16x16x32_bf16 a[84:87], v[176:179], v[144:147], a[84:87]
    ds_read_b64_tr_b16 v[122:123], v18 offset:6752
    buffer_load_dwordx4 v[32:35], v5, s[8:11], s20 offen
    v_mfma_f32_16x16x32_bf16 a[88:91], v[180:183], v[144:147], a[88:91]
    ds_read_b64_tr_b16 v[124:125], v18 offset:128
    ds_read_b64_tr_b16 v[126:127], v18 offset:6784
    v_mfma_f32_16x16x32_bf16 a[92:95], v[184:187], v[144:147], a[92:95]
    buffer_load_dwordx4 v[36:39], v6, s[8:11], s20 offen
    ds_read_b64_tr_b16 v[128:129], v18 offset:160
    v_mfma_f32_16x16x32_bf16 a[96:99], v[164:167], v[148:151], a[96:99]
    ds_read_b64_tr_b16 v[130:131], v18 offset:6816
    buffer_load_dwordx4 v[40:43], v7, s[8:11], s20 offen
    v_mfma_f32_16x16x32_bf16 a[100:103], v[168:171], v[148:151], a[100:103]
    ds_read_b64 v[76:77], v16 offset:0
    ds_read_b64 v[78:79], v16 offset:32
    v_mfma_f32_16x16x32_bf16 a[104:107], v[172:175], v[148:151], a[104:107]
    buffer_load_dwordx4 v[44:47], v8, s[8:11], s20 offen
    ds_read_b64 v[80:81], v16 offset:2304
    v_mfma_f32_16x16x32_bf16 a[108:111], v[176:179], v[148:151], a[108:111]
    ds_read_b64 v[82:83], v16 offset:2336
    buffer_load_dwordx4 v[48:51], v9, s[8:11], s20 offen
    v_mfma_f32_16x16x32_bf16 a[112:115], v[180:183], v[148:151], a[112:115]
    ds_read_b64 v[84:85], v16 offset:4608
    ds_read_b64 v[86:87], v16 offset:4640
    v_mfma_f32_16x16x32_bf16 a[116:119], v[184:187], v[148:151], a[116:119]
    buffer_load_dwordx4 v[52:55], v10, s[12:15], s21 offen offset:0
    ds_read_b64 v[88:89], v16 offset:6912
    v_mfma_f32_16x16x32_bf16 a[120:123], v[164:167], v[152:155], a[120:123]
    ds_read_b64 v[90:91], v16 offset:6944
    buffer_load_dwordx4 v[56:59], v10, s[12:15], s21 offen offset:128
    v_mfma_f32_16x16x32_bf16 a[124:127], v[168:171], v[152:155], a[124:127]
    ds_read_b64 v[92:93], v16 offset:9216
    ds_read_b64 v[94:95], v16 offset:9248
    v_mfma_f32_16x16x32_bf16 a[128:131], v[172:175], v[152:155], a[128:131]
    buffer_load_dwordx4 v[60:63], v10, s[12:15], s21 offen offset:256
    ds_read_b64 v[96:97], v16 offset:11520
    v_mfma_f32_16x16x32_bf16 a[132:135], v[176:179], v[152:155], a[132:135]
    ds_read_b64 v[98:99], v16 offset:11552
    buffer_load_dwordx4 v[64:67], v11, s[12:15], s21 offen offset:0
    v_mfma_f32_16x16x32_bf16 a[136:139], v[180:183], v[152:155], a[136:139]
    ds_read_b64 v[100:101], v16 offset:13824
    ds_read_b64 v[102:103], v16 offset:13856
    v_mfma_f32_16x16x32_bf16 a[140:143], v[184:187], v[152:155], a[140:143]
    buffer_load_dwordx4 v[68:71], v11, s[12:15], s21 offen offset:128
    ds_read_b64 v[104:105], v16 offset:16128
    v_mfma_f32_16x16x32_bf16 a[144:147], v[164:167], v[156:159], a[144:147]
    ds_read_b64 v[106:107], v16 offset:16160
    buffer_load_dwordx4 v[72:75], v11, s[12:15], s21 offen offset:256
    v_mfma_f32_16x16x32_bf16 a[148:151], v[168:171], v[156:159], a[148:151]
    v_mfma_f32_16x16x32_bf16 a[152:155], v[172:175], v[156:159], a[152:155]
    v_mfma_f32_16x16x32_bf16 a[156:159], v[176:179], v[156:159], a[156:159]
    v_mfma_f32_16x16x32_bf16 a[160:163], v[180:183], v[156:159], a[160:163]
    v_mfma_f32_16x16x32_bf16 a[164:167], v[184:187], v[156:159], a[164:167]
    v_mfma_f32_16x16x32_bf16 a[168:171], v[164:167], v[160:163], a[168:171]
    v_mfma_f32_16x16x32_bf16 a[172:175], v[168:171], v[160:163], a[172:175]
    v_mfma_f32_16x16x32_bf16 a[176:179], v[172:175], v[160:163], a[176:179]
    v_mfma_f32_16x16x32_bf16 a[180:183], v[176:179], v[160:163], a[180:183]
    v_mfma_f32_16x16x32_bf16 a[184:187], v[180:183], v[160:163], a[184:187]
    v_mfma_f32_16x16x32_bf16 a[188:191], v[184:187], v[160:163], a[188:191]
    s_add_u32 s20, s20, 128
    s_add_u32 s21, s21, 786432
    s_sub_u32 s22, s22, 1
    s_cmp_eq_u32 s22, 0
    s_waitcnt lgkmcnt(0)
    s_cbranch_scc0 mvu_loop
mvu_done:
    s_waitcnt vmcnt(0)
    s_nop 7
    v_lshrrev_b32 v60, 4, v0
    v_and_b32 v61, 15, v0
    v_mul_u32_u24 v2, 1280, v60
    v_lshl_add_u32 v2, v61, 4, v2
    v_mul_u32_u24 v3, 288, v60
    v_lshl_add_u32 v3, v61, 4, v3
    v_add_u32 v3, 102400, v3
    v_and_b32 v60, 15, v0
    v_bfe_u32 v61, v0, 4, 2
    v_lshrrev_b32 v62, 7, v0
    v_bfe_u32 v63, v0, 6, 1
    v_lshl_add_u32 v64, v62, 7, v60
    v_mul_u32_u24 v4, 400, v64
    v_lshl_add_u32 v5, v61, 3, v4
    v_mul_u32_u24 v64, 192, v63
    v_add_u32 v6, v64, v5
    v_lshrrev_b32 v64, 2, v60
    v_lshl_add_u32 v64, v61, 2, v64
    v_mul_u32_u24 v7, 288, v64
    v_and_b32 v64, 3, v60
    v_lshl_add_u32 v7, v64, 3, v7
    v_lshl_add_u32 v7, v63, 7, v7
    v_add_u32 v7, 102400, v7
    s_add_u32 s77, s76, 0
    buffer_load_dwordx4 v[188:191], v2, s[28:31], s77 offen
    s_add_u32 s77, s76, 20480
    buffer_load_dwordx4 v[192:195], v2, s[28:31], s77 offen
    s_add_u32 s77, s76, 40960
    buffer_load_dwordx4 v[196:199], v2, s[28:31], s77 offen
    s_add_u32 s77, s76, 61440
    buffer_load_dwordx4 v[200:203], v2, s[28:31], s77 offen
    s_add_u32 s77, s76, 81920
    buffer_load_dwordx4 v[204:207], v2, s[28:31], s77 offen
    s_add_u32 s77, s76, 102400
    buffer_load_dwordx4 v[208:211], v2, s[28:31], s77 offen
    s_add_u32 s77, s76, 122880
    buffer_load_dwordx4 v[212:215], v2, s[28:31], s77 offen
    s_add_u32 s77, s76, 143360
    buffer_load_dwordx4 v[216:219], v2, s[28:31], s77 offen
    s_add_u32 s77, s76, 163840
    buffer_load_dwordx4 v[220:223], v2, s[28:31], s77 offen
    s_add_u32 s77, s76, 184320
    buffer_load_dwordx4 v[224:227], v2, s[28:31], s77 offen
    s_add_u32 s77, s76, 204800
    buffer_load_dwordx4 v[228:231], v2, s[28:31], s77 offen
    s_add_u32 s77, s76, 225280
    buffer_load_dwordx4 v[232:235], v2, s[28:31], s77 offen
    s_add_u32 s76, s76, 256
    s_barrier
    v_accvgpr_read_b32 v148, a0
    v_accvgpr_read_b32 v149, a1
    v_accvgpr_read_b32 v150, a2
    v_accvgpr_read_b32 v151, a3
    v_cvt_pk_bf16_f32 v76, v148, v149
    v_cvt_pk_bf16_f32 v77, v150, v151
    ds_write_b64 v6, v[76:77] offset:0
    v_accvgpr_read_b32 v152, a4
    v_accvgpr_read_b32 v153, a5
    v_accvgpr_read_b32 v154, a6
    v_accvgpr_read_b32 v155, a7
    v_cvt_pk_bf16_f32 v78, v152, v153
    v_cvt_pk_bf16_f32 v79, v154, v155
    ds_write_b64 v6, v[78:79] offset:32
    v_accvgpr_read_b32 v148, a8
    v_accvgpr_read_b32 v149, a9
    v_accvgpr_read_b32 v150, a10
    v_accvgpr_read_b32 v151, a11
    v_cvt_pk_bf16_f32 v80, v148, v149
    v_cvt_pk_bf16_f32 v81, v150, v151
    ds_write_b64 v6, v[80:81] offset:64
    v_accvgpr_read_b32 v152, a12
    v_accvgpr_read_b32 v153, a13
    v_accvgpr_read_b32 v154, a14
    v_accvgpr_read_b32 v155, a15
    v_cvt_pk_bf16_f32 v82, v152, v153
    v_cvt_pk_bf16_f32 v83, v154, v155
    ds_write_b64 v6, v[82:83] offset:96
    v_accvgpr_read_b32 v148, a16
    v_accvgpr_read_b32 v149, a17
    v_accvgpr_read_b32 v150, a18
    v_accvgpr_read_b32 v151, a19
    v_cvt_pk_bf16_f32 v84, v148, v149
    v_cvt_pk_bf16_f32 v85, v150, v151
    ds_write_b64 v6, v[84:85] offset:128
    v_accvgpr_read_b32 v152, a20
    v_accvgpr_read_b32 v153, a21
    v_accvgpr_read_b32 v154, a22
    v_accvgpr_read_b32 v155, a23
    v_cvt_pk_bf16_f32 v86, v152, v153
    v_cvt_pk_bf16_f32 v87, v154, v155
    ds_write_b64 v6, v[86:87] offset:160
    v_accvgpr_read_b32 v148, a24
    v_accvgpr_read_b32 v149, a25
    v_accvgpr_read_b32 v150, a26
    v_accvgpr_read_b32 v151, a27
    v_cvt_pk_bf16_f32 v88, v148, v149
    v_cvt_pk_bf16_f32 v89, v150, v151
    ds_write_b64 v6, v[88:89] offset:6400
    v_accvgpr_read_b32 v152, a28
    v_accvgpr_read_b32 v153, a29
    v_accvgpr_read_b32 v154, a30
    v_accvgpr_read_b32 v155, a31
    v_cvt_pk_bf16_f32 v90, v152, v153
    v_cvt_pk_bf16_f32 v91, v154, v155
    ds_write_b64 v6, v[90:91] offset:6432
    v_accvgpr_read_b32 v148, a32
    v_accvgpr_read_b32 v149, a33
    v_accvgpr_read_b32 v150, a34
    v_accvgpr_read_b32 v151, a35
    v_cvt_pk_bf16_f32 v92, v148, v149
    v_cvt_pk_bf16_f32 v93, v150, v151
    ds_write_b64 v6, v[92:93] offset:6464
    v_accvgpr_read_b32 v152, a36
    v_accvgpr_read_b32 v153, a37
    v_accvgpr_read_b32 v154, a38
    v_accvgpr_read_b32 v155, a39
    v_cvt_pk_bf16_f32 v94, v152, v153
    v_cvt_pk_bf16_f32 v95, v154, v155
    ds_write_b64 v6, v[94:95] offset:6496
    v_accvgpr_read_b32 v148, a40
    v_accvgpr_read_b32 v149, a41
    v_accvgpr_read_b32 v150, a42
    v_accvgpr_read_b32 v151, a43
    v_cvt_pk_bf16_f32 v96, v148, v149
    v_cvt_pk_bf16_f32 v97, v150, v151
    ds_write_b64 v6, v[96:97] offset:6528
    v_accvgpr_read_b32 v152, a44
    v_accvgpr_read_b32 v153, a45
    v_accvgpr_read_b32 v154, a46
    v_accvgpr_read_b32 v155, a47
    v_cvt_pk_bf16_f32 v98, v152, v153
    v_cvt_pk_bf16_f32 v99, v154, v155
    ds_write_b64 v6, v[98:99] offset:6560
    v_accvgpr_read_b32 v148, a48
    v_accvgpr_read_b32 v149, a49
    v_accvgpr_read_b32 v150, a50
    v_accvgpr_read_b32 v151, a51
    v_cvt_pk_bf16_f32 v100, v148, v149
    v_cvt_pk_bf16_f32 v101, v150, v151
    ds_write_b64 v6, v[100:101] offset:12800
    v_accvgpr_read_b32 v152, a52
    v_accvgpr_read_b32 v153, a53
    v_accvgpr_read_b32 v154, a54
    v_accvgpr_read_b32 v155, a55
    v_cvt_pk_bf16_f32 v102, v152, v153
    v_cvt_pk_bf16_f32 v103, v154, v155
    ds_write_b64 v6, v[102:103] offset:12832
    v_accvgpr_read_b32 v148, a56
    v_accvgpr_read_b32 v149, a57
    v_accvgpr_read_b32 v150, a58
    v_accvgpr_read_b32 v151, a59
    v_cvt_pk_bf16_f32 v104, v148, v149
    v_cvt_pk_bf16_f32 v105, v150, v151
    ds_write_b64 v6, v[104:105] offset:12864
    v_accvgpr_read_b32 v152, a60
    v_accvgpr_read_b32 v153, a61
    v_accvgpr_read_b32 v154, a62
    v_accvgpr_read_b32 v155, a63
    v_cvt_pk_bf16_f32 v106, v152, v153
    v_cvt_pk_bf16_f32 v107, v154, v155
    ds_write_b64 v6, v[106:107] offset:12896
    v_accvgpr_read_b32 v148, a64
    v_accvgpr_read_b32 v149, a65
    v_accvgpr_read_b32 v150, a66
    v_accvgpr_read_b32 v151, a67
    v_cvt_pk_bf16_f32 v76, v148, v149
    v_cvt_pk_bf16_f32 v77, v150, v151
    ds_write_b64 v6, v[76:77] offset:12928
    v_accvgpr_read_b32 v152, a68
    v_accvgpr_read_b32 v153, a69
    v_accvgpr_read_b32 v154, a70
    v_accvgpr_read_b32 v155, a71
    v_cvt_pk_bf16_f32 v78, v152, v153
    v_cvt_pk_bf16_f32 v79, v154, v155
    ds_write_b64 v6, v[78:79] offset:12960
    v_accvgpr_read_b32 v148, a72
    v_accvgpr_read_b32 v149, a73
    v_accvgpr_read_b32 v150, a74
    v_accvgpr_read_b32 v151, a75
    v_cvt_pk_bf16_f32 v80, v148, v149
    v_cvt_pk_bf16_f32 v81, v150, v151
    ds_write_b64 v6, v[80:81] offset:19200
    v_accvgpr_read_b32 v152, a76
    v_accvgpr_read_b32 v153, a77
    v_accvgpr_read_b32 v154, a78
    v_accvgpr_read_b32 v155, a79
    v_cvt_pk_bf16_f32 v82, v152, v153
    v_cvt_pk_bf16_f32 v83, v154, v155
    ds_write_b64 v6, v[82:83] offset:19232
    v_accvgpr_read_b32 v148, a80
    v_accvgpr_read_b32 v149, a81
    v_accvgpr_read_b32 v150, a82
    v_accvgpr_read_b32 v151, a83
    v_cvt_pk_bf16_f32 v84, v148, v149
    v_cvt_pk_bf16_f32 v85, v150, v151
    ds_write_b64 v6, v[84:85] offset:19264
    v_accvgpr_read_b32 v152, a84
    v_accvgpr_read_b32 v153, a85
    v_accvgpr_read_b32 v154, a86
    v_accvgpr_read_b32 v155, a87
    v_cvt_pk_bf16_f32 v86, v152, v153
    v_cvt_pk_bf16_f32 v87, v154, v155
    ds_write_b64 v6, v[86:87] offset:19296
    v_accvgpr_read_b32 v148, a88
    v_accvgpr_read_b32 v149, a89
    v_accvgpr_read_b32 v150, a90
    v_accvgpr_read_b32 v151, a91
    v_cvt_pk_bf16_f32 v88, v148, v149
    v_cvt_pk_bf16_f32 v89, v150, v151
    ds_write_b64 v6, v[88:89] offset:19328
    v_accvgpr_read_b32 v152, a92
    v_accvgpr_read_b32 v153, a93
    v_accvgpr_read_b32 v154, a94
    v_accvgpr_read_b32 v155, a95
    v_cvt_pk_bf16_f32 v90, v152, v153
    v_cvt_pk_bf16_f32 v91, v154, v155
    ds_write_b64 v6, v[90:91] offset:19360
    v_accvgpr_read_b32 v148, a96
    v_accvgpr_read_b32 v149, a97
    v_accvgpr_read_b32 v150, a98
    v_accvgpr_read_b32 v151, a99
    v_cvt_pk_bf16_f32 v92, v148, v149
    v_cvt_pk_bf16_f32 v93, v150, v151
    ds_write_b64 v6, v[92:93] offset:25600
    v_accvgpr_read_b32 v152, a100
    v_accvgpr_read_b32 v153, a101
    v_accvgpr_read_b32 v154, a102
    v_accvgpr_read_b32 v155, a103
    v_cvt_pk_bf16_f32 v94, v152, v153
    v_cvt_pk_bf16_f32 v95, v154, v155
    ds_write_b64 v6, v[94:95] offset:25632
    v_accvgpr_read_b32 v148, a104
    v_accvgpr_read_b32 v149, a105
    v_accvgpr_read_b32 v150, a106
    v_accvgpr_read_b32 v151, a107
    v_cvt_pk_bf16_f32 v96, v148, v149
    v_cvt_pk_bf16_f32 v97, v150, v151
    ds_write_b64 v6, v[96:97] offset:25664
    v_accvgpr_read_b32 v152, a108
    v_accvgpr_read_b32 v153, a109
    v_accvgpr_read_b32 v154, a110
    v_accvgpr_read_b32 v155, a111
    v_cvt_pk_bf16_f32 v98, v152, v153
    v_cvt_pk_bf16_f32 v99, v154, v155
    ds_write_b64 v6, v[98:99] offset:25696
    v_accvgpr_read_b32 v148, a112
    v_accvgpr_read_b32 v149, a113
    v_accvgpr_read_b32 v150, a114
    v_accvgpr_read_b32 v151, a115
    v_cvt_pk_bf16_f32 v100, v148, v149
    v_cvt_pk_bf16_f32 v101, v150, v151
    ds_write_b64 v6, v[100:101] offset:25728
    v_accvgpr_read_b32 v152, a116
    v_accvgpr_read_b32 v153, a117
    v_accvgpr_read_b32 v154, a118
    v_accvgpr_read_b32 v155, a119
    v_cvt_pk_bf16_f32 v102, v152, v153
    v_cvt_pk_bf16_f32 v103, v154, v155
    ds_write_b64 v6, v[102:103] offset:25760
    v_accvgpr_read_b32 v148, a120
    v_accvgpr_read_b32 v149, a121
    v_accvgpr_read_b32 v150, a122
    v_accvgpr_read_b32 v151, a123
    v_cvt_pk_bf16_f32 v104, v148, v149
    v_cvt_pk_bf16_f32 v105, v150, v151
    ds_write_b64 v6, v[104:105] offset:32000
    v_accvgpr_read_b32 v152, a124
    v_accvgpr_read_b32 v153, a125
    v_accvgpr_read_b32 v154, a126
    v_accvgpr_read_b32 v155, a127
    v_cvt_pk_bf16_f32 v106, v152, v153
    v_cvt_pk_bf16_f32 v107, v154, v155
    ds_write_b64 v6, v[106:107] offset:32032
    v_accvgpr_read_b32 v148, a128
    v_accvgpr_read_b32 v149, a129
    v_accvgpr_read_b32 v150, a130
    v_accvgpr_read_b32 v151, a131
    v_cvt_pk_bf16_f32 v76, v148, v149
    v_cvt_pk_bf16_f32 v77, v150, v151
    ds_write_b64 v6, v[76:77] offset:32064
    v_accvgpr_read_b32 v152, a132
    v_accvgpr_read_b32 v153, a133
    v_accvgpr_read_b32 v154, a134
    v_accvgpr_read_b32 v155, a135
    v_cvt_pk_bf16_f32 v78, v152, v153
    v_cvt_pk_bf16_f32 v79, v154, v155
    ds_write_b64 v6, v[78:79] offset:32096
    v_accvgpr_read_b32 v148, a136
    v_accvgpr_read_b32 v149, a137
    v_accvgpr_read_b32 v150, a138
    v_accvgpr_read_b32 v151, a139
    v_cvt_pk_bf16_f32 v80, v148, v149
    v_cvt_pk_bf16_f32 v81, v150, v151
    ds_write_b64 v6, v[80:81] offset:32128
    v_accvgpr_read_b32 v152, a140
    v_accvgpr_read_b32 v153, a141
    v_accvgpr_read_b32 v154, a142
    v_accvgpr_read_b32 v155, a143
    v_cvt_pk_bf16_f32 v82, v152, v153
    v_cvt_pk_bf16_f32 v83, v154, v155
    ds_write_b64 v6, v[82:83] offset:32160
    v_accvgpr_read_b32 v148, a144
    v_accvgpr_read_b32 v149, a145
    v_accvgpr_read_b32 v150, a146
    v_accvgpr_read_b32 v151, a147
    v_cvt_pk_bf16_f32 v84, v148, v149
    v_cvt_pk_bf16_f32 v85, v150, v151
    ds_write_b64 v6, v[84:85] offset:38400
    v_accvgpr_read_b32 v152, a148
    v_accvgpr_read_b32 v153, a149
    v_accvgpr_read_b32 v154, a150
    v_accvgpr_read_b32 v155, a151
    v_cvt_pk_bf16_f32 v86, v152, v153
    v_cvt_pk_bf16_f32 v87, v154, v155
    ds_write_b64 v6, v[86:87] offset:38432
    v_accvgpr_read_b32 v148, a152
    v_accvgpr_read_b32 v149, a153
    v_accvgpr_read_b32 v150, a154
    v_accvgpr_read_b32 v151, a155
    v_cvt_pk_bf16_f32 v88, v148, v149
    v_cvt_pk_bf16_f32 v89, v150, v151
    ds_write_b64 v6, v[88:89] offset:38464
    v_accvgpr_read_b32 v152, a156
    v_accvgpr_read_b32 v153, a157
    v_accvgpr_read_b32 v154, a158
    v_accvgpr_read_b32 v155, a159
    v_cvt_pk_bf16_f32 v90, v152, v153
    v_cvt_pk_bf16_f32 v91, v154, v155
    ds_write_b64 v6, v[90:91] offset:38496
    v_accvgpr_read_b32 v148, a160
    v_accvgpr_read_b32 v149, a161
    v_accvgpr_read_b32 v150, a162
    v_accvgpr_read_b32 v151, a163
    v_cvt_pk_bf16_f32 v92, v148, v149
    v_cvt_pk_bf16_f32 v93, v150, v151
    ds_write_b64 v6, v[92:93] offset:38528
    v_accvgpr_read_b32 v152, a164
    v_accvgpr_read_b32 v153, a165
    v_accvgpr_read_b32 v154, a166
    v_accvgpr_read_b32 v155, a167
    v_cvt_pk_bf16_f32 v94, v152, v153
    v_cvt_pk_bf16_f32 v95, v154, v155
    ds_write_b64 v6, v[94:95] offset:38560
    v_accvgpr_read_b32 v148, a168
    v_accvgpr_read_b32 v149, a169
    v_accvgpr_read_b32 v150, a170
    v_accvgpr_read_b32 v151, a171
    v_cvt_pk_bf16_f32 v96, v148, v149
    v_cvt_pk_bf16_f32 v97, v150, v151
    ds_write_b64 v6, v[96:97] offset:44800
    v_accvgpr_read_b32 v152, a172
    v_accvgpr_read_b32 v153, a173
    v_accvgpr_read_b32 v154, a174
    v_accvgpr_read_b32 v155, a175
    v_cvt_pk_bf16_f32 v98, v152, v153
    v_cvt_pk_bf16_f32 v99, v154, v155
    ds_write_b64 v6, v[98:99] offset:44832
    v_accvgpr_read_b32 v148, a176
    v_accvgpr_read_b32 v149, a177
    v_accvgpr_read_b32 v150, a178
    v_accvgpr_read_b32 v151, a179
    v_cvt_pk_bf16_f32 v100, v148, v149
    v_cvt_pk_bf16_f32 v101, v150, v151
    ds_write_b64 v6, v[100:101] offset:44864
    v_accvgpr_read_b32 v152, a180
    v_accvgpr_read_b32 v153, a181
    v_accvgpr_read_b32 v154, a182
    v_accvgpr_read_b32 v155, a183
    v_cvt_pk_bf16_f32 v102, v152, v153
    v_cvt_pk_bf16_f32 v103, v154, v155
    ds_write_b64 v6, v[102:103] offset:44896
    v_accvgpr_read_b32 v148, a184
    v_accvgpr_read_b32 v149, a185
    v_accvgpr_read_b32 v150, a186
    v_accvgpr_read_b32 v151, a187
    v_cvt_pk_bf16_f32 v104, v148, v149
    v_cvt_pk_bf16_f32 v105, v150, v151
    ds_write_b64 v6, v[104:105] offset:44928
    v_accvgpr_read_b32 v152, a188
    v_accvgpr_read_b32 v153, a189
    v_accvgpr_read_b32 v154, a190
    v_accvgpr_read_b32 v155, a191
    v_cvt_pk_bf16_f32 v106, v152, v153
    v_cvt_pk_bf16_f32 v107, v154, v155
    ds_write_b64 v6, v[106:107] offset:44960
    s_mov_b32 s78, s73
mvu2_chunk:
    s_waitcnt vmcnt(0) lgkmcnt(0)
    s_barrier
    ds_write_b128 v3, v[188:191] offset:0
    ds_write_b128 v3, v[192:195] offset:4608
    ds_write_b128 v3, v[196:199] offset:9216
    ds_write_b128 v3, v[200:203] offset:13824
    ds_write_b128 v3, v[204:207] offset:18432
    ds_write_b128 v3, v[208:211] offset:23040
    ds_write_b128 v3, v[212:215] offset:27648
    ds_write_b128 v3, v[216:219] offset:32256
    ds_write_b128 v3, v[220:223] offset:36864
    ds_write_b128 v3, v[224:227] offset:41472
    ds_write_b128 v3, v[228:231] offset:46080
    ds_write_b128 v3, v[232:235] offset:50688
    s_waitcnt lgkmcnt(0)
    s_barrier
    s_add_u32 s77, s76, 0
    buffer_load_dwordx4 v[188:191], v2, s[28:31], s77 offen
    s_add_u32 s77, s76, 20480
    buffer_load_dwordx4 v[192:195], v2, s[28:31], s77 offen
    s_add_u32 s77, s76, 40960
    buffer_load_dwordx4 v[196:199], v2, s[28:31], s77 offen
    s_add_u32 s77, s76, 61440
    buffer_load_dwordx4 v[200:203], v2, s[28:31], s77 offen
    s_add_u32 s77, s76, 81920
    buffer_load_dwordx4 v[204:207], v2, s[28:31], s77 offen
    s_add_u32 s77, s76, 102400
    buffer_load_dwordx4 v[208:211], v2, s[28:31], s77 offen
    s_add_u32 s77, s76, 122880
    buffer_load_dwordx4 v[212:215], v2, s[28:31], s77 offen
    s_add_u32 s77, s76, 143360
    buffer_load_dwordx4 v[216:219], v2, s[28:31], s77 offen
    s_add_u32 s77, s76, 163840
    buffer_load_dwordx4 v[220:223], v2, s[28:31], s77 offen
    s_add_u32 s77, s76, 184320
    buffer_load_dwordx4 v[224:227], v2, s[28:31], s77 offen
    s_add_u32 s77, s76, 204800
    buffer_load_dwordx4 v[228:231], v2, s[28:31], s77 offen
    s_add_u32 s77, s76, 225280
    buffer_load_dwordx4 v[232:235], v2, s[28:31], s77 offen
    s_add_u32 s76, s76, 256
    ds_read_b64_tr_b16 v[108:109], v7 offset:0
    ds_read_b64_tr_b16 v[110:111], v7 offset:4608
    ds_read_b64_tr_b16 v[112:113], v7 offset:32
    ds_read_b64_tr_b16 v[114:115], v7 offset:4640
    ds_read_b64_tr_b16 v[116:117], v7 offset:64
    ds_read_b64_tr_b16 v[118:119], v7 offset:4672
    ds_read_b64_tr_b16 v[120:121], v7 offset:96
    ds_read_b64_tr_b16 v[122:123], v7 offset:4704
    ds_read_b64 v[76:77], v5 offset:0
    ds_read_b64 v[78:79], v5 offset:32
    ds_read_b64 v[80:81], v5 offset:6400
    ds_read_b64 v[82:83], v5 offset:6432
    ds_read_b64 v[84:85], v5 offset:12800
    ds_read_b64 v[86:87], v5 offset:12832
    ds_read_b64 v[88:89], v5 offset:19200
    ds_read_b64 v[90:91], v5 offset:19232
    ds_read_b64 v[92:93], v5 offset:25600
    ds_read_b64 v[94:95], v5 offset:25632
    ds_read_b64 v[96:97], v5 offset:32000
    ds_read_b64 v[98:99], v5 offset:32032
    ds_read_b64 v[100:101], v5 offset:38400
    ds_read_b64 v[102:103], v5 offset:38432
    ds_read_b64 v[104:105], v5 offset:44800
    ds_read_b64 v[106:107], v5 offset:44832
    s_waitcnt lgkmcnt(0)
    v_mfma_f32_16x16x32_bf16 a[0:3], v[76:79], v[108:111], 0
    v_mfma_f32_16x16x32_bf16 a[4:7], v[76:79], v[112:115], 0
    ds_read_b64_tr_b16 v[156:157], v7 offset:9216
    v_mfma_f32_16x16x32_bf16 a[8:11], v[76:79], v[116:119], 0
    ds_read_b64_tr_b16 v[158:159], v7 offset:13824
    v_mfma_f32_16x16x32_bf16 a[12:15], v[76:79], v[120:123], 0
    ds_read_b64_tr_b16 v[160:161], v7 offset:9248
    v_mfma_f32_16x16x32_bf16 a[16:19], v[80:83], v[108:111], 0
    ds_read_b64_tr_b16 v[162:163], v7 offset:13856
    v_mfma_f32_16x16x32_bf16 a[20:23], v[80:83], v[112:115], 0
    ds_read_b64_tr_b16 v[164:165], v7 offset:9280
    v_mfma_f32_16x16x32_bf16 a[24:27], v[80:83], v[116:119], 0
    ds_read_b64_tr_b16 v[166:167], v7 offset:13888
    v_mfma_f32_16x16x32_bf16 a[28:31], v[80:83], v[120:123], 0
    ds_read_b64_tr_b16 v[168:169], v7 offset:9312
    v_mfma_f32_16x16x32_bf16 a[32:35], v[84:87], v[108:111], 0
    ds_read_b64_tr_b16 v[170:171], v7 offset:13920
    v_mfma_f32_16x16x32_bf16 a[36:39], v[84:87], v[112:115], 0
    ds_read_b64 v[124:125], v5 offset:64
    v_mfma_f32_16x16x32_bf16 a[40:43], v[84:87], v[116:119], 0
    ds_read_b64 v[126:127], v5 offset:96
    v_mfma_f32_16x16x32_bf16 a[44:47], v[84:87], v[120:123], 0
    ds_read_b64 v[128:129], v5 offset:6464
    v_mfma_f32_16x16x32_bf16 a[48:51], v[88:91], v[108:111], 0
    ds_read_b64 v[130:131], v5 offset:6496
    v_mfma_f32_16x16x32_bf16 a[52:55], v[88:91], v[112:115], 0
    ds_read_b64 v[132:133], v5 offset:12864
    v_mfma_f32_16x16x32_bf16 a[56:59], v[88:91], v[116:119], 0
    ds_read_b64 v[134:135], v5 offset:12896
    v_mfma_f32_16x16x32_bf16 a[60:63], v[88:91], v[120:123], 0
    ds_read_b64 v[136:137], v5 offset:19264
    v_mfma_f32_16x16x32_bf16 a[64:67], v[92:95], v[108:111], 0
    ds_read_b64 v[138:139], v5 offset:19296
    v_mfma_f32_16x16x32_bf16 a[68:71], v[92:95], v[112:115], 0
    ds_read_b64 v[140:141], v5 offset:25664
    v_mfma_f32_16x16x32_bf16 a[72:75], v[92:95], v[116:119], 0
    ds_read_b64 v[142:143], v5 offset:25696
    v_mfma_f32_16x16x32_bf16 a[76:79], v[92:95], v[120:123], 0
    ds_read_b64 v[144:145], v5 offset:32064
    v_mfma_f32_16x16x32_bf16 a[80:83], v[96:99], v[108:111], 0
    ds_read_b64 v[146:147], v5 offset:32096
    v_mfma_f32_16x16x32_bf16 a[84:87], v[96:99], v[112:115], 0
    ds_read_b64 v[148:149], v5 offset:38464
    v_mfma_f32_16x16x32_bf16 a[88:91], v[96:99], v[116:119], 0
    ds_read_b64 v[150:151], v5 offset:38496
    v_mfma_f32_16x16x32_bf16 a[92:95], v[96:99], v[120:123], 0
    ds_read_b64 v[152:153], v5 offset:44864
    v_mfma_f32_16x16x32_bf16 a[96:99], v[100:103], v[108:111], 0
    ds_read_b64 v[154:155], v5 offset:44896
    v_mfma_f32_16x16x32_bf16 a[100:103], v[100:103], v[112:115], 0
    v_mfma_f32_16x16x32_bf16 a[104:107], v[100:103], v[116:119], 0
    v_mfma_f32_16x16x32_bf16 a[108:111], v[100:103], v[120:123], 0
    v_mfma_f32_16x16x32_bf16 a[112:115], v[104:107], v[108:111], 0
    v_mfma_f32_16x16x32_bf16 a[116:119], v[104:107], v[112:115], 0
    v_mfma_f32_16x16x32_bf16 a[120:123], v[104:107], v[116:119], 0
    v_mfma_f32_16x16x32_bf16 a[124:127], v[104:107], v[120:123], 0
    s_waitcnt lgkmcnt(0)
    v_mfma_f32_16x16x32_bf16 a[0:3], v[124:127], v[156:159], a[0:3]
    v_mfma_f32_16x16x32_bf16 a[4:7], v[124:127], v[160:163], a[4:7]
    ds_read_b64_tr_b16 v[108:109], v7 offset:18432
    v_mfma_f32_16x16x32_bf16 a[8:11], v[124:127], v[164:167], a[8:11]
    ds_read_b64_tr_b16 v[110:111], v7 offset:23040
    v_mfma_f32_16x16x32_bf16 a[12:15], v[124:127], v[168:171], a[12:15]
    ds_read_b64_tr_b16 v[112:113], v7 offset:18464
    v_mfma_f32_16x16x32_bf16 a[16:19], v[128:131], v[156:159], a[16:19]
    ds_read_b64_tr_b16 v[114:115], v7 offset:23072
    v_mfma_f32_16x16x32_bf16 a[20:23], v[128:131], v[160:163], a[20:23]
    ds_read_b64_tr_b16 v[116:117], v7 offset:18496
    v_mfma_f32_16x16x32_bf16 a[24:27], v[128:131], v[164:167], a[24:27]
    ds_read_b64_tr_b16 v[118:119], v7 offset:23104
    v_mfma_f32_16x16x32_bf16 a[28:31], v[128:131], v[168:171], a[28:31]
    ds_read_b64_tr_b16 v[120:121], v7 offset:18528
    v_mfma_f32_16x16x32_bf16 a[32:35], v[132:135], v[156:159], a[32:35]
    ds_read_b64_tr_b16 v[122:123], v7 offset:23136
    v_mfma_f32_16x16x32_bf16 a[36:39], v[132:135], v[160:163], a[36:39]
    ds_read_b64 v[76:77], v5 offset:128
    v_mfma_f32_16x16x32_bf16 a[40:43], v[132:135], v[164:167], a[40:43]
    ds_read_b64 v[78:79], v5 offset:160
    v_mfma_f32_16x16x32_bf16 a[44:47], v[132:135], v[168:171], a[44:47]
    ds_read_b64 v[80:81], v5 offset:6528
    v_mfma_f32_16x16x32_bf16 a[48:51], v[136:139], v[156:159], a[48:51]
    ds_read_b64 v[82:83], v5 offset:6560
    v_mfma_f32_16x16x32_bf16 a[52:55], v[136:139], v[160:163], a[52:55]
    ds_read_b64 v[84:85], v5 offset:12928
    v_mfma_f32_16x16x32_bf16 a[56:59], v[136:139], v[164:167], a[56:59]
    ds_read_b64 v[86:87], v5 offset:12960
    v_mfma_f32_16x16x32_bf16 a[60:63], v[136:139], v[168:171], a[60:63]
    ds_read_b64 v[88:89], v5 offset:19328
    v_mfma_f32_16x16x32_bf16 a[64:67], v[140:143], v[156:159], a[64:67]
    ds_read_b64 v[90:91], v5 offset:19360
    v_mfma_f32_16x16x32_bf16 a[68:71], v[140:143], v[160:163], a[68:71]
    ds_read_b64 v[92:93], v5 offset:25728
    v_mfma_f32_16x16x32_bf16 a[72:75], v[140:143], v[164:167], a[72:75]
    ds_read_b64 v[94:95], v5 offset:25760
    v_mfma_f32_16x16x32_bf16 a[76:79], v[140:143], v[168:171], a[76:79]
    ds_read_b64 v[96:97], v5 offset:32128
    v_mfma_f32_16x16x32_bf16 a[80:83], v[144:147], v[156:159], a[80:83]
    ds_read_b64 v[98:99], v5 offset:32160
    v_mfma_f32_16x16x32_bf16 a[84:87], v[144:147], v[160:163], a[84:87]
    ds_read_b64 v[100:101], v5 offset:38528
    v_mfma_f32_16x16x32_bf16 a[88:91], v[144:147], v[164:167], a[88:91]
    ds_read_b64 v[102:103], v5 offset:38560
    v_mfma_f32_16x16x32_bf16 a[92:95], v[144:147], v[168:171], a[92:95]
    ds_read_b64 v[104:105], v5 offset:44928
    v_mfma_f32_16x16x32_bf16 a[96:99], v[148:151], v[156:159], a[96:99]
    ds_read_b64 v[106:107], v5 offset:44960
    v_mfma_f32_16x16x32_bf16 a[100:103], v[148:151], v[160:163], a[100:103]
    v_mfma_f32_16x16x32_bf16 a[104:107], v[148:151], v[164:167], a[104:107]
    v_mfma_f32_16x16x32_bf16 a[108:111], v[148:151], v[168:171], a[108:111]
    v_mfma_f32_16x16x32_bf16 a[112:115], v[152:155], v[156:159], a[112:115]
    v_mfma_f32_16x16x32_bf16 a[116:119], v[152:155], v[160:163], a[116:119]
    v_mfma_f32_16x16x32_bf16 a[120:123], v[152:155], v[164:167], a[120:123]
    v_mfma_f32_16x16x32_bf16 a[124:127], v[152:155], v[168:171], a[124:127]
    s_waitcnt lgkmcnt(0)
    v_mfma_f32_16x16x32_bf16 a[0:3], v[76:79], v[108:111], a[0:3]
    v_mfma_f32_16x16x32_bf16 a[4:7], v[76:79], v[112:115], a[4:7]
    ds_read_b64_tr_b16 v[156:157], v7 offset:27648
    v_mfma_f32_16x16x32_bf16 a[8:11], v[76:79], v[116:119], a[8:11]
    ds_read_b64_tr_b16 v[158:159], v7 offset:32256
    v_mfma_f32_16x16x32_bf16 a[12:15], v[76:79], v[120:123], a[12:15]
    ds_read_b64_tr_b16 v[160:161], v7 offset:27680
    v_mfma_f32_16x16x32_bf16 a[16:19], v[80:83], v[108:111], a[16:19]
    ds_read_b64_tr_b16 v[162:163], v7 offset:32288
    v_mfma_f32_16x16x32_bf16 a[20:23], v[80:83], v[112:115], a[20:23]
    ds_read_b64_tr_b16 v[164:165], v7 offset:27712
    v_mfma_f32_16x16x32_bf16 a[24:27], v[80:83], v[116:119], a[24:27]
    ds_read_b64_tr_b16 v[166:167], v7 offset:32320
    v_mfma_f32_16x16x32_bf16 a[28:31], v[80:83], v[120:123], a[28:31]
    ds_read_b64_tr_b16 v[168:169], v7 offset:27744
    v_mfma_f32_16x16x32_bf16 a[32:35], v[84:87], v[108:111], a[32:35]
    ds_read_b64_tr_b16 v[170:171], v7 offset:32352
    v_mfma_f32_16x16x32_bf16 a[36:39], v[84:87], v[112:115], a[36:39]
    ds_read_b64 v[124:125], v5 offset:192
    v_mfma_f32_16x16x32_bf16 a[40:43], v[84:87], v[116:119], a[40:43]
    ds_read_b64 v[126:127], v5 offset:224
    v_mfma_f32_16x16x32_bf16 a[44:47], v[84:87], v[120:123], a[44:47]
    ds_read_b64 v[128:129], v5 offset:6592
    v_mfma_f32_16x16x32_bf16 a[48:51], v[88:91], v[108:111], a[48:51]
    ds_read_b64 v[130:131], v5 offset:6624
    v_mfma_f32_16x16x32_bf16 a[52:55], v[88:91], v[112:115], a[52:55]
    ds_read_b64 v[132:133], v5 offset:12992
    v_mfma_f32_16x16x32_bf16 a[56:59], v[88:91], v[116:119], a[56:59]
    ds_read_b64 v[134:135], v5 offset:13024
    v_mfma_f32_16x16x32_bf16 a[60:63], v[88:91], v[120:123], a[60:63]
    ds_read_b64 v[136:137], v5 offset:19392
    v_mfma_f32_16x16x32_bf16 a[64:67], v[92:95], v[108:111], a[64:67]
    ds_read_b64 v[138:139], v5 offset:19424
    v_mfma_f32_16x16x32_bf16 a[68:71], v[92:95], v[112:115], a[68:71]
    ds_read_b64 v[140:141], v5 offset:25792
    v_mfma_f32_16x16x32_bf16 a[72:75], v[92:95], v[116:119], a[72:75]
    ds_read_b64 v[142:143], v5 offset:25824
    v_mfma_f32_16x16x32_bf16 a[76:79], v[92:95], v[120:123], a[76:79]
    ds_read_b64 v[144:145], v5 offset:32192
    v_mfma_f32_16x16x32_bf16 a[80:83], v[96:99], v[108:111], a[80:83]
    ds_read_b64 v[146:147], v5 offset:32224
    v_mfma_f32_16x16x32_bf16 a[84:87], v[96:99], v[112:115], a[84:87]
    ds_read_b64 v[148:149], v5 offset:38592
    v_mfma_f32_16x16x32_bf16 a[88:91], v[96:99], v[116:119], a[88:91]
    ds_read_b64 v[150:151], v5 offset:38624
    v_mfma_f32_16x16x32_bf16 a[92:95], v[96:99], v[120:123], a[92:95]
    ds_read_b64 v[152:153], v5 offset:44992
    v_mfma_f32_16x16x32_bf16 a[96:99], v[100:103], v[108:111], a[96:99]
    ds_read_b64 v[154:155], v5 offset:45024
    v_mfma_f32_16x16x32_bf16 a[100:103], v[100:103], v[112:115], a[100:103]
    v_mfma_f32_16x16x32_bf16 a[104:107], v[100:103], v[116:119], a[104:107]
    v_mfma_f32_16x16x32_bf16 a[108:111], v[100:103], v[120:123], a[108:111]
    v_mfma_f32_16x16x32_bf16 a[112:115], v[104:107], v[108:111], a[112:115]
    v_mfma_f32_16x16x32_bf16 a[116:119], v[104:107], v[112:115], a[116:119]
    v_mfma_f32_16x16x32_bf16 a[120:123], v[104:107], v[116:119], a[120:123]
    v_mfma_f32_16x16x32_bf16 a[124:127], v[104:107], v[120:123], a[124:127]
    s_waitcnt lgkmcnt(0)
    v_mfma_f32_16x16x32_bf16 a[0:3], v[124:127], v[156:159], a[0:3]
    v_mfma_f32_16x16x32_bf16 a[4:7], v[124:127], v[160:163], a[4:7]
    ds_read_b64_tr_b16 v[108:109], v7 offset:36864
    v_mfma_f32_16x16x32_bf16 a[8:11], v[124:127], v[164:167], a[8:11]
    ds_read_b64_tr_b16 v[110:111], v7 offset:41472
    v_mfma_f32_16x16x32_bf16 a[12:15], v[124:127], v[168:171], a[12:15]
    ds_read_b64_tr_b16 v[112:113], v7 offset:36896
    v_mfma_f32_16x16x32_bf16 a[16:19], v[128:131], v[156:159], a[16:19]
    ds_read_b64_tr_b16 v[114:115], v7 offset:41504
    v_mfma_f32_16x16x32_bf16 a[20:23], v[128:131], v[160:163], a[20:23]
    ds_read_b64_tr_b16 v[116:117], v7 offset:36928
    v_mfma_f32_16x16x32_bf16 a[24:27], v[128:131], v[164:167], a[24:27]
    ds_read_b64_tr_b16 v[118:119], v7 offset:41536
    v_mfma_f32_16x16x32_bf16 a[28:31], v[128:131], v[168:171], a[28:31]
    ds_read_b64_tr_b16 v[120:121], v7 offset:36960
    v_mfma_f32_16x16x32_bf16 a[32:35], v[132:135], v[156:159], a[32:35]
    ds_read_b64_tr_b16 v[122:123], v7 offset:41568
    v_mfma_f32_16x16x32_bf16 a[36:39], v[132:135], v[160:163], a[36:39]
    ds_read_b64 v[76:77], v5 offset:256
    v_mfma_f32_16x16x32_bf16 a[40:43], v[132:135], v[164:167], a[40:43]
    ds_read_b64 v[78:79], v5 offset:288
    v_mfma_f32_16x16x32_bf16 a[44:47], v[132:135], v[168:171], a[44:47]
    ds_read_b64 v[80:81], v5 offset:6656
    v_mfma_f32_16x16x32_bf16 a[48:51], v[136:139], v[156:159], a[48:51]
    ds_read_b64 v[82:83], v5 offset:6688
    v_mfma_f32_16x16x32_bf16 a[52:55], v[136:139], v[160:163], a[52:55]
    ds_read_b64 v[84:85], v5 offset:13056
    v_mfma_f32_16x16x32_bf16 a[56:59], v[136:139], v[164:167], a[56:59]
    ds_read_b64 v[86:87], v5 offset:13088
    v_mfma_f32_16x16x32_bf16 a[60:63], v[136:139], v[168:171], a[60:63]
    ds_read_b64 v[88:89], v5 offset:19456
    v_mfma_f32_16x16x32_bf16 a[64:67], v[140:143], v[156:159], a[64:67]
    ds_read_b64 v[90:91], v5 offset:19488
    v_mfma_f32_16x16x32_bf16 a[68:71], v[140:143], v[160:163], a[68:71]
    ds_read_b64 v[92:93], v5 offset:25856
    v_mfma_f32_16x16x32_bf16 a[72:75], v[140:143], v[164:167], a[72:75]
    ds_read_b64 v[94:95], v5 offset:25888
    v_mfma_f32_16x16x32_bf16 a[76:79], v[140:143], v[168:171], a[76:79]
    ds_read_b64 v[96:97], v5 offset:32256
    v_mfma_f32_16x16x32_bf16 a[80:83], v[144:147], v[156:159], a[80:83]
    ds_read_b64 v[98:99], v5 offset:32288
    v_mfma_f32_16x16x32_bf16 a[84:87], v[144:147], v[160:163], a[84:87]
    ds_read_b64 v[100:101], v5 offset:38656
    v_mfma_f32_16x16x32_bf16 a[88:91], v[144:147], v[164:167], a[88:91]
    ds_read_b64 v[102:103], v5 offset:38688
    v_mfma_f32_16x16x32_bf16 a[92:95], v[144:147], v[168:171], a[92:95]
    ds_read_b64 v[104:105], v5 offset:45056
    v_mfma_f32_16x16x32_bf16 a[96:99], v[148:151], v[156:159], a[96:99]
    ds_read_b64 v[106:107], v5 offset:45088
    v_mfma_f32_16x16x32_bf16 a[100:103], v[148:151], v[160:163], a[100:103]
    v_mfma_f32_16x16x32_bf16 a[104:107], v[148:151], v[164:167], a[104:107]
    v_mfma_f32_16x16x32_bf16 a[108:111], v[148:151], v[168:171], a[108:111]
    v_mfma_f32_16x16x32_bf16 a[112:115], v[152:155], v[156:159], a[112:115]
    v_mfma_f32_16x16x32_bf16 a[116:119], v[152:155], v[160:163], a[116:119]
    v_mfma_f32_16x16x32_bf16 a[120:123], v[152:155], v[164:167], a[120:123]
    v_mfma_f32_16x16x32_bf16 a[124:127], v[152:155], v[168:171], a[124:127]
    s_waitcnt lgkmcnt(0)
    v_mfma_f32_16x16x32_bf16 a[0:3], v[76:79], v[108:111], a[0:3]
    v_mfma_f32_16x16x32_bf16 a[4:7], v[76:79], v[112:115], a[4:7]
    ds_read_b64_tr_b16 v[156:157], v7 offset:46080
    v_mfma_f32_16x16x32_bf16 a[8:11], v[76:79], v[116:119], a[8:11]
    ds_read_b64_tr_b16 v[158:159], v7 offset:50688
    v_mfma_f32_16x16x32_bf16 a[12:15], v[76:79], v[120:123], a[12:15]
    ds_read_b64_tr_b16 v[160:161], v7 offset:46112
    v_mfma_f32_16x16x32_bf16 a[16:19], v[80:83], v[108:111], a[16:19]
    ds_read_b64_tr_b16 v[162:163], v7 offset:50720
    v_mfma_f32_16x16x32_bf16 a[20:23], v[80:83], v[112:115], a[20:23]
    ds_read_b64_tr_b16 v[164:165], v7 offset:46144
    v_mfma_f32_16x16x32_bf16 a[24:27], v[80:83], v[116:119], a[24:27]
    ds_read_b64_tr_b16 v[166:167], v7 offset:50752
    v_mfma_f32_16x16x32_bf16 a[28:31], v[80:83], v[120:123], a[28:31]
    ds_read_b64_tr_b16 v[168:169], v7 offset:46176
    v_mfma_f32_16x16x32_bf16 a[32:35], v[84:87], v[108:111], a[32:35]
    ds_read_b64_tr_b16 v[170:171], v7 offset:50784
    v_mfma_f32_16x16x32_bf16 a[36:39], v[84:87], v[112:115], a[36:39]
    ds_read_b64 v[124:125], v5 offset:320
    v_mfma_f32_16x16x32_bf16 a[40:43], v[84:87], v[116:119], a[40:43]
    ds_read_b64 v[126:127], v5 offset:352
    v_mfma_f32_16x16x32_bf16 a[44:47], v[84:87], v[120:123], a[44:47]
    ds_read_b64 v[128:129], v5 offset:6720
    v_mfma_f32_16x16x32_bf16 a[48:51], v[88:91], v[108:111], a[48:51]
    ds_read_b64 v[130:131], v5 offset:6752
    v_mfma_f32_16x16x32_bf16 a[52:55], v[88:91], v[112:115], a[52:55]
    ds_read_b64 v[132:133], v5 offset:13120
    v_mfma_f32_16x16x32_bf16 a[56:59], v[88:91], v[116:119], a[56:59]
    ds_read_b64 v[134:135], v5 offset:13152
    v_mfma_f32_16x16x32_bf16 a[60:63], v[88:91], v[120:123], a[60:63]
    ds_read_b64 v[136:137], v5 offset:19520
    v_mfma_f32_16x16x32_bf16 a[64:67], v[92:95], v[108:111], a[64:67]
    ds_read_b64 v[138:139], v5 offset:19552
    v_mfma_f32_16x16x32_bf16 a[68:71], v[92:95], v[112:115], a[68:71]
    ds_read_b64 v[140:141], v5 offset:25920
    v_mfma_f32_16x16x32_bf16 a[72:75], v[92:95], v[116:119], a[72:75]
    ds_read_b64 v[142:143], v5 offset:25952
    v_mfma_f32_16x16x32_bf16 a[76:79], v[92:95], v[120:123], a[76:79]
    ds_read_b64 v[144:145], v5 offset:32320
    v_mfma_f32_16x16x32_bf16 a[80:83], v[96:99], v[108:111], a[80:83]
    ds_read_b64 v[146:147], v5 offset:32352
    v_mfma_f32_16x16x32_bf16 a[84:87], v[96:99], v[112:115], a[84:87]
    ds_read_b64 v[148:149], v5 offset:38720
    v_mfma_f32_16x16x32_bf16 a[88:91], v[96:99], v[116:119], a[88:91]
    ds_read_b64 v[150:151], v5 offset:38752
    v_mfma_f32_16x16x32_bf16 a[92:95], v[96:99], v[120:123], a[92:95]
    ds_read_b64 v[152:153], v5 offset:45120
    v_mfma_f32_16x16x32_bf16 a[96:99], v[100:103], v[108:111], a[96:99]
    ds_read_b64 v[154:155], v5 offset:45152
    v_mfma_f32_16x16x32_bf16 a[100:103], v[100:103], v[112:115], a[100:103]
    v_mfma_f32_16x16x32_bf16 a[104:107], v[100:103], v[116:119], a[104:107]
    v_mfma_f32_16x16x32_bf16 a[108:111], v[100:103], v[120:123], a[108:111]
    v_mfma_f32_16x16x32_bf16 a[112:115], v[104:107], v[108:111], a[112:115]
    v_mfma_f32_16x16x32_bf16 a[116:119], v[104:107], v[112:115], a[116:119]
    v_mfma_f32_16x16x32_bf16 a[120:123], v[104:107], v[116:119], a[120:123]
    v_mfma_f32_16x16x32_bf16 a[124:127], v[104:107], v[120:123], a[124:127]
    s_waitcnt lgkmcnt(0)
    v_mfma_f32_16x16x32_bf16 a[0:3], v[124:127], v[156:159], a[0:3]
    v_mfma_f32_16x16x32_bf16 a[4:7], v[124:127], v[160:163], a[4:7]
    v_mfma_f32_16x16x32_bf16 a[8:11], v[124:127], v[164:167], a[8:11]
    v_mfma_f32_16x16x32_bf16 a[12:15], v[124:127], v[168:171], a[12:15]
    v_mfma_f32_16x16x32_bf16 a[16:19], v[128:131], v[156:159], a[16:19]
    v_mfma_f32_16x16x32_bf16 a[20:23], v[128:131], v[160:163], a[20:23]
    v_mfma_f32_16x16x32_bf16 a[24:27], v[128:131], v[164:167], a[24:27]
    v_mfma_f32_16x16x32_bf16 a[28:31], v[128:131], v[168:171], a[28:31]
    v_mfma_f32_16x16x32_bf16 a[32:35], v[132:135], v[156:159], a[32:35]
    v_mfma_f32_16x16x32_bf16 a[36:39], v[132:135], v[160:163], a[36:39]
    v_mfma_f32_16x16x32_bf16 a[40:43], v[132:135], v[164:167], a[40:43]
    v_mfma_f32_16x16x32_bf16 a[44:47], v[132:135], v[168:171], a[44:47]
    v_mfma_f32_16x16x32_bf16 a[48:51], v[136:139], v[156:159], a[48:51]
    v_mfma_f32_16x16x32_bf16 a[52:55], v[136:139], v[160:163], a[52:55]
    v_mfma_f32_16x16x32_bf16 a[56:59], v[136:139], v[164:167], a[56:59]
    v_mfma_f32_16x16x32_bf16 a[60:63], v[136:139], v[168:171], a[60:63]
    v_mfma_f32_16x16x32_bf16 a[64:67], v[140:143], v[156:159], a[64:67]
    v_mfma_f32_16x16x32_bf16 a[68:71], v[140:143], v[160:163], a[68:71]
    v_mfma_f32_16x16x32_bf16 a[72:75], v[140:143], v[164:167], a[72:75]
    v_mfma_f32_16x16x32_bf16 a[76:79], v[140:143], v[168:171], a[76:79]
    v_mfma_f32_16x16x32_bf16 a[80:83], v[144:147], v[156:159], a[80:83]
    v_mfma_f32_16x16x32_bf16 a[84:87], v[144:147], v[160:163], a[84:87]
    v_mfma_f32_16x16x32_bf16 a[88:91], v[144:147], v[164:167], a[88:91]
    v_mfma_f32_16x16x32_bf16 a[92:95], v[144:147], v[168:171], a[92:95]
    v_mfma_f32_16x16x32_bf16 a[96:99], v[148:151], v[156:159], a[96:99]
    v_mfma_f32_16x16x32_bf16 a[100:103], v[148:151], v[160:163], a[100:103]
    v_mfma_f32_16x16x32_bf16 a[104:107], v[148:151], v[164:167], a[104:107]
    v_mfma_f32_16x16x32_bf16 a[108:111], v[148:151], v[168:171], a[108:111]
    v_mfma_f32_16x16x32_bf16 a[112:115], v[152:155], v[156:159], a[112:115]
    v_mfma_f32_16x16x32_bf16 a[116:119], v[152:155], v[160:163], a[116:119]
    v_mfma_f32_16x16x32_bf16 a[120:123], v[152:155], v[164:167], a[120:123]
    v_mfma_f32_16x16x32_bf16 a[124:127], v[152:155], v[168:171], a[124:127]
    s_nop 7
    s_sub_u32 s78, s78, 1
    s_cmp_lg_u32 s78, 0
    s_cbranch_scc1 mvu2_nofetch
    s_cmp_lg_u32 s61, 0
    s_cbranch_scc1 if_skip_18
    s_mov_b64 exec, 1
    v_accvgpr_write_b32 a255, 1
    v_mov_b32 v3, 0
    s_nop 1
    buffer_atomic_add a255, v3, s[56:59], s75 offen sc0 sc1
    s_mov_b64 exec, -1
if_skip_18:
mvu2_nofetch:
    v_and_b32 v60, 15, v0
    v_bfe_u32 v61, v0, 4, 2
    v_lshrrev_b32 v62, 7, v0
    v_bfe_u32 v63, v0, 6, 1
    v_mul_u32_u24 v64, 64, v63
    v_add_u32 v64, v64, v60
    v_mul_u32_u24 v64, 64, v64
    v_lshl_add_u32 v64, v61, 4, v64
    s_mov_b32 s24, 5242880
    v_mul_lo_u32 v65, v62, s24
    v_add_u32 v60, v64, v65
    v_accvgpr_read_b32 v148, a0
    v_accvgpr_read_b32 v149, a1
    v_accvgpr_read_b32 v150, a2
    v_accvgpr_read_b32 v151, a3
    v_cvt_pk_bf16_f32 v76, v148, v149
    v_cvt_pk_bf16_f32 v77, v150, v151
    v_accvgpr_read_b32 v152, a16
    v_accvgpr_read_b32 v153, a17
    v_accvgpr_read_b32 v154, a18
    v_accvgpr_read_b32 v155, a19
    v_cvt_pk_bf16_f32 v78, v152, v153
    v_cvt_pk_bf16_f32 v79, v154, v155
    s_nop 1
    v_permlane32_swap_b32 v76, v78
    v_permlane32_swap_b32 v77, v79
    s_nop 1
    v_permlane16_swap_b32 v76, v78
    v_permlane16_swap_b32 v77, v79
    buffer_store_dwordx4 v[76:79], v60, s[16:19], s23 offen offset:0 sc1
    v_accvgpr_read_b32 v148, a4
    v_accvgpr_read_b32 v149, a5
    v_accvgpr_read_b32 v150, a6
    v_accvgpr_read_b32 v151, a7
    v_cvt_pk_bf16_f32 v84, v148, v149
    v_cvt_pk_bf16_f32 v85, v150, v151
    v_accvgpr_read_b32 v152, a20
    v_accvgpr_read_b32 v153, a21
    v_accvgpr_read_b32 v154, a22
    v_accvgpr_read_b32 v155, a23
    v_cvt_pk_bf16_f32 v86, v152, v153
    v_cvt_pk_bf16_f32 v87, v154, v155
    s_nop 1
    v_permlane32_swap_b32 v84, v86
    v_permlane32_swap_b32 v85, v87
    s_nop 1
    v_permlane16_swap_b32 v84, v86
    v_permlane16_swap_b32 v85, v87
    buffer_store_dwordx4 v[84:87], v60, s[16:19], s23 offen offset:1024 sc1
    v_accvgpr_read_b32 v148, a8
    v_accvgpr_read_b32 v149, a9
    v_accvgpr_read_b32 v150, a10
    v_accvgpr_read_b32 v151, a11
    v_cvt_pk_bf16_f32 v92, v148, v149
    v_cvt_pk_bf16_f32 v93, v150, v151
    v_accvgpr_read_b32 v152, a24
    v_accvgpr_read_b32 v153, a25
    v_accvgpr_read_b32 v154, a26
    v_accvgpr_read_b32 v155, a27
    v_cvt_pk_bf16_f32 v94, v152, v153
    v_cvt_pk_bf16_f32 v95, v154, v155
    s_nop 1
    v_permlane32_swap_b32 v92, v94
    v_permlane32_swap_b32 v93, v95
    s_nop 1
    v_permlane16_swap_b32 v92, v94
    v_permlane16_swap_b32 v93, v95
    buffer_store_dwordx4 v[92:95], v60, s[16:19], s23 offen offset:2048 sc1
    v_accvgpr_read_b32 v148, a12
    v_accvgpr_read_b32 v149, a13
    v_accvgpr_read_b32 v150, a14
    v_accvgpr_read_b32 v151, a15
    v_cvt_pk_bf16_f32 v100, v148, v149
    v_cvt_pk_bf16_f32 v101, v150, v151
    v_accvgpr_read_b32 v152, a28
    v_accvgpr_read_b32 v153, a29
    v_accvgpr_read_b32 v154, a30
    v_accvgpr_read_b32 v155, a31
    v_cvt_pk_bf16_f32 v102, v152, v153
    v_cvt_pk_bf16_f32 v103, v154, v155
    s_nop 1
    v_permlane32_swap_b32 v100, v102
    v_permlane32_swap_b32 v101, v103
    s_nop 1
    v_permlane16_swap_b32 v100, v102
    v_permlane16_swap_b32 v101, v103
    buffer_store_dwordx4 v[100:103], v60, s[16:19], s23 offen offset:3072 sc1
    v_add_u32 v60, 1310720, v60
    v_accvgpr_read_b32 v148, a32
    v_accvgpr_read_b32 v149, a33
    v_accvgpr_read_b32 v150, a34
    v_accvgpr_read_b32 v151, a35
    v_cvt_pk_bf16_f32 v108, v148, v149
    v_cvt_pk_bf16_f32 v109, v150, v151
    v_accvgpr_read_b32 v152, a48
    v_accvgpr_read_b32 v153, a49
    v_accvgpr_read_b32 v154, a50
    v_accvgpr_read_b32 v155, a51
    v_cvt_pk_bf16_f32 v110, v152, v153
    v_cvt_pk_bf16_f32 v111, v154, v155
    s_nop 1
    v_permlane32_swap_b32 v108, v110
    v_permlane32_swap_b32 v109, v111
    s_nop 1
    v_permlane16_swap_b32 v108, v110
    v_permlane16_swap_b32 v109, v111
    buffer_store_dwordx4 v[108:111], v60, s[16:19], s23 offen offset:0 sc1
    v_accvgpr_read_b32 v148, a36
    v_accvgpr_read_b32 v149, a37
    v_accvgpr_read_b32 v150, a38
    v_accvgpr_read_b32 v151, a39
    v_cvt_pk_bf16_f32 v116, v148, v149
    v_cvt_pk_bf16_f32 v117, v150, v151
    v_accvgpr_read_b32 v152, a52
    v_accvgpr_read_b32 v153, a53
    v_accvgpr_read_b32 v154, a54
    v_accvgpr_read_b32 v155, a55
    v_cvt_pk_bf16_f32 v118, v152, v153
    v_cvt_pk_bf16_f32 v119, v154, v155
    s_nop 1
    v_permlane32_swap_b32 v116, v118
    v_permlane32_swap_b32 v117, v119
    s_nop 1
    v_permlane16_swap_b32 v116, v118
    v_permlane16_swap_b32 v117, v119
    buffer_store_dwordx4 v[116:119], v60, s[16:19], s23 offen offset:1024 sc1
    v_accvgpr_read_b32 v148, a40
    v_accvgpr_read_b32 v149, a41
    v_accvgpr_read_b32 v150, a42
    v_accvgpr_read_b32 v151, a43
    v_cvt_pk_bf16_f32 v124, v148, v149
    v_cvt_pk_bf16_f32 v125, v150, v151
    v_accvgpr_read_b32 v152, a56
    v_accvgpr_read_b32 v153, a57
    v_accvgpr_read_b32 v154, a58
    v_accvgpr_read_b32 v155, a59
    v_cvt_pk_bf16_f32 v126, v152, v153
    v_cvt_pk_bf16_f32 v127, v154, v155
    s_nop 1
    v_permlane32_swap_b32 v124, v126
    v_permlane32_swap_b32 v125, v127
    s_nop 1
    v_permlane16_swap_b32 v124, v126
    v_permlane16_swap_b32 v125, v127
    buffer_store_dwordx4 v[124:127], v60, s[16:19], s23 offen offset:2048 sc1
    v_accvgpr_read_b32 v148, a44
    v_accvgpr_read_b32 v149, a45
    v_accvgpr_read_b32 v150, a46
    v_accvgpr_read_b32 v151, a47
    v_cvt_pk_bf16_f32 v132, v148, v149
    v_cvt_pk_bf16_f32 v133, v150, v151
    v_accvgpr_read_b32 v152, a60
    v_accvgpr_read_b32 v153, a61
    v_accvgpr_read_b32 v154, a62
    v_accvgpr_read_b32 v155, a63
    v_cvt_pk_bf16_f32 v134, v152, v153
    v_cvt_pk_bf16_f32 v135, v154, v155
    s_nop 1
    v_permlane32_swap_b32 v132, v134
    v_permlane32_swap_b32 v133, v135
    s_nop 1
    v_permlane16_swap_b32 v132, v134
    v_permlane16_swap_b32 v133, v135
    buffer_store_dwordx4 v[132:135], v60, s[16:19], s23 offen offset:3072 sc1
    v_add_u32 v60, 1310720, v60
    v_accvgpr_read_b32 v148, a64
    v_accvgpr_read_b32 v149, a65
    v_accvgpr_read_b32 v150, a66
    v_accvgpr_read_b32 v151, a67
    v_cvt_pk_bf16_f32 v76, v148, v149
    v_cvt_pk_bf16_f32 v77, v150, v151
    v_accvgpr_read_b32 v152, a80
    v_accvgpr_read_b32 v153, a81
    v_accvgpr_read_b32 v154, a82
    v_accvgpr_read_b32 v155, a83
    v_cvt_pk_bf16_f32 v78, v152, v153
    v_cvt_pk_bf16_f32 v79, v154, v155
    s_nop 1
    v_permlane32_swap_b32 v76, v78
    v_permlane32_swap_b32 v77, v79
    s_nop 1
    v_permlane16_swap_b32 v76, v78
    v_permlane16_swap_b32 v77, v79
    buffer_store_dwordx4 v[76:79], v60, s[16:19], s23 offen offset:0 sc1
    v_accvgpr_read_b32 v148, a68
    v_accvgpr_read_b32 v149, a69
    v_accvgpr_read_b32 v150, a70
    v_accvgpr_read_b32 v151, a71
    v_cvt_pk_bf16_f32 v84, v148, v149
    v_cvt_pk_bf16_f32 v85, v150, v151
    v_accvgpr_read_b32 v152, a84
    v_accvgpr_read_b32 v153, a85
    v_accvgpr_read_b32 v154, a86
    v_accvgpr_read_b32 v155, a87
    v_cvt_pk_bf16_f32 v86, v152, v153
    v_cvt_pk_bf16_f32 v87, v154, v155
    s_nop 1
    v_permlane32_swap_b32 v84, v86
    v_permlane32_swap_b32 v85, v87
    s_nop 1
    v_permlane16_swap_b32 v84, v86
    v_permlane16_swap_b32 v85, v87
    buffer_store_dwordx4 v[84:87], v60, s[16:19], s23 offen offset:1024 sc1
    v_accvgpr_read_b32 v148, a72
    v_accvgpr_read_b32 v149, a73
    v_accvgpr_read_b32 v150, a74
    v_accvgpr_read_b32 v151, a75
    v_cvt_pk_bf16_f32 v92, v148, v149
    v_cvt_pk_bf16_f32 v93, v150, v151
    v_accvgpr_read_b32 v152, a88
    v_accvgpr_read_b32 v153, a89
    v_accvgpr_read_b32 v154, a90
    v_accvgpr_read_b32 v155, a91
    v_cvt_pk_bf16_f32 v94, v152, v153
    v_cvt_pk_bf16_f32 v95, v154, v155
    s_nop 1
    v_permlane32_swap_b32 v92, v94
    v_permlane32_swap_b32 v93, v95
    s_nop 1
    v_permlane16_swap_b32 v92, v94
    v_permlane16_swap_b32 v93, v95
    buffer_store_dwordx4 v[92:95], v60, s[16:19], s23 offen offset:2048 sc1
    v_accvgpr_read_b32 v148, a76
    v_accvgpr_read_b32 v149, a77
    v_accvgpr_read_b32 v150, a78
    v_accvgpr_read_b32 v151, a79
    v_cvt_pk_bf16_f32 v100, v148, v149
    v_cvt_pk_bf16_f32 v101, v150, v151
    v_accvgpr_read_b32 v152, a92
    v_accvgpr_read_b32 v153, a93
    v_accvgpr_read_b32 v154, a94
    v_accvgpr_read_b32 v155, a95
    v_cvt_pk_bf16_f32 v102, v152, v153
    v_cvt_pk_bf16_f32 v103, v154, v155
    s_nop 1
    v_permlane32_swap_b32 v100, v102
    v_permlane32_swap_b32 v101, v103
    s_nop 1
    v_permlane16_swap_b32 v100, v102
    v_permlane16_swap_b32 v101, v103
    buffer_store_dwordx4 v[100:103], v60, s[16:19], s23 offen offset:3072 sc1
    v_add_u32 v60, 1310720, v60
    v_accvgpr_read_b32 v148, a96
    v_accvgpr_read_b32 v149, a97
    v_accvgpr_read_b32 v150, a98
    v_accvgpr_read_b32 v151, a99
    v_cvt_pk_bf16_f32 v108, v148, v149
    v_cvt_pk_bf16_f32 v109, v150, v151
    v_accvgpr_read_b32 v152, a112
    v_accvgpr_read_b32 v153, a113
    v_accvgpr_read_b32 v154, a114
    v_accvgpr_read_b32 v155, a115
    v_cvt_pk_bf16_f32 v110, v152, v153
    v_cvt_pk_bf16_f32 v111, v154, v155
    s_nop 1
    v_permlane32_swap_b32 v108, v110
    v_permlane32_swap_b32 v109, v111
    s_nop 1
    v_permlane16_swap_b32 v108, v110
    v_permlane16_swap_b32 v109, v111
    buffer_store_dwordx4 v[108:111], v60, s[16:19], s23 offen offset:0 sc1
    v_accvgpr_read_b32 v148, a100
    v_accvgpr_read_b32 v149, a101
    v_accvgpr_read_b32 v150, a102
    v_accvgpr_read_b32 v151, a103
    v_cvt_pk_bf16_f32 v116, v148, v149
    v_cvt_pk_bf16_f32 v117, v150, v151
    v_accvgpr_read_b32 v152, a116
    v_accvgpr_read_b32 v153, a117
    v_accvgpr_read_b32 v154, a118
    v_accvgpr_read_b32 v155, a119
    v_cvt_pk_bf16_f32 v118, v152, v153
    v_cvt_pk_bf16_f32 v119, v154, v155
    s_nop 1
    v_permlane32_swap_b32 v116, v118
    v_permlane32_swap_b32 v117, v119
    s_nop 1
    v_permlane16_swap_b32 v116, v118
    v_permlane16_swap_b32 v117, v119
    buffer_store_dwordx4 v[116:119], v60, s[16:19], s23 offen offset:1024 sc1
    v_accvgpr_read_b32 v148, a104
    v_accvgpr_read_b32 v149, a105
    v_accvgpr_read_b32 v150, a106
    v_accvgpr_read_b32 v151, a107
    v_cvt_pk_bf16_f32 v124, v148, v149
    v_cvt_pk_bf16_f32 v125, v150, v151
    v_accvgpr_read_b32 v152, a120
    v_accvgpr_read_b32 v153, a121
    v_accvgpr_read_b32 v154, a122
    v_accvgpr_read_b32 v155, a123
    v_cvt_pk_bf16_f32 v126, v152, v153
    v_cvt_pk_bf16_f32 v127, v154, v155
    s_nop 1
    v_permlane32_swap_b32 v124, v126
    v_permlane32_swap_b32 v125, v127
    s_nop 1
    v_permlane16_swap_b32 v124, v126
    v_permlane16_swap_b32 v125, v127
    buffer_store_dwordx4 v[124:127], v60, s[16:19], s23 offen offset:2048 sc1
    v_accvgpr_read_b32 v148, a108
    v_accvgpr_read_b32 v149, a109
    v_accvgpr_read_b32 v150, a110
    v_accvgpr_read_b32 v151, a111
    v_cvt_pk_bf16_f32 v132, v148, v149
    v_cvt_pk_bf16_f32 v133, v150, v151
    v_accvgpr_read_b32 v152, a124
    v_accvgpr_read_b32 v153, a125
    v_accvgpr_read_b32 v154, a126
    v_accvgpr_read_b32 v155, a127
    v_cvt_pk_bf16_f32 v134, v152, v153
    v_cvt_pk_bf16_f32 v135, v154, v155
    s_nop 1
    v_permlane32_swap_b32 v132, v134
    v_permlane32_swap_b32 v133, v135
    s_nop 1
    v_permlane16_swap_b32 v132, v134
    v_permlane16_swap_b32 v133, v135
    buffer_store_dwordx4 v[132:135], v60, s[16:19], s23 offen offset:3072 sc1
mvu2_skip:
    s_add_u32 s23, s23, 8192
    s_cmp_lg_u32 s78, 0
    s_cbranch_scc1 mvu2_chunk
    s_waitcnt vmcnt(0)
    s_xor_b32 s66, s66, 16
    v_mov_b32 v3, 160000
    v_add_u32 v3, s66, v3
    s_cmp_lg_u32 s61, 0
    s_cbranch_scc1 fi1_19
    v_accvgpr_read_b32 v2, a255
    s_mov_b64 exec, 1
    ds_write_b32 v3, v2
    s_mov_b64 exec, -1
    s_waitcnt lgkmcnt(0)
fi1_19:
    s_barrier
    ds_read_b32 v4, v3
    s_cmp_lg_u32 s61, 0
    s_cbranch_scc1 fi2_20
    s_mov_b64 exec, 1
    v_mov_b32 v6, s73
    v_mov_b32 v7, 0
    buffer_atomic_add v6, v7, s[56:59], s74 offen sc1
    s_mov_b64 exec, -1
fi2_20:
    s_waitcnt lgkmcnt(0)
    v_readfirstlane_b32 s62, v4
    s_nop 3
    s_cmp_eq_u32 s63, 0
    s_cbranch_scc1 mega_decA
    s_branch mega_decB
blk_bt:
    s_load_dwordx4 s[32:35], s[0:1], 32
    s_add_u32 s16, s64, 78118912
    s_addc_u32 s17, s65, 0
    s_mov_b32 s18, 26214400
    s_mov_b32 s19, 0x00020000
    s_waitcnt lgkmcnt(0)
    s_mov_b32 s8, s32
    s_mov_b32 s9, s33
    s_mov_b32 s10, 7864320
    s_mov_b32 s11, 0x00020000
    s_mov_b32 s28, s34
    s_mov_b32 s29, s35
    s_mov_b32 s30, 7864320
    s_mov_b32 s31, 0x00020000
    s_mul_i32 s20, s70, 3145728
    s_mul_i32 s24, s71, 384
    s_add_u32 s20, s20, s24
    s_lshr_b32 s23, s71, 3
    s_mul_i32 s23, s23, 81920
    s_bfe_u32 s24, s71, 0x20001
    s_lshl_b32 s24, s24, 10
    s_add_u32 s23, s23, s24
    s_and_b32 s24, s71, 1
    s_lshl_b32 s24, s24, 7
    s_add_u32 s23, s23, s24
    s_lshl_b32 s24, s70, 15
    s_add_u32 s23, s23, s24
    s_mul_i32 s76, s71, 245760
    s_mov_b32 s74, 256
    v_lshrrev_b32 v60, 3, v0
    v_and_b32 v61, 7, v0
    s_mov_b32 s24, 12288
    v_mul_lo_u32 v8, v60, s24
    v_lshl_add_u32 v8, v61, 4, v8
    v_mul_u32_u24 v9, 400, v60
    v_lshl_add_u32 v9, v61, 4, v9
    s_add_u32 s21, s20, 0
    buffer_load_dwordx4 v[76:79], v8, s[8:11], s21 offen offset:0
    buffer_load_dwordx4 v[80:83], v8, s[8:11], s21 offen offset:128
    buffer_load_dwordx4 v[84:87], v8, s[8:11], s21 offen offset:256
    s_add_u32 s21, s20, 393216
    buffer_load_dwordx4 v[88:91], v8, s[8:11], s21 offen offset:0
    buffer_load_dwordx4 v[92:95], v8, s[8:11], s21 offen offset:128
    buffer_load_dwordx4 v[96:99], v8, s[8:11], s21 offen offset:256
    s_add_u32 s21, s20, 786432
    buffer_load_dwordx4 v[100:103], v8, s[8:11], s21 offen offset:0
    buffer_load_dwordx4 v[104:107], v8, s[8:11], s21 offen offset:128
    buffer_load_dwordx4 v[108:111], v8, s[8:11], s21 offen offset:256
    s_add_u32 s21, s20, 1179648
    buffer_load_dwordx4 v[112:115], v8, s[8:11], s21 offen offset:0
    buffer_load_dwordx4 v[116:119], v8, s[8:11], s21 offen offset:128
    buffer_load_dwordx4 v[120:123], v8, s[8:11], s21 offen offset:256
    s_add_u32 s21, s20, 1572864
    buffer_load_dwordx4 v[124:127], v8, s[8:11], s21 offen offset:0
    buffer_load_dwordx4 v[128:131], v8, s[8:11], s21 offen offset:128
    buffer_load_dwordx4 v[132:135], v8, s[8:11], s21 offen offset:256
    s_add_u32 s21, s20, 1966080
    buffer_load_dwordx4 v[136:139], v8, s[8:11], s21 offen offset:0
    buffer_load_dwordx4 v[140:143], v8, s[8:11], s21 offen offset:128
    buffer_load_dwordx4 v[144:147], v8, s[8:11], s21 offen offset:256
    s_add_u32 s21, s20, 2359296
    buffer_load_dwordx4 v[148:151], v8, s[8:11], s21 offen offset:0
    buffer_load_dwordx4 v[152:155], v8, s[8:11], s21 offen offset:128
    buffer_load_dwordx4 v[156:159], v8, s[8:11], s21 offen offset:256
    s_add_u32 s21, s20, 2752512
    buffer_load_dwordx4 v[160:163], v8, s[8:11], s21 offen offset:0
    buffer_load_dwordx4 v[164:167], v8, s[8:11], s21 offen offset:128
    buffer_load_dwordx4 v[168:171], v8, s[8:11], s21 offen offset:256
    v_lshrrev_b32 v60, 4, v0
    v_and_b32 v61, 15, v0
    v_mul_u32_u24 v2, 1280, v60
    v_lshl_add_u32 v2, v61, 4, v2
    v_mul_u32_u24 v3, 288, v60
    v_lshl_add_u32 v3, v61, 4, v3
    v_add_u32 v3, 102400, v3
    v_and_b32 v60, 15, v0
    v_bfe_u32 v61, v0, 4, 2
    v_lshrrev_b32 v62, 7, v0
    v_bfe_u32 v63, v0, 6, 1
    v_lshl_add_u32 v64, v62, 7, v60
    v_mul_u32_u24 v4, 400, v64
    v_lshl_add_u32 v5, v61, 3, v4
    v_mul_u32_u24 v64, 192, v63
    v_add_u32 v6, v64, v5
    v_lshrrev_b32 v64, 2, v60
    v_lshl_add_u32 v64, v61, 2, v64
    v_mul_u32_u24 v7, 288, v64
    v_and_b32 v64, 3, v60
    v_lshl_add_u32 v7, v64, 3, v7
    v_lshl_add_u32 v7, v63, 7, v7
    v_add_u32 v7, 102400, v7
    s_add_u32 s77, s76, 0
    buffer_load_dwordx4 v[188:191], v2, s[28:31], s77 offen
    s_add_u32 s77, s76, 20480
    buffer_load_dwordx4 v[192:195], v2, s[28:31], s77 offen
    s_add_u32 s77, s76, 40960
    buffer_load_dwordx4 v[196:199], v2, s[28:31], s77 offen
    s_add_u32 s77, s76, 61440
    buffer_load_dwordx4 v[200:203], v2, s[28:31], s77 offen
    s_add_u32 s77, s76, 81920
    buffer_load_dwordx4 v[204:207], v2, s[28:31], s77 offen
    s_add_u32 s77, s76, 102400
    buffer_load_dwordx4 v[208:211], v2, s[28:31], s77 offen
    s_add_u32 s77, s76, 122880
    buffer_load_dwordx4 v[212:215], v2, s[28:31], s77 offen
    s_add_u32 s77, s76, 143360
    buffer_load_dwordx4 v[216:219], v2, s[28:31], s77 offen
    s_add_u32 s77, s76, 163840
    buffer_load_dwordx4 v[220:223], v2, s[28:31], s77 offen
    s_add_u32 s77, s76, 184320
    buffer_load_dwordx4 v[224:227], v2, s[28:31], s77 offen
    s_add_u32 s77, s76, 204800
    buffer_load_dwordx4 v[228:231], v2, s[28:31], s77 offen
    s_add_u32 s77, s76, 225280
    buffer_load_dwordx4 v[232:235], v2, s[28:31], s77 offen
    s_add_u32 s76, s76, 256
    s_waitcnt vmcnt(12)
    v_add_u32 v10, 51200, v9
    ds_write_b128 v9, v[76:79] offset:0
    ds_write_b128 v9, v[80:83] offset:128
    ds_write_b128 v9, v[84:87] offset:256
    ds_write_b128 v9, v[88:91] offset:12800
    ds_write_b128 v9, v[92:95] offset:12928
    ds_write_b128 v9, v[96:99] offset:13056
    ds_write_b128 v9, v[100:103] offset:25600
    ds_write_b128 v9, v[104:107] offset:25728
    ds_write_b128 v9, v[108:111] offset:25856
    ds_write_b128 v9, v[112:115] offset:38400
    ds_write_b128 v9, v[116:119] offset:38528
    ds_write_b128 v9, v[120:123] offset:38656
    ds_write_b128 v10, v[124:127] offset:0
    ds_write_b128 v10, v[128:131] offset:128
    ds_write_b128 v10, v[132:135] offset:256
    ds_write_b128 v10, v[136:139] offset:12800
    ds_write_b128 v10, v[140:143] offset:12928
    ds_write_b128 v10, v[144:147] offset:13056
    ds_write_b128 v10, v[148:151] offset:25600
    ds_write_b128 v10, v[152:155] offset:25728
    ds_write_b128 v10, v[156:159] offset:25856
    ds_write_b128 v10, v[160:163] offset:38400
    ds_write_b128 v10, v[164:167] offset:38528
    ds_write_b128 v10, v[168:171] offset:38656
    s_mov_b32 s78, 5
mbt2_chunk:
    s_waitcnt vmcnt(0) lgkmcnt(0)
    s_barrier
    ds_write_b128 v3, v[188:191] offset:0
    ds_write_b128 v3, v[192:195] offset:4608
    ds_write_b128 v3, v[196:199] offset:9216
    ds_write_b128 v3, v[200:203] offset:13824
    ds_write_b128 v3, v[204:207] offset:18432
    ds_write_b128 v3, v[208:211] offset:23040
    ds_write_b128 v3, v[212:215] offset:27648
    ds_write_b128 v3, v[216:219] offset:32256
    ds_write_b128 v3, v[220:223] offset:36864
    ds_write_b128 v3, v[224:227] offset:41472
    ds_write_b128 v3, v[228:231] offset:46080
    ds_write_b128 v3, v[232:235] offset:50688
    s_waitcnt lgkmcnt(0)
    s_barrier
    s_add_u32 s77, s76, 0
    buffer_load_dwordx4 v[188:191], v2, s[28:31], s77 offen
    s_add_u32 s77, s76, 20480
    buffer_load_dwordx4 v[192:195], v2, s[28:31], s77 offen
    s_add_u32 s77, s76, 40960
    buffer_load_dwordx4 v[196:199], v2, s[28:31], s77 offen
    s_add_u32 s77, s76, 61440
    buffer_load_dwordx4 v[200:203], v2, s[28:31], s77 offen
    s_add_u32 s77, s76, 81920
    buffer_load_dwordx4 v[204:207], v2, s[28:31], s77 offen
    s_add_u32 s77, s76, 102400
    buffer_load_dwordx4 v[208:211], v2, s[28:31], s77 offen
    s_add_u32 s77, s76, 122880
    buffer_load_dwordx4 v[212:215], v2, s[28:31], s77 offen
    s_add_u32 s77, s76, 143360
    buffer_load_dwordx4 v[216:219], v2, s[28:31], s77 offen
    s_add_u32 s77, s76, 163840
    buffer_load_dwordx4 v[220:223], v2, s[28:31], s77 offen
    s_add_u32 s77, s76, 184320
    buffer_load_dwordx4 v[224:227], v2, s[28:31], s77 offen
    s_add_u32 s77, s76, 204800
    buffer_load_dwordx4 v[228:231], v2, s[28:31], s77 offen
    s_add_u32 s77, s76, 225280
    buffer_load_dwordx4 v[232:235], v2, s[28:31], s77 offen
    s_add_u32 s76, s76, 256
    ds_read_b64_tr_b16 v[108:109], v7 offset:0
    ds_read_b64_tr_b16 v[110:111], v7 offset:4608
    ds_read_b64_tr_b16 v[112:113], v7 offset:32
    ds_read_b64_tr_b16 v[114:115], v7 offset:4640
    ds_read_b64_tr_b16 v[116:117], v7 offset:64
    ds_read_b64_tr_b16 v[118:119], v7 offset:4672
    ds_read_b64_tr_b16 v[120:121], v7 offset:96
    ds_read_b64_tr_b16 v[122:123], v7 offset:4704
    ds_read_b64 v[76:77], v5 offset:0
    ds_read_b64 v[78:79], v5 offset:32
    ds_read_b64 v[80:81], v5 offset:6400
    ds_read_b64 v[82:83], v5 offset:6432
    ds_read_b64 v[84:85], v5 offset:12800
    ds_read_b64 v[86:87], v5 offset:12832
    ds_read_b64 v[88:89], v5 offset:19200
    ds_read_b64 v[90:91], v5 offset:19232
    ds_read_b64 v[92:93], v5 offset:25600
    ds_read_b64 v[94:95], v5 offset:25632
    ds_read_b64 v[96:97], v5 offset:32000
    ds_read_b64 v[98:99], v5 offset:32032
    ds_read_b64 v[100:101], v5 offset:38400
    ds_read_b64 v[102:103], v5 offset:38432
    ds_read_b64 v[104:105], v5 offset:44800
    ds_read_b64 v[106:107], v5 offset:44832
    s_waitcnt lgkmcnt(0)
    v_mfma_f32_16x16x32_bf16 a[0:3], v[76:79], v[108:111], 0
    v_mfma_f32_16x16x32_bf16 a[4:7], v[76:79], v[112:115], 0
    ds_read_b64_tr_b16 v[156:157], v7 offset:9216
    v_mfma_f32_16x16x32_bf16 a[8:11], v[76:79], v[116:119], 0
    ds_read_b64_tr_b16 v[158:159], v7 offset:13824
    v_mfma_f32_16x16x32_bf16 a[12:15], v[76:79], v[120:123], 0
    ds_read_b64_tr_b16 v[160:161], v7 offset:9248
    v_mfma_f32_16x16x32_bf16 a[16:19], v[80:83], v[108:111], 0
    ds_read_b64_tr_b16 v[162:163], v7 offset:13856
    v_mfma_f32_16x16x32_bf16 a[20:23], v[80:83], v[112:115], 0
    ds_read_b64_tr_b16 v[164:165], v7 offset:9280
    v_mfma_f32_16x16x32_bf16 a[24:27], v[80:83], v[116:119], 0
    ds_read_b64_tr_b16 v[166:167], v7 offset:13888
    v_mfma_f32_16x16x32_bf16 a[28:31], v[80:83], v[120:123], 0
    ds_read_b64_tr_b16 v[168:169], v7 offset:9312
    v_mfma_f32_16x16x32_bf16 a[32:35], v[84:87], v[108:111], 0
    ds_read_b64_tr_b16 v[170:171], v7 offset:13920
    v_mfma_f32_16x16x32_bf16 a[36:39], v[84:87], v[112:115], 0
    ds_read_b64 v[124:125], v5 offset:64
    v_mfma_f32_16x16x32_bf16 a[40:43], v[84:87], v[116:119], 0
    ds_read_b64 v[126:127], v5 offset:96
    v_mfma_f32_16x16x32_bf16 a[44:47], v[84:87], v[120:123], 0
    ds_read_b64 v[128:129], v5 offset:6464
    v_mfma_f32_16x16x32_bf16 a[48:51], v[88:91], v[108:111], 0
    ds_read_b64 v[130:131], v5 offset:6496
    v_mfma_f32_16x16x32_bf16 a[52:55], v[88:91], v[112:115], 0
    ds_read_b64 v[132:133], v5 offset:12864
    v_mfma_f32_16x16x32_bf16 a[56:59], v[88:91], v[116:119], 0
    ds_read_b64 v[134:135], v5 offset:12896
    v_mfma_f32_16x16x32_bf16 a[60:63], v[88:91], v[120:123], 0
    ds_read_b64 v[136:137], v5 offset:19264
    v_mfma_f32_16x16x32_bf16 a[64:67], v[92:95], v[108:111], 0
    ds_read_b64 v[138:139], v5 offset:19296
    v_mfma_f32_16x16x32_bf16 a[68:71], v[92:95], v[112:115], 0
    ds_read_b64 v[140:141], v5 offset:25664
    v_mfma_f32_16x16x32_bf16 a[72:75], v[92:95], v[116:119], 0
    ds_read_b64 v[142:143], v5 offset:25696
    v_mfma_f32_16x16x32_bf16 a[76:79], v[92:95], v[120:123], 0
    ds_read_b64 v[144:145], v5 offset:32064
    v_mfma_f32_16x16x32_bf16 a[80:83], v[96:99], v[108:111], 0
    ds_read_b64 v[146:147], v5 offset:32096
    v_mfma_f32_16x16x32_bf16 a[84:87], v[96:99], v[112:115], 0
    ds_read_b64 v[148:149], v5 offset:38464
    v_mfma_f32_16x16x32_bf16 a[88:91], v[96:99], v[116:119], 0
    ds_read_b64 v[150:151], v5 offset:38496
    v_mfma_f32_16x16x32_bf16 a[92:95], v[96:99], v[120:123], 0
    ds_read_b64 v[152:153], v5 offset:44864
    v_mfma_f32_16x16x32_bf16 a[96:99], v[100:103], v[108:111], 0
    ds_read_b64 v[154:155], v5 offset:44896
    v_mfma_f32_16x16x32_bf16 a[100:103], v[100:103], v[112:115], 0
    v_mfma_f32_16x16x32_bf16 a[104:107], v[100:103], v[116:119], 0
    v_mfma_f32_16x16x32_bf16 a[108:111], v[100:103], v[120:123], 0
    v_mfma_f32_16x16x32_bf16 a[112:115], v[104:107], v[108:111], 0
    v_mfma_f32_16x16x32_bf16 a[116:119], v[104:107], v[112:115], 0
    v_mfma_f32_16x16x32_bf16 a[120:123], v[104:107], v[116:119], 0
    v_mfma_f32_16x16x32_bf16 a[124:127], v[104:107], v[120:123], 0
    s_waitcnt lgkmcnt(0)
    v_mfma_f32_16x16x32_bf16 a[0:3], v[124:127], v[156:159], a[0:3]
    v_mfma_f32_16x16x32_bf16 a[4:7], v[124:127], v[160:163], a[4:7]
    ds_read_b64_tr_b16 v[108:109], v7 offset:18432
    v_mfma_f32_16x16x32_bf16 a[8:11], v[124:127], v[164:167], a[8:11]
    ds_read_b64_tr_b16 v[110:111], v7 offset:23040
    v_mfma_f32_16x16x32_bf16 a[12:15], v[124:127], v[168:171], a[12:15]
    ds_read_b64_tr_b16 v[112:113], v7 offset:18464
    v_mfma_f32_16x16x32_bf16 a[16:19], v[128:131], v[156:159], a[16:19]
    ds_read_b64_tr_b16 v[114:115], v7 offset:23072
    v_mfma_f32_16x16x32_bf16 a[20:23], v[128:131], v[160:163], a[20:23]
    ds_read_b64_tr_b16 v[116:117], v7 offset:18496
    v_mfma_f32_16x16x32_bf16 a[24:27], v[128:131], v[164:167], a[24:27]
    ds_read_b64_tr_b16 v[118:119], v7 offset:23104
    v_mfma_f32_16x16x32_bf16 a[28:31], v[128:131], v[168:171], a[28:31]
    ds_read_b64_tr_b16 v[120:121], v7 offset:18528
    v_mfma_f32_16x16x32_bf16 a[32:35], v[132:135], v[156:159], a[32:35]
    ds_read_b64_tr_b16 v[122:123], v7 offset:23136
    v_mfma_f32_16x16x32_bf16 a[36:39], v[132:135], v[160:163], a[36:39]
    ds_read_b64 v[76:77], v5 offset:128
    v_mfma_f32_16x16x32_bf16 a[40:43], v[132:135], v[164:167], a[40:43]
    ds_read_b64 v[78:79], v5 offset:160
    v_mfma_f32_16x16x32_bf16 a[44:47], v[132:135], v[168:171], a[44:47]
    ds_read_b64 v[80:81], v5 offset:6528
    v_mfma_f32_16x16x32_bf16 a[48:51], v[136:139], v[156:159], a[48:51]
    ds_read_b64 v[82:83], v5 offset:6560
    v_mfma_f32_16x16x32_bf16 a[52:55], v[136:139], v[160:163], a[52:55]
    ds_read_b64 v[84:85], v5 offset:12928
    v_mfma_f32_16x16x32_bf16 a[56:59], v[136:139], v[164:167], a[56:59]
    ds_read_b64 v[86:87], v5 offset:12960
    v_mfma_f32_16x16x32_bf16 a[60:63], v[136:139], v[168:171], a[60:63]
    ds_read_b64 v[88:89], v5 offset:19328
    v_mfma_f32_16x16x32_bf16 a[64:67], v[140:143], v[156:159], a[64:67]
    ds_read_b64 v[90:91], v5 offset:19360
    v_mfma_f32_16x16x32_bf16 a[68:71], v[140:143], v[160:163], a[68:71]
    ds_read_b64 v[92:93], v5 offset:25728
    v_mfma_f32_16x16x32_bf16 a[72:75], v[140:143], v[164:167], a[72:75]
    ds_read_b64 v[94:95], v5 offset:25760
    v_mfma_f32_16x16x32_bf16 a[76:79], v[140:143], v[168:171], a[76:79]
    ds_read_b64 v[96:97], v5 offset:32128
    v_mfma_f32_16x16x32_bf16 a[80:83], v[144:147], v[156:159], a[80:83]
    ds_read_b64 v[98:99], v5 offset:32160
    v_mfma_f32_16x16x32_bf16 a[84:87], v[144:147], v[160:163], a[84:87]
    ds_read_b64 v[100:101], v5 offset:38528
    v_mfma_f32_16x16x32_bf16 a[88:91], v[144:147], v[164:167], a[88:91]
    ds_read_b64 v[102:103], v5 offset:38560
    v_mfma_f32_16x16x32_bf16 a[92:95], v[144:147], v[168:171], a[92:95]
    ds_read_b64 v[104:105], v5 offset:44928
    v_mfma_f32_16x16x32_bf16 a[96:99], v[148:151], v[156:159], a[96:99]
    ds_read_b64 v[106:107], v5 offset:44960
    v_mfma_f32_16x16x32_bf16 a[100:103], v[148:151], v[160:163], a[100:103]
    v_mfma_f32_16x16x32_bf16 a[104:107], v[148:151], v[164:167], a[104:107]
    v_mfma_f32_16x16x32_bf16 a[108:111], v[148:151], v[168:171], a[108:111]
    v_mfma_f32_16x16x32_bf16 a[112:115], v[152:155], v[156:159], a[112:115]
    v_mfma_f32_16x16x32_bf16 a[116:119], v[152:155], v[160:163], a[116:119]
    v_mfma_f32_16x16x32_bf16 a[120:123], v[152:155], v[164:167], a[120:123]
    v_mfma_f32_16x16x32_bf16 a[124:127], v[152:155], v[168:171], a[124:127]
    s_waitcnt lgkmcnt(0)
    v_mfma_f32_16x16x32_bf16 a[0:3], v[76:79], v[108:111], a[0:3]
    v_mfma_f32_16x16x32_bf16 a[4:7], v[76:79], v[112:115], a[4:7]
    ds_read_b64_tr_b16 v[156:157], v7 offset:27648
    v_mfma_f32_16x16x32_bf16 a[8:11], v[76:79], v[116:119], a[8:11]
    ds_read_b64_tr_b16 v[158:159], v7 offset:32256
    v_mfma_f32_16x16x32_bf16 a[12:15], v[76:79], v[120:123], a[12:15]
    ds_read_b64_tr_b16 v[160:161], v7 offset:27680
    v_mfma_f32_16x16x32_bf16 a[16:19], v[80:83], v[108:111], a[16:19]
    ds_read_b64_tr_b16 v[162:163], v7 offset:32288
    v_mfma_f32_16x16x32_bf16 a[20:23], v[80:83], v[112:115], a[20:23]
    ds_read_b64_tr_b16 v[164:165], v7 offset:27712
    v_mfma_f32_16x16x32_bf16 a[24:27], v[80:83], v[116:119], a[24:27]
    ds_read_b64_tr_b16 v[166:167], v7 offset:32320
    v_mfma_f32_16x16x32_bf16 a[28:31], v[80:83], v[120:123], a[28:31]
    ds_read_b64_tr_b16 v[168:169], v7 offset:27744
    v_mfma_f32_16x16x32_bf16 a[32:35], v[84:87], v[108:111], a[32:35]
    ds_read_b64_tr_b16 v[170:171], v7 offset:32352
    v_mfma_f32_16x16x32_bf16 a[36:39], v[84:87], v[112:115], a[36:39]
    ds_read_b64 v[124:125], v5 offset:192
    v_mfma_f32_16x16x32_bf16 a[40:43], v[84:87], v[116:119], a[40:43]
    ds_read_b64 v[126:127], v5 offset:224
    v_mfma_f32_16x16x32_bf16 a[44:47], v[84:87], v[120:123], a[44:47]
    ds_read_b64 v[128:129], v5 offset:6592
    v_mfma_f32_16x16x32_bf16 a[48:51], v[88:91], v[108:111], a[48:51]
    ds_read_b64 v[130:131], v5 offset:6624
    v_mfma_f32_16x16x32_bf16 a[52:55], v[88:91], v[112:115], a[52:55]
    ds_read_b64 v[132:133], v5 offset:12992
    v_mfma_f32_16x16x32_bf16 a[56:59], v[88:91], v[116:119], a[56:59]
    ds_read_b64 v[134:135], v5 offset:13024
    v_mfma_f32_16x16x32_bf16 a[60:63], v[88:91], v[120:123], a[60:63]
    ds_read_b64 v[136:137], v5 offset:19392
    v_mfma_f32_16x16x32_bf16 a[64:67], v[92:95], v[108:111], a[64:67]
    ds_read_b64 v[138:139], v5 offset:19424
    v_mfma_f32_16x16x32_bf16 a[68:71], v[92:95], v[112:115], a[68:71]
    ds_read_b64 v[140:141], v5 offset:25792
    v_mfma_f32_16x16x32_bf16 a[72:75], v[92:95], v[116:119], a[72:75]
    ds_read_b64 v[142:143], v5 offset:25824
    v_mfma_f32_16x16x32_bf16 a[76:79], v[92:95], v[120:123], a[76:79]
    ds_read_b64 v[144:145], v5 offset:32192
    v_mfma_f32_16x16x32_bf16 a[80:83], v[96:99], v[108:111], a[80:83]
    ds_read_b64 v[146:147], v5 offset:32224
    v_mfma_f32_16x16x32_bf16 a[84:87], v[96:99], v[112:115], a[84:87]
    ds_read_b64 v[148:149], v5 offset:38592
    v_mfma_f32_16x16x32_bf16 a[88:91], v[96:99], v[116:119], a[88:91]
    ds_read_b64 v[150:151], v5 offset:38624
    v_mfma_f32_16x16x32_bf16 a[92:95], v[96:99], v[120:123], a[92:95]
    ds_read_b64 v[152:153], v5 offset:44992
    v_mfma_f32_16x16x32_bf16 a[96:99], v[100:103], v[108:111], a[96:99]
    ds_read_b64 v[154:155], v5 offset:45024
    v_mfma_f32_16x16x32_bf16 a[100:103], v[100:103], v[112:115], a[100:103]
    v_mfma_f32_16x16x32_bf16 a[104:107], v[100:103], v[116:119], a[104:107]
    v_mfma_f32_16x16x32_bf16 a[108:111], v[100:103], v[120:123], a[108:111]
    v_mfma_f32_16x16x32_bf16 a[112:115], v[104:107], v[108:111], a[112:115]
    v_mfma_f32_16x16x32_bf16 a[116:119], v[104:107], v[112:115], a[116:119]
    v_mfma_f32_16x16x32_bf16 a[120:123], v[104:107], v[116:119], a[120:123]
    v_mfma_f32_16x16x32_bf16 a[124:127], v[104:107], v[120:123], a[124:127]
    s_waitcnt lgkmcnt(0)
    v_mfma_f32_16x16x32_bf16 a[0:3], v[124:127], v[156:159], a[0:3]
    v_mfma_f32_16x16x32_bf16 a[4:7], v[124:127], v[160:163], a[4:7]
    ds_read_b64_tr_b16 v[108:109], v7 offset:36864
    v_mfma_f32_16x16x32_bf16 a[8:11], v[124:127], v[164:167], a[8:11]
    ds_read_b64_tr_b16 v[110:111], v7 offset:41472
    v_mfma_f32_16x16x32_bf16 a[12:15], v[124:127], v[168:171], a[12:15]
    ds_read_b64_tr_b16 v[112:113], v7 offset:36896
    v_mfma_f32_16x16x32_bf16 a[16:19], v[128:131], v[156:159], a[16:19]
    ds_read_b64_tr_b16 v[114:115], v7 offset:41504
    v_mfma_f32_16x16x32_bf16 a[20:23], v[128:131], v[160:163], a[20:23]
    ds_read_b64_tr_b16 v[116:117], v7 offset:36928
    v_mfma_f32_16x16x32_bf16 a[24:27], v[128:131], v[164:167], a[24:27]
    ds_read_b64_tr_b16 v[118:119], v7 offset:41536
    v_mfma_f32_16x16x32_bf16 a[28:31], v[128:131], v[168:171], a[28:31]
    ds_read_b64_tr_b16 v[120:121], v7 offset:36960
    v_mfma_f32_16x16x32_bf16 a[32:35], v[132:135], v[156:159], a[32:35]
    ds_read_b64_tr_b16 v[122:123], v7 offset:41568
    v_mfma_f32_16x16x32_bf16 a[36:39], v[132:135], v[160:163], a[36:39]
    ds_read_b64 v[76:77], v5 offset:256
    v_mfma_f32_16x16x32_bf16 a[40:43], v[132:135], v[164:167], a[40:43]
    ds_read_b64 v[78:79], v5 offset:288
    v_mfma_f32_16x16x32_bf16 a[44:47], v[132:135], v[168:171], a[44:47]
    ds_read_b64 v[80:81], v5 offset:6656
    v_mfma_f32_16x16x32_bf16 a[48:51], v[136:139], v[156:159], a[48:51]
    ds_read_b64 v[82:83], v5 offset:6688
    v_mfma_f32_16x16x32_bf16 a[52:55], v[136:139], v[160:163], a[52:55]
    ds_read_b64 v[84:85], v5 offset:13056
    v_mfma_f32_16x16x32_bf16 a[56:59], v[136:139], v[164:167], a[56:59]
    ds_read_b64 v[86:87], v5 offset:13088
    v_mfma_f32_16x16x32_bf16 a[60:63], v[136:139], v[168:171], a[60:63]
    ds_read_b64 v[88:89], v5 offset:19456
    v_mfma_f32_16x16x32_bf16 a[64:67], v[140:143], v[156:159], a[64:67]
    ds_read_b64 v[90:91], v5 offset:19488
    v_mfma_f32_16x16x32_bf16 a[68:71], v[140:143], v[160:163], a[68:71]
    ds_read_b64 v[92:93], v5 offset:25856
    v_mfma_f32_16x16x32_bf16 a[72:75], v[140:143], v[164:167], a[72:75]
    ds_read_b64 v[94:95], v5 offset:25888
    v_mfma_f32_16x16x32_bf16 a[76:79], v[140:143], v[168:171], a[76:79]
    ds_read_b64 v[96:97], v5 offset:32256
    v_mfma_f32_16x16x32_bf16 a[80:83], v[144:147], v[156:159], a[80:83]
    ds_read_b64 v[98:99], v5 offset:32288
    v_mfma_f32_16x16x32_bf16 a[84:87], v[144:147], v[160:163], a[84:87]
    ds_read_b64 v[100:101], v5 offset:38656
    v_mfma_f32_16x16x32_bf16 a[88:91], v[144:147], v[164:167], a[88:91]
    ds_read_b64 v[102:103], v5 offset:38688
    v_mfma_f32_16x16x32_bf16 a[92:95], v[144:147], v[168:171], a[92:95]
    ds_read_b64 v[104:105], v5 offset:45056
    v_mfma_f32_16x16x32_bf16 a[96:99], v[148:151], v[156:159], a[96:99]
    ds_read_b64 v[106:107], v5 offset:45088
    v_mfma_f32_16x16x32_bf16 a[100:103], v[148:151], v[160:163], a[100:103]
    v_mfma_f32_16x16x32_bf16 a[104:107], v[148:151], v[164:167], a[104:107]
    v_mfma_f32_16x16x32_bf16 a[108:111], v[148:151], v[168:171], a[108:111]
    v_mfma_f32_16x16x32_bf16 a[112:115], v[152:155], v[156:159], a[112:115]
    v_mfma_f32_16x16x32_bf16 a[116:119], v[152:155], v[160:163], a[116:119]
    v_mfma_f32_16x16x32_bf16 a[120:123], v[152:155], v[164:167], a[120:123]
    v_mfma_f32_16x16x32_bf16 a[124:127], v[152:155], v[168:171], a[124:127]
    s_waitcnt lgkmcnt(0)
    v_mfma_f32_16x16x32_bf16 a[0:3], v[76:79], v[108:111], a[0:3]
    v_mfma_f32_16x16x32_bf16 a[4:7], v[76:79], v[112:115], a[4:7]
    ds_read_b64_tr_b16 v[156:157], v7 offset:46080
    v_mfma_f32_16x16x32_bf16 a[8:11], v[76:79], v[116:119], a[8:11]
    ds_read_b64_tr_b16 v[158:159], v7 offset:50688
    v_mfma_f32_16x16x32_bf16 a[12:15], v[76:79], v[120:123], a[12:15]
    ds_read_b64_tr_b16 v[160:161], v7 offset:46112
    v_mfma_f32_16x16x32_bf16 a[16:19], v[80:83], v[108:111], a[16:19]
    ds_read_b64_tr_b16 v[162:163], v7 offset:50720
    v_mfma_f32_16x16x32_bf16 a[20:23], v[80:83], v[112:115], a[20:23]
    ds_read_b64_tr_b16 v[164:165], v7 offset:46144
    v_mfma_f32_16x16x32_bf16 a[24:27], v[80:83], v[116:119], a[24:27]
    ds_read_b64_tr_b16 v[166:167], v7 offset:50752
    v_mfma_f32_16x16x32_bf16 a[28:31], v[80:83], v[120:123], a[28:31]
    ds_read_b64_tr_b16 v[168:169], v7 offset:46176
    v_mfma_f32_16x16x32_bf16 a[32:35], v[84:87], v[108:111], a[32:35]
    ds_read_b64_tr_b16 v[170:171], v7 offset:50784
    v_mfma_f32_16x16x32_bf16 a[36:39], v[84:87], v[112:115], a[36:39]
    ds_read_b64 v[124:125], v5 offset:320
    v_mfma_f32_16x16x32_bf16 a[40:43], v[84:87], v[116:119], a[40:43]
    ds_read_b64 v[126:127], v5 offset:352
    v_mfma_f32_16x16x32_bf16 a[44:47], v[84:87], v[120:123], a[44:47]
    ds_read_b64 v[128:129], v5 offset:6720
    v_mfma_f32_16x16x32_bf16 a[48:51], v[88:91], v[108:111], a[48:51]
    ds_read_b64 v[130:131], v5 offset:6752
    v_mfma_f32_16x16x32_bf16 a[52:55], v[88:91], v[112:115], a[52:55]
    ds_read_b64 v[132:133], v5 offset:13120
    v_mfma_f32_16x16x32_bf16 a[56:59], v[88:91], v[116:119], a[56:59]
    ds_read_b64 v[134:135], v5 offset:13152
    v_mfma_f32_16x16x32_bf16 a[60:63], v[88:91], v[120:123], a[60:63]
    ds_read_b64 v[136:137], v5 offset:19520
    v_mfma_f32_16x16x32_bf16 a[64:67], v[92:95], v[108:111], a[64:67]
    ds_read_b64 v[138:139], v5 offset:19552
    v_mfma_f32_16x16x32_bf16 a[68:71], v[92:95], v[112:115], a[68:71]
    ds_read_b64 v[140:141], v5 offset:25920
    v_mfma_f32_16x16x32_bf16 a[72:75], v[92:95], v[116:119], a[72:75]
    ds_read_b64 v[142:143], v5 offset:25952
    v_mfma_f32_16x16x32_bf16 a[76:79], v[92:95], v[120:123], a[76:79]
    ds_read_b64 v[144:145], v5 offset:32320
    v_mfma_f32_16x16x32_bf16 a[80:83], v[96:99], v[108:111], a[80:83]
    ds_read_b64 v[146:147], v5 offset:32352
    v_mfma_f32_16x16x32_bf16 a[84:87], v[96:99], v[112:115], a[84:87]
    ds_read_b64 v[148:149], v5 offset:38720
    v_mfma_f32_16x16x32_bf16 a[88:91], v[96:99], v[116:119], a[88:91]
    ds_read_b64 v[150:151], v5 offset:38752
    v_mfma_f32_16x16x32_bf16 a[92:95], v[96:99], v[120:123], a[92:95]
    ds_read_b64 v[152:153], v5 offset:45120
    v_mfma_f32_16x16x32_bf16 a[96:99], v[100:103], v[108:111], a[96:99]
    ds_read_b64 v[154:155], v5 offset:45152
    v_mfma_f32_16x16x32_bf16 a[100:103], v[100:103], v[112:115], a[100:103]
    v_mfma_f32_16x16x32_bf16 a[104:107], v[100:103], v[116:119], a[104:107]
    v_mfma_f32_16x16x32_bf16 a[108:111], v[100:103], v[120:123], a[108:111]
    v_mfma_f32_16x16x32_bf16 a[112:115], v[104:107], v[108:111], a[112:115]
    v_mfma_f32_16x16x32_bf16 a[116:119], v[104:107], v[112:115], a[116:119]
    v_mfma_f32_16x16x32_bf16 a[120:123], v[104:107], v[116:119], a[120:123]
    v_mfma_f32_16x16x32_bf16 a[124:127], v[104:107], v[120:123], a[124:127]
    s_waitcnt lgkmcnt(0)
    v_mfma_f32_16x16x32_bf16 a[0:3], v[124:127], v[156:159], a[0:3]
    v_mfma_f32_16x16x32_bf16 a[4:7], v[124:127], v[160:163], a[4:7]
    v_mfma_f32_16x16x32_bf16 a[8:11], v[124:127], v[164:167], a[8:11]
    v_mfma_f32_16x16x32_bf16 a[12:15], v[124:127], v[168:171], a[12:15]
    v_mfma_f32_16x16x32_bf16 a[16:19], v[128:131], v[156:159], a[16:19]
    v_mfma_f32_16x16x32_bf16 a[20:23], v[128:131], v[160:163], a[20:23]
    v_mfma_f32_16x16x32_bf16 a[24:27], v[128:131], v[164:167], a[24:27]
    v_mfma_f32_16x16x32_bf16 a[28:31], v[128:131], v[168:171], a[28:31]
    v_mfma_f32_16x16x32_bf16 a[32:35], v[132:135], v[156:159], a[32:35]
    v_mfma_f32_16x16x32_bf16 a[36:39], v[132:135], v[160:163], a[36:39]
    v_mfma_f32_16x16x32_bf16 a[40:43], v[132:135], v[164:167], a[40:43]
    v_mfma_f32_16x16x32_bf16 a[44:47], v[132:135], v[168:171], a[44:47]
    v_mfma_f32_16x16x32_bf16 a[48:51], v[136:139], v[156:159], a[48:51]
    v_mfma_f32_16x16x32_bf16 a[52:55], v[136:139], v[160:163], a[52:55]
    v_mfma_f32_16x16x32_bf16 a[56:59], v[136:139], v[164:167], a[56:59]
    v_mfma_f32_16x16x32_bf16 a[60:63], v[136:139], v[168:171], a[60:63]
    v_mfma_f32_16x16x32_bf16 a[64:67], v[140:143], v[156:159], a[64:67]
    v_mfma_f32_16x16x32_bf16 a[68:71], v[140:143], v[160:163], a[68:71]
    v_mfma_f32_16x16x32_bf16 a[72:75], v[140:143], v[164:167], a[72:75]
    v_mfma_f32_16x16x32_bf16 a[76:79], v[140:143], v[168:171], a[76:79]
    v_mfma_f32_16x16x32_bf16 a[80:83], v[144:147], v[156:159], a[80:83]
    v_mfma_f32_16x16x32_bf16 a[84:87], v[144:147], v[160:163], a[84:87]
    v_mfma_f32_16x16x32_bf16 a[88:91], v[144:147], v[164:167], a[88:91]
    v_mfma_f32_16x16x32_bf16 a[92:95], v[144:147], v[168:171], a[92:95]
    v_mfma_f32_16x16x32_bf16 a[96:99], v[148:151], v[156:159], a[96:99]
    v_mfma_f32_16x16x32_bf16 a[100:103], v[148:151], v[160:163], a[100:103]
    v_mfma_f32_16x16x32_bf16 a[104:107], v[148:151], v[164:167], a[104:107]
    v_mfma_f32_16x16x32_bf16 a[108:111], v[148:151], v[168:171], a[108:111]
    v_mfma_f32_16x16x32_bf16 a[112:115], v[152:155], v[156:159], a[112:115]
    v_mfma_f32_16x16x32_bf16 a[116:119], v[152:155], v[160:163], a[116:119]
    v_mfma_f32_16x16x32_bf16 a[120:123], v[152:155], v[164:167], a[120:123]
    v_mfma_f32_16x16x32_bf16 a[124:127], v[152:155], v[168:171], a[124:127]
    s_nop 7
    s_sub_u32 s78, s78, 1
    s_cmp_lg_u32 s78, 0
    s_cbranch_scc1 mbt2_nofetch
    s_cmp_lg_u32 s61, 0
    s_cbranch_scc1 if_skip_21
    s_mov_b64 exec, 1
    v_accvgpr_write_b32 a255, 1
    v_mov_b32 v3, 0
    s_nop 1
    buffer_atomic_add a255, v3, s[56:59], s75 offen sc0 sc1
    s_mov_b64 exec, -1
if_skip_21:
mbt2_nofetch:
    s_lshr_b32 s24, s61, 1
    s_lshl_b32 s24, s24, 1
    s_add_u32 s24, s24, s70
    s_cmp_ge_u32 s24, 4
    s_cbranch_scc1 mbt2_skip
    v_and_b32 v60, 15, v0
    v_bfe_u32 v61, v0, 4, 2
    v_lshrrev_b32 v62, 7, v0
    v_bfe_u32 v63, v0, 6, 1
    v_lshrrev_b32 v64, 3, v60
    v_lshl_add_u32 v64, v63, 3, v64
    s_mov_b32 s24, 327680
    v_mul_lo_u32 v64, v64, s24
    v_and_b32 v65, 7, v60
    v_lshl_add_u32 v64, v65, 4, v64
    v_lshl_add_u32 v64, v61, 8, v64
    v_lshl_add_u32 v60, v62, 14, v64
    v_accvgpr_read_b32 v148, a0
    v_accvgpr_read_b32 v149, a1
    v_accvgpr_read_b32 v150, a2
    v_accvgpr_read_b32 v151, a3
    v_cvt_pk_bf16_f32 v76, v148, v149
    v_cvt_pk_bf16_f32 v77, v150, v151
    v_accvgpr_read_b32 v152, a16
    v_accvgpr_read_b32 v153, a17
    v_accvgpr_read_b32 v154, a18
    v_accvgpr_read_b32 v155, a19
    v_cvt_pk_bf16_f32 v78, v152, v153
    v_cvt_pk_bf16_f32 v79, v154, v155
    s_nop 1
    v_permlane32_swap_b32 v76, v78
    v_permlane32_swap_b32 v77, v79
    s_nop 1
    v_permlane16_swap_b32 v76, v78
    v_permlane16_swap_b32 v77, v79
    v_add_u32 v66, 0, v60
    buffer_store_dwordx4 v[76:79], v66, s[16:19], s23 offen sc1
    v_accvgpr_read_b32 v148, a32
    v_accvgpr_read_b32 v149, a33
    v_accvgpr_read_b32 v150, a34
    v_accvgpr_read_b32 v151, a35
    v_cvt_pk_bf16_f32 v84, v148, v149
    v_cvt_pk_bf16_f32 v85, v150, v151
    v_accvgpr_read_b32 v152, a48
    v_accvgpr_read_b32 v153, a49
    v_accvgpr_read_b32 v154, a50
    v_accvgpr_read_b32 v155, a51
    v_cvt_pk_bf16_f32 v86, v152, v153
    v_cvt_pk_bf16_f32 v87, v154, v155
    s_nop 1
    v_permlane32_swap_b32 v84, v86
    v_permlane32_swap_b32 v85, v87
    s_nop 1
    v_permlane16_swap_b32 v84, v86
    v_permlane16_swap_b32 v85, v87
    v_add_u32 v66, 4096, v60
    buffer_store_dwordx4 v[84:87], v66, s[16:19], s23 offen sc1
    v_accvgpr_read_b32 v148, a64
    v_accvgpr_read_b32 v149, a65
    v_accvgpr_read_b32 v150, a66
    v_accvgpr_read_b32 v151, a67
    v_cvt_pk_bf16_f32 v92, v148, v149
    v_cvt_pk_bf16_f32 v93, v150, v151
    v_accvgpr_read_b32 v152, a80
    v_accvgpr_read_b32 v153, a81
    v_accvgpr_read_b32 v154, a82
    v_accvgpr_read_b32 v155, a83
    v_cvt_pk_bf16_f32 v94, v152, v153
    v_cvt_pk_bf16_f32 v95, v154, v155
    s_nop 1
    v_permlane32_swap_b32 v92, v94
    v_permlane32_swap_b32 v93, v95
    s_nop 1
    v_permlane16_swap_b32 v92, v94
    v_permlane16_swap_b32 v93, v95
    v_add_u32 v66, 8192, v60
    buffer_store_dwordx4 v[92:95], v66, s[16:19], s23 offen sc1
    v_accvgpr_read_b32 v148, a96
    v_accvgpr_read_b32 v149, a97
    v_accvgpr_read_b32 v150, a98
    v_accvgpr_read_b32 v151, a99
    v_cvt_pk_bf16_f32 v100, v148, v149
    v_cvt_pk_bf16_f32 v101, v150, v151
    v_accvgpr_read_b32 v152, a112
    v_accvgpr_read_b32 v153, a113
    v_accvgpr_read_b32 v154, a114
    v_accvgpr_read_b32 v155, a115
    v_cvt_pk_bf16_f32 v102, v152, v153
    v_cvt_pk_bf16_f32 v103, v154, v155
    s_nop 1
    v_permlane32_swap_b32 v100, v102
    v_permlane32_swap_b32 v101, v103
    s_nop 1
    v_permlane16_swap_b32 v100, v102
    v_permlane16_swap_b32 v101, v103
    v_add_u32 v66, 12288, v60
    buffer_store_dwordx4 v[100:103], v66, s[16:19], s23 offen sc1
    v_add_u32 v60, 655360, v60
    v_accvgpr_read_b32 v148, a4
    v_accvgpr_read_b32 v149, a5
    v_accvgpr_read_b32 v150, a6
    v_accvgpr_read_b32 v151, a7
    v_cvt_pk_bf16_f32 v108, v148, v149
    v_cvt_pk_bf16_f32 v109, v150, v151
    v_accvgpr_read_b32 v152, a20
    v_accvgpr_read_b32 v153, a21
    v_accvgpr_read_b32 v154, a22
    v_accvgpr_read_b32 v155, a23
    v_cvt_pk_bf16_f32 v110, v152, v153
    v_cvt_pk_bf16_f32 v111, v154, v155
    s_nop 1
    v_permlane32_swap_b32 v108, v110
    v_permlane32_swap_b32 v109, v111
    s_nop 1
    v_permlane16_swap_b32 v108, v110
    v_permlane16_swap_b32 v109, v111
    v_add_u32 v66, 0, v60
    buffer_store_dwordx4 v[108:111], v66, s[16:19], s23 offen sc1
    v_accvgpr_read_b32 v148, a36
    v_accvgpr_read_b32 v149, a37
    v_accvgpr_read_b32 v150, a38
    v_accvgpr_read_b32 v151, a39
    v_cvt_pk_bf16_f32 v116, v148, v149
    v_cvt_pk_bf16_f32 v117, v150, v151
    v_accvgpr_read_b32 v152, a52
    v_accvgpr_read_b32 v153, a53
    v_accvgpr_read_b32 v154, a54
    v_accvgpr_read_b32 v155, a55
    v_cvt_pk_bf16_f32 v118, v152, v153
    v_cvt_pk_bf16_f32 v119, v154, v155
    s_nop 1
    v_permlane32_swap_b32 v116, v118
    v_permlane32_swap_b32 v117, v119
    s_nop 1
    v_permlane16_swap_b32 v116, v118
    v_permlane16_swap_b32 v117, v119
    v_add_u32 v66, 4096, v60
    buffer_store_dwordx4 v[116:119], v66, s[16:19], s23 offen sc1
    v_accvgpr_read_b32 v148, a68
    v_accvgpr_read_b32 v149, a69
    v_accvgpr_read_b32 v150, a70
    v_accvgpr_read_b32 v151, a71
    v_cvt_pk_bf16_f32 v124, v148, v149
    v_cvt_pk_bf16_f32 v125, v150, v151
    v_accvgpr_read_b32 v152, a84
    v_accvgpr_read_b32 v153, a85
    v_accvgpr_read_b32 v154, a86
    v_accvgpr_read_b32 v155, a87
    v_cvt_pk_bf16_f32 v126, v152, v153
    v_cvt_pk_bf16_f32 v127, v154, v155
    s_nop 1
    v_permlane32_swap_b32 v124, v126
    v_permlane32_swap_b32 v125, v127
    s_nop 1
    v_permlane16_swap_b32 v124, v126
    v_permlane16_swap_b32 v125, v127
    v_add_u32 v66, 8192, v60
    buffer_store_dwordx4 v[124:127], v66, s[16:19], s23 offen sc1
    v_accvgpr_read_b32 v148, a100
    v_accvgpr_read_b32 v149, a101
    v_accvgpr_read_b32 v150, a102
    v_accvgpr_read_b32 v151, a103
    v_cvt_pk_bf16_f32 v132, v148, v149
    v_cvt_pk_bf16_f32 v133, v150, v151
    v_accvgpr_read_b32 v152, a116
    v_accvgpr_read_b32 v153, a117
    v_accvgpr_read_b32 v154, a118
    v_accvgpr_read_b32 v155, a119
    v_cvt_pk_bf16_f32 v134, v152, v153
    v_cvt_pk_bf16_f32 v135, v154, v155
    s_nop 1
    v_permlane32_swap_b32 v132, v134
    v_permlane32_swap_b32 v133, v135
    s_nop 1
    v_permlane16_swap_b32 v132, v134
    v_permlane16_swap_b32 v133, v135
    v_add_u32 v66, 12288, v60
    buffer_store_dwordx4 v[132:135], v66, s[16:19], s23 offen sc1
    v_add_u32 v60, 655360, v60
    v_accvgpr_read_b32 v148, a8
    v_accvgpr_read_b32 v149, a9
    v_accvgpr_read_b32 v150, a10
    v_accvgpr_read_b32 v151, a11
    v_cvt_pk_bf16_f32 v76, v148, v149
    v_cvt_pk_bf16_f32 v77, v150, v151
    v_accvgpr_read_b32 v152, a24
    v_accvgpr_read_b32 v153, a25
    v_accvgpr_read_b32 v154, a26
    v_accvgpr_read_b32 v155, a27
    v_cvt_pk_bf16_f32 v78, v152, v153
    v_cvt_pk_bf16_f32 v79, v154, v155
    s_nop 1
    v_permlane32_swap_b32 v76, v78
    v_permlane32_swap_b32 v77, v79
    s_nop 1
    v_permlane16_swap_b32 v76, v78
    v_permlane16_swap_b32 v77, v79
    v_add_u32 v66, 0, v60
    buffer_store_dwordx4 v[76:79], v66, s[16:19], s23 offen sc1
    v_accvgpr_read_b32 v148, a40
    v_accvgpr_read_b32 v149, a41
    v_accvgpr_read_b32 v150, a42
    v_accvgpr_read_b32 v151, a43
    v_cvt_pk_bf16_f32 v84, v148, v149
    v_cvt_pk_bf16_f32 v85, v150, v151
    v_accvgpr_read_b32 v152, a56
    v_accvgpr_read_b32 v153, a57
    v_accvgpr_read_b32 v154, a58
    v_accvgpr_read_b32 v155, a59
    v_cvt_pk_bf16_f32 v86, v152, v153
    v_cvt_pk_bf16_f32 v87, v154, v155
    s_nop 1
    v_permlane32_swap_b32 v84, v86
    v_permlane32_swap_b32 v85, v87
    s_nop 1
    v_permlane16_swap_b32 v84, v86
    v_permlane16_swap_b32 v85, v87
    v_add_u32 v66, 4096, v60
    buffer_store_dwordx4 v[84:87], v66, s[16:19], s23 offen sc1
    v_accvgpr_read_b32 v148, a72
    v_accvgpr_read_b32 v149, a73
    v_accvgpr_read_b32 v150, a74
    v_accvgpr_read_b32 v151, a75
    v_cvt_pk_bf16_f32 v92, v148, v149
    v_cvt_pk_bf16_f32 v93, v150, v151
    v_accvgpr_read_b32 v152, a88
    v_accvgpr_read_b32 v153, a89
    v_accvgpr_read_b32 v154, a90
    v_accvgpr_read_b32 v155, a91
    v_cvt_pk_bf16_f32 v94, v152, v153
    v_cvt_pk_bf16_f32 v95, v154, v155
    s_nop 1
    v_permlane32_swap_b32 v92, v94
    v_permlane32_swap_b32 v93, v95
    s_nop 1
    v_permlane16_swap_b32 v92, v94
    v_permlane16_swap_b32 v93, v95
    v_add_u32 v66, 8192, v60
    buffer_store_dwordx4 v[92:95], v66, s[16:19], s23 offen sc1
    v_accvgpr_read_b32 v148, a104
    v_accvgpr_read_b32 v149, a105
    v_accvgpr_read_b32 v150, a106
    v_accvgpr_read_b32 v151, a107
    v_cvt_pk_bf16_f32 v100, v148, v149
    v_cvt_pk_bf16_f32 v101, v150, v151
    v_accvgpr_read_b32 v152, a120
    v_accvgpr_read_b32 v153, a121
    v_accvgpr_read_b32 v154, a122
    v_accvgpr_read_b32 v155, a123
    v_cvt_pk_bf16_f32 v102, v152, v153
    v_cvt_pk_bf16_f32 v103, v154, v155
    s_nop 1
    v_permlane32_swap_b32 v100, v102
    v_permlane32_swap_b32 v101, v103
    s_nop 1
    v_permlane16_swap_b32 v100, v102
    v_permlane16_swap_b32 v101, v103
    v_add_u32 v66, 12288, v60
    buffer_store_dwordx4 v[100:103], v66, s[16:19], s23 offen sc1
    v_add_u32 v60, 655360, v60
    v_accvgpr_read_b32 v148, a12
    v_accvgpr_read_b32 v149, a13
    v_accvgpr_read_b32 v150, a14
    v_accvgpr_read_b32 v151, a15
    v_cvt_pk_bf16_f32 v108, v148, v149
    v_cvt_pk_bf16_f32 v109, v150, v151
    v_accvgpr_read_b32 v152, a28
    v_accvgpr_read_b32 v153, a29
    v_accvgpr_read_b32 v154, a30
    v_accvgpr_read_b32 v155, a31
    v_cvt_pk_bf16_f32 v110, v152, v153
    v_cvt_pk_bf16_f32 v111, v154, v155
    s_nop 1
    v_permlane32_swap_b32 v108, v110
    v_permlane32_swap_b32 v109, v111
    s_nop 1
    v_permlane16_swap_b32 v108, v110
    v_permlane16_swap_b32 v109, v111
    v_add_u32 v66, 0, v60
    buffer_store_dwordx4 v[108:111], v66, s[16:19], s23 offen sc1
    v_accvgpr_read_b32 v148, a44
    v_accvgpr_read_b32 v149, a45
    v_accvgpr_read_b32 v150, a46
    v_accvgpr_read_b32 v151, a47
    v_cvt_pk_bf16_f32 v116, v148, v149
    v_cvt_pk_bf16_f32 v117, v150, v151
    v_accvgpr_read_b32 v152, a60
    v_accvgpr_read_b32 v153, a61
    v_accvgpr_read_b32 v154, a62
    v_accvgpr_read_b32 v155, a63
    v_cvt_pk_bf16_f32 v118, v152, v153
    v_cvt_pk_bf16_f32 v119, v154, v155
    s_nop 1
    v_permlane32_swap_b32 v116, v118
    v_permlane32_swap_b32 v117, v119
    s_nop 1
    v_permlane16_swap_b32 v116, v118
    v_permlane16_swap_b32 v117, v119
    v_add_u32 v66, 4096, v60
    buffer_store_dwordx4 v[116:119], v66, s[16:19], s23 offen sc1
    v_accvgpr_read_b32 v148, a76
    v_accvgpr_read_b32 v149, a77
    v_accvgpr_read_b32 v150, a78
    v_accvgpr_read_b32 v151, a79
    v_cvt_pk_bf16_f32 v124, v148, v149
    v_cvt_pk_bf16_f32 v125, v150, v151
    v_accvgpr_read_b32 v152, a92
    v_accvgpr_read_b32 v153, a93
    v_accvgpr_read_b32 v154, a94
    v_accvgpr_read_b32 v155, a95
    v_cvt_pk_bf16_f32 v126, v152, v153
    v_cvt_pk_bf16_f32 v127, v154, v155
    s_nop 1
    v_permlane32_swap_b32 v124, v126
    v_permlane32_swap_b32 v125, v127
    s_nop 1
    v_permlane16_swap_b32 v124, v126
    v_permlane16_swap_b32 v125, v127
    v_add_u32 v66, 8192, v60
    buffer_store_dwordx4 v[124:127], v66, s[16:19], s23 offen sc1
    v_accvgpr_read_b32 v148, a108
    v_accvgpr_read_b32 v149, a109
    v_accvgpr_read_b32 v150, a110
    v_accvgpr_read_b32 v151, a111
    v_cvt_pk_bf16_f32 v132, v148, v149
    v_cvt_pk_bf16_f32 v133, v150, v151
    v_accvgpr_read_b32 v152, a124
    v_accvgpr_read_b32 v153, a125
    v_accvgpr_read_b32 v154, a126
    v_accvgpr_read_b32 v155, a127
    v_cvt_pk_bf16_f32 v134, v152, v153
    v_cvt_pk_bf16_f32 v135, v154, v155
    s_nop 1
    v_permlane32_swap_b32 v132, v134
    v_permlane32_swap_b32 v133, v135
    s_nop 1
    v_permlane16_swap_b32 v132, v134
    v_permlane16_swap_b32 v133, v135
    v_add_u32 v66, 12288, v60
    buffer_store_dwordx4 v[132:135], v66, s[16:19], s23 offen sc1
mbt2_skip:
    s_add_u32 s23, s23, 5242880
    s_cmp_lg_u32 s78, 0
    s_cbranch_scc1 mbt2_chunk
    s_waitcnt vmcnt(0)
    s_xor_b32 s66, s66, 16
    v_mov_b32 v3, 160000
    v_add_u32 v3, s66, v3
    s_cmp_lg_u32 s61, 0
    s_cbranch_scc1 fi1_22
    v_accvgpr_read_b32 v2, a255
    s_mov_b64 exec, 1
    ds_write_b32 v3, v2
    s_mov_b64 exec, -1
    s_waitcnt lgkmcnt(0)
fi1_22:
    s_barrier
    ds_read_b32 v4, v3
    s_cmp_lg_u32 s61, 0
    s_cbranch_scc1 fi2_23
    s_mov_b64 exec, 1
    v_mov_b32 v6, 1
    v_mov_b32 v7, 0
    buffer_atomic_add v6, v7, s[56:59], s74 offen sc1
    s_mov_b64 exec, -1
fi2_23:
    s_waitcnt lgkmcnt(0)
    v_readfirstlane_b32 s62, v4
    s_nop 3
    s_cmp_eq_u32 s63, 0
    s_cbranch_scc1 mega_decA
    s_branch mega_decB
blk_down:
    s_load_dwordx2 s[32:33], s[0:1], 80
    s_add_u32 s53, s70, 32
    s_lshl_b32 s53, s53, 7
    s_mov_b32 s40, 0
wf_24:
    v_mov_b32 v2, 0
    buffer_load_dword v2, v2, s[56:59], s53 offen sc1
    s_waitcnt vmcnt(0)
    v_readfirstlane_b32 s39, v2
    s_nop 3
    s_cmp_ge_u32 s39, 16
    s_cbranch_scc1 wf_ok_25
    s_sleep 32
    s_add_u32 s40, s40, 1
    s_cmp_lt_u32 s40, 2097152
    s_cbranch_scc1 wf_24
    s_branch chain_fail
wf_ok_25:
    s_add_u32 s8, s64, 188219392
    s_addc_u32 s9, s65, 0
    s_mov_b32 s10, 6291456
    s_mov_b32 s11, 0x00020000
    s_add_u32 s16, s64, 223752192
    s_addc_u32 s17, s65, 0
    s_mov_b32 s18, 2621440
    s_mov_b32 s19, 0x00020000
    s_waitcnt lgkmcnt(0)
    s_mov_b32 s12, s32
    s_mov_b32 s13, s33
    s_mov_b32 s14, 1966080
    s_mov_b32 s15, 0x00020000
    s_mul_i32 s20, s70, 786432
    s_mul_i32 s21, s71, 320
    s_mul_i32 s23, s70, 327680
    s_add_u32 s23, s23, s21
    s_add_u32 s74, s70, 40
    s_lshl_b32 s74, s74, 7
    v_lshrrev_b32 v1, 3, v0
    v_and_b32 v60, 7, v0
    s_mov_b32 s24, 3072
    v_mul_lo_u32 v2, v1, s24
    v_lshl_add_u32 v2, v60, 4, v2
    v_add_u32 v3, 98304, v2
    v_add_u32 v4, 196608, v2
    v_add_u32 v5, 294912, v2
    v_add_u32 v6, 393216, v2
    v_add_u32 v7, 491520, v2
    v_add_u32 v8, 589824, v2
    v_add_u32 v9, 688128, v2
    v_mul_u32_u24 v12, 144, v1
    v_lshl_add_u32 v12, v60, 4, v12
    v_add_u32 v13, 59392, v12
    v_lshrrev_b32 v61, 2, v0
    v_and_b32 v62, 3, v0
    s_mov_b32 s24, 1280
    v_mul_lo_u32 v10, v61, s24
    v_lshl_add_u32 v10, v62, 4, v10
    v_mul_u32_u24 v14, 352, v61
    v_lshl_add_u32 v14, v62, 4, v14
    v_add_u32 v14, 36864, v14
    v_add_u32 v15, 59392, v14
    v_and_b32 v60, 15, v0
    v_bfe_u32 v61, v0, 4, 2
    v_lshrrev_b32 v62, 7, v0
    v_bfe_u32 v63, v0, 6, 1
    v_lshl_add_u32 v64, v62, 7, v60
    v_mul_u32_u24 v16, 144, v64
    v_lshl_add_u32 v16, v61, 3, v16
    v_add_u32 v17, 59392, v16
    v_lshrrev_b32 v64, 2, v60
    v_lshl_add_u32 v64, v61, 2, v64
    v_mul_u32_u24 v18, 352, v64
    v_and_b32 v64, 3, v60
    v_lshl_add_u32 v18, v64, 3, v18
    v_mul_u32_u24 v64, 160, v63
    v_add_u32 v18, v64, v18
    v_add_u32 v18, 36864, v18
    v_add_u32 v19, 59392, v18
    buffer_load_dwordx4 v[20:23], v2, s[8:11], s20 offen sc1
    buffer_load_dwordx4 v[24:27], v3, s[8:11], s20 offen sc1
    buffer_load_dwordx4 v[28:31], v4, s[8:11], s20 offen sc1
    buffer_load_dwordx4 v[32:35], v5, s[8:11], s20 offen sc1
    buffer_load_dwordx4 v[36:39], v6, s[8:11], s20 offen sc1
    buffer_load_dwordx4 v[40:43], v7, s[8:11], s20 offen sc1
    buffer_load_dwordx4 v[44:47], v8, s[8:11], s20 offen sc1
    buffer_load_dwordx4 v[48:51], v9, s[8:11], s20 offen sc1
    buffer_load_dwordx4 v[52:55], v10, s[12:15], s21 offen offset:0
    buffer_load_dwordx4 v[56:59], v10, s[12:15], s21 offen offset:64
    buffer_load_dwordx4 v[60:63], v10, s[12:15], s21 offen offset:128
    buffer_load_dwordx4 v[64:67], v10, s[12:15], s21 offen offset:192
    buffer_load_dwordx4 v[68:71], v10, s[12:15], s21 offen offset:256
    s_add_u32 s20, s20, 128
    s_add_u32 s21, s21, 81920
    buffer_load_dwordx4 v[188:191], v2, s[8:11], s20 offen sc1
    buffer_load_dwordx4 v[192:195], v3, s[8:11], s20 offen sc1
    buffer_load_dwordx4 v[196:199], v4, s[8:11], s20 offen sc1
    buffer_load_dwordx4 v[200:203], v5, s[8:11], s20 offen sc1
    buffer_load_dwordx4 v[204:207], v6, s[8:11], s20 offen sc1
    buffer_load_dwordx4 v[208:211], v7, s[8:11], s20 offen sc1
    buffer_load_dwordx4 v[212:215], v8, s[8:11], s20 offen sc1
    buffer_load_dwordx4 v[216:219], v9, s[8:11], s20 offen sc1
    buffer_load_dwordx4 v[220:223], v10, s[12:15], s21 offen offset:0
    buffer_load_dwordx4 v[224:227], v10, s[12:15], s21 offen offset:64
    buffer_load_dwordx4 v[228:231], v10, s[12:15], s21 offen offset:128
    buffer_load_dwordx4 v[232:235], v10, s[12:15], s21 offen offset:192
    buffer_load_dwordx4 v[236:239], v10, s[12:15], s21 offen offset:256
    s_add_u32 s20, s20, 128
    s_add_u32 s21, s21, 81920
    v_accvgpr_write_b32 a0, 0
    v_accvgpr_write_b32 a1, 0
    v_accvgpr_write_b32 a2, 0
    v_accvgpr_write_b32 a3, 0
    v_accvgpr_write_b32 a4, 0
    v_accvgpr_write_b32 a5, 0
    v_accvgpr_write_b32 a6, 0
    v_accvgpr_write_b32 a7, 0
    v_accvgpr_write_b32 a8, 0
    v_accvgpr_write_b32 a9, 0
    v_accvgpr_write_b32 a10, 0
    v_accvgpr_write_b32 a11, 0
    v_accvgpr_write_b32 a12, 0
    v_accvgpr_write_b32 a13, 0
    v_accvgpr_write_b32 a14, 0
    v_accvgpr_write_b32 a15, 0
    v_accvgpr_write_b32 a16, 0
    v_accvgpr_write_b32 a17, 0
    v_accvgpr_write_b32 a18, 0
    v_accvgpr_write_b32 a19, 0
    v_accvgpr_write_b32 a20, 0
    v_accvgpr_write_b32 a21, 0
    v_accvgpr_write_b32 a22, 0
    v_accvgpr_write_b32 a23, 0
    v_accvgpr_write_b32 a24, 0
    v_accvgpr_write_b32 a25, 0
    v_accvgpr_write_b32 a26, 0
    v_accvgpr_write_b32 a27, 0
    v_accvgpr_write_b32 a28, 0
    v_accvgpr_write_b32 a29, 0
    v_accvgpr_write_b32 a30, 0
    v_accvgpr_write_b32 a31, 0
    v_accvgpr_write_b32 a32, 0
    v_accvgpr_write_b32 a33, 0
    v_accvgpr_write_b32 a34, 0
    v_accvgpr_write_b32 a35, 0
    v_accvgpr_write_b32 a36, 0
    v_accvgpr_write_b32 a37, 0
    v_accvgpr_write_b32 a38, 0
    v_accvgpr_write_b32 a39, 0
    v_accvgpr_write_b32 a40, 0
    v_accvgpr_write_b32 a41, 0
    v_accvgpr_write_b32 a42, 0
    v_accvgpr_write_b32 a43, 0
    v_accvgpr_write_b32 a44, 0
    v_accvgpr_write_b32 a45, 0
    v_accvgpr_write_b32 a46, 0
    v_accvgpr_write_b32 a47, 0
    v_accvgpr_write_b32 a48, 0
    v_accvgpr_write_b32 a49, 0
    v_accvgpr_write_b32 a50, 0
    v_accvgpr_write_b32 a51, 0
    v_accvgpr_write_b32 a52, 0
    v_accvgpr_write_b32 a53, 0
    v_accvgpr_write_b32 a54, 0
    v_accvgpr_write_b32 a55, 0
    v_accvgpr_write_b32 a56, 0
    v_accvgpr_write_b32 a57, 0
    v_accvgpr_write_b32 a58, 0
    v_accvgpr_write_b32 a59, 0
    v_accvgpr_write_b32 a60, 0
    v_accvgpr_write_b32 a61, 0
    v_accvgpr_write_b32 a62, 0
    v_accvgpr_write_b32 a63, 0
    v_accvgpr_write_b32 a64, 0
    v_accvgpr_write_b32 a65, 0
    v_accvgpr_write_b32 a66, 0
    v_accvgpr_write_b32 a67, 0
    v_accvgpr_write_b32 a68, 0
    v_accvgpr_write_b32 a69, 0
    v_accvgpr_write_b32 a70, 0
    v_accvgpr_write_b32 a71, 0
    v_accvgpr_write_b32 a72, 0
    v_accvgpr_write_b32 a73, 0
    v_accvgpr_write_b32 a74, 0
    v_accvgpr_write_b32 a75, 0
    v_accvgpr_write_b32 a76, 0
    v_accvgpr_write_b32 a77, 0
    v_accvgpr_write_b32 a78, 0
    v_accvgpr_write_b32 a79, 0
    v_accvgpr_write_b32 a80, 0
    v_accvgpr_write_b32 a81, 0
    v_accvgpr_write_b32 a82, 0
    v_accvgpr_write_b32 a83, 0
    v_accvgpr_write_b32 a84, 0
    v_accvgpr_write_b32 a85, 0
    v_accvgpr_write_b32 a86, 0
    v_accvgpr_write_b32 a87, 0
    v_accvgpr_write_b32 a88, 0
    v_accvgpr_write_b32 a89, 0
    v_accvgpr_write_b32 a90, 0
    v_accvgpr_write_b32 a91, 0
    v_accvgpr_write_b32 a92, 0
    v_accvgpr_write_b32 a93, 0
    v_accvgpr_write_b32 a94, 0
    v_accvgpr_write_b32 a95, 0
    v_accvgpr_write_b32 a96, 0
    v_accvgpr_write_b32 a97, 0
    v_accvgpr_write_b32 a98, 0
    v_accvgpr_write_b32 a99, 0
    v_accvgpr_write_b32 a100, 0
    v_accvgpr_write_b32 a101, 0
    v_accvgpr_write_b32 a102, 0
    v_accvgpr_write_b32 a103, 0
    v_accvgpr_write_b32 a104, 0
    v_accvgpr_write_b32 a105, 0
    v_accvgpr_write_b32 a106, 0
    v_accvgpr_write_b32 a107, 0
    v_accvgpr_write_b32 a108, 0
    v_accvgpr_write_b32 a109, 0
    v_accvgpr_write_b32 a110, 0
    v_accvgpr_write_b32 a111, 0
    v_accvgpr_write_b32 a112, 0
    v_accvgpr_write_b32 a113, 0
    v_accvgpr_write_b32 a114, 0
    v_accvgpr_write_b32 a115, 0
    v_accvgpr_write_b32 a116, 0
    v_accvgpr_write_b32 a117, 0
    v_accvgpr_write_b32 a118, 0
    v_accvgpr_write_b32 a119, 0
    v_accvgpr_write_b32 a120, 0
    v_accvgpr_write_b32 a121, 0
    v_accvgpr_write_b32 a122, 0
    v_accvgpr_write_b32 a123, 0
    v_accvgpr_write_b32 a124, 0
    v_accvgpr_write_b32 a125, 0
    v_accvgpr_write_b32 a126, 0
    v_accvgpr_write_b32 a127, 0
    v_accvgpr_write_b32 a128, 0
    v_accvgpr_write_b32 a129, 0
    v_accvgpr_write_b32 a130, 0
    v_accvgpr_write_b32 a131, 0
    v_accvgpr_write_b32 a132, 0
    v_accvgpr_write_b32 a133, 0
    v_accvgpr_write_b32 a134, 0
    v_accvgpr_write_b32 a135, 0
    v_accvgpr_write_b32 a136, 0
    v_accvgpr_write_b32 a137, 0
    v_accvgpr_write_b32 a138, 0
    v_accvgpr_write_b32 a139, 0
    v_accvgpr_write_b32 a140, 0
    v_accvgpr_write_b32 a141, 0
    v_accvgpr_write_b32 a142, 0
    v_accvgpr_write_b32 a143, 0
    v_accvgpr_write_b32 a144, 0
    v_accvgpr_write_b32 a145, 0
    v_accvgpr_write_b32 a146, 0
    v_accvgpr_write_b32 a147, 0
    v_accvgpr_write_b32 a148, 0
    v_accvgpr_write_b32 a149, 0
    v_accvgpr_write_b32 a150, 0
    v_accvgpr_write_b32 a151, 0
    v_accvgpr_write_b32 a152, 0
    v_accvgpr_write_b32 a153, 0
    v_accvgpr_write_b32 a154, 0
    v_accvgpr_write_b32 a155, 0
    v_accvgpr_write_b32 a156, 0
    v_accvgpr_write_b32 a157, 0
    v_accvgpr_write_b32 a158, 0
    v_accvgpr_write_b32 a159, 0
    s_waitcnt vmcnt(13)
    ds_write_b128 v12, v[20:23] offset:0
    ds_write_b128 v12, v[24:27] offset:4608
    ds_write_b128 v12, v[28:31] offset:9216
    ds_write_b128 v12, v[32:35] offset:13824
    ds_write_b128 v12, v[36:39] offset:18432
    ds_write_b128 v12, v[40:43] offset:23040
    ds_write_b128 v12, v[44:47] offset:27648
    ds_write_b128 v12, v[48:51] offset:32256
    ds_write_b128 v14, v[52:55] offset:0
    ds_write_b128 v14, v[56:59] offset:64
    ds_write_b128 v14, v[60:63] offset:128
    ds_write_b128 v14, v[64:67] offset:192
    ds_write_b128 v14, v[68:71] offset:256
    s_waitcnt lgkmcnt(0)
    buffer_load_dwordx4 v[20:23], v2, s[8:11], s20 offen sc1
    buffer_load_dwordx4 v[24:27], v3, s[8:11], s20 offen sc1
    buffer_load_dwordx4 v[28:31], v4, s[8:11], s20 offen sc1
    buffer_load_dwordx4 v[32:35], v5, s[8:11], s20 offen sc1
    buffer_load_dwordx4 v[36:39], v6, s[8:11], s20 offen sc1
    buffer_load_dwordx4 v[40:43], v7, s[8:11], s20 offen sc1
    buffer_load_dwordx4 v[44:47], v8, s[8:11], s20 offen sc1
    buffer_load_dwordx4 v[48:51], v9, s[8:11], s20 offen sc1
    buffer_load_dwordx4 v[52:55], v10, s[12:15], s21 offen offset:0
    buffer_load_dwordx4 v[56:59], v10, s[12:15], s21 offen offset:64
    buffer_load_dwordx4 v[60:63], v10, s[12:15], s21 offen offset:128
    buffer_load_dwordx4 v[64:67], v10, s[12:15], s21 offen offset:192
    buffer_load_dwordx4 v[68:71], v10, s[12:15], s21 offen offset:256
    s_add_u32 s20, s20, 128
    s_add_u32 s21, s21, 81920
    s_barrier
    ds_read_b64_tr_b16 v[108:109], v18 offset:0
    ds_read_b64_tr_b16 v[110:111], v18 offset:5632
    ds_read_b64_tr_b16 v[112:113], v18 offset:32
    ds_read_b64_tr_b16 v[114:115], v18 offset:5664
    ds_read_b64_tr_b16 v[116:117], v18 offset:64
    ds_read_b64_tr_b16 v[118:119], v18 offset:5696
    ds_read_b64_tr_b16 v[120:121], v18 offset:96
    ds_read_b64_tr_b16 v[122:123], v18 offset:5728
    ds_read_b64_tr_b16 v[124:125], v18 offset:128
    ds_read_b64_tr_b16 v[126:127], v18 offset:5760
    ds_read_b64 v[76:77], v16 offset:0
    ds_read_b64 v[78:79], v16 offset:32
    ds_read_b64 v[80:81], v16 offset:2304
    ds_read_b64 v[82:83], v16 offset:2336
    ds_read_b64 v[84:85], v16 offset:4608
    ds_read_b64 v[86:87], v16 offset:4640
    ds_read_b64 v[88:89], v16 offset:6912
    ds_read_b64 v[90:91], v16 offset:6944
    ds_read_b64 v[92:93], v16 offset:9216
    ds_read_b64 v[94:95], v16 offset:9248
    ds_read_b64 v[96:97], v16 offset:11520
    ds_read_b64 v[98:99], v16 offset:11552
    ds_read_b64 v[100:101], v16 offset:13824
    ds_read_b64 v[102:103], v16 offset:13856
    ds_read_b64 v[104:105], v16 offset:16128
    ds_read_b64 v[106:107], v16 offset:16160
    s_mov_b32 s22, 24
    s_waitcnt lgkmcnt(0)
mdown_loop:
    v_mfma_f32_16x16x32_bf16 a[0:3], v[108:111], v[76:79], a[0:3]
    v_mfma_f32_16x16x32_bf16 a[4:7], v[112:115], v[76:79], a[4:7]
    ds_read_b64_tr_b16 v[164:165], v18 offset:11264
    v_mfma_f32_16x16x32_bf16 a[8:11], v[116:119], v[76:79], a[8:11]
    ds_read_b64_tr_b16 v[166:167], v18 offset:16896
    v_mfma_f32_16x16x32_bf16 a[12:15], v[120:123], v[76:79], a[12:15]
    ds_read_b64_tr_b16 v[168:169], v18 offset:11296
    v_mfma_f32_16x16x32_bf16 a[16:19], v[124:127], v[76:79], a[16:19]
    ds_read_b64_tr_b16 v[170:171], v18 offset:16928
    v_mfma_f32_16x16x32_bf16 a[20:23], v[108:111], v[80:83], a[20:23]
    ds_read_b64_tr_b16 v[172:173], v18 offset:11328
    v_mfma_f32_16x16x32_bf16 a[24:27], v[112:115], v[80:83], a[24:27]
    ds_read_b64_tr_b16 v[174:175], v18 offset:16960
    v_mfma_f32_16x16x32_bf16 a[28:31], v[116:119], v[80:83], a[28:31]
    ds_read_b64_tr_b16 v[176:177], v18 offset:11360
    v_mfma_f32_16x16x32_bf16 a[32:35], v[120:123], v[80:83], a[32:35]
    ds_read_b64_tr_b16 v[178:179], v18 offset:16992
    v_mfma_f32_16x16x32_bf16 a[36:39], v[124:127], v[80:83], a[36:39]
    ds_read_b64_tr_b16 v[180:181], v18 offset:11392
    v_mfma_f32_16x16x32_bf16 a[40:43], v[108:111], v[84:87], a[40:43]
    ds_read_b64_tr_b16 v[182:183], v18 offset:17024
    v_mfma_f32_16x16x32_bf16 a[44:47], v[112:115], v[84:87], a[44:47]
    ds_read_b64 v[132:133], v16 offset:64
    v_mfma_f32_16x16x32_bf16 a[48:51], v[116:119], v[84:87], a[48:51]
    ds_read_b64 v[134:135], v16 offset:96
    v_mfma_f32_16x16x32_bf16 a[52:55], v[120:123], v[84:87], a[52:55]
    ds_read_b64 v[136:137], v16 offset:2368
    v_mfma_f32_16x16x32_bf16 a[56:59], v[124:127], v[84:87], a[56:59]
    ds_read_b64 v[138:139], v16 offset:2400
    v_mfma_f32_16x16x32_bf16 a[60:63], v[108:111], v[88:91], a[60:63]
    ds_read_b64 v[140:141], v16 offset:4672
    v_mfma_f32_16x16x32_bf16 a[64:67], v[112:115], v[88:91], a[64:67]
    ds_read_b64 v[142:143], v16 offset:4704
    v_mfma_f32_16x16x32_bf16 a[68:71], v[116:119], v[88:91], a[68:71]
    ds_read_b64 v[144:145], v16 offset:6976
    v_mfma_f32_16x16x32_bf16 a[72:75], v[120:123], v[88:91], a[72:75]
    ds_read_b64 v[146:147], v16 offset:7008
    v_mfma_f32_16x16x32_bf16 a[76:79], v[124:127], v[88:91], a[76:79]
    ds_read_b64 v[148:149], v16 offset:9280
    v_mfma_f32_16x16x32_bf16 a[80:83], v[108:111], v[92:95], a[80:83]
    ds_read_b64 v[150:151], v16 offset:9312
    v_mfma_f32_16x16x32_bf16 a[84:87], v[112:115], v[92:95], a[84:87]
    ds_read_b64 v[152:153], v16 offset:11584
    v_mfma_f32_16x16x32_bf16 a[88:91], v[116:119], v[92:95], a[88:91]
    ds_read_b64 v[154:155], v16 offset:11616
    v_mfma_f32_16x16x32_bf16 a[92:95], v[120:123], v[92:95], a[92:95]
    ds_read_b64 v[156:157], v16 offset:13888
    v_mfma_f32_16x16x32_bf16 a[96:99], v[124:127], v[92:95], a[96:99]
    ds_read_b64 v[158:159], v16 offset:13920
    v_mfma_f32_16x16x32_bf16 a[100:103], v[108:111], v[96:99], a[100:103]
    ds_read_b64 v[160:161], v16 offset:16192
    v_mfma_f32_16x16x32_bf16 a[104:107], v[112:115], v[96:99], a[104:107]
    ds_read_b64 v[162:163], v16 offset:16224
    v_mfma_f32_16x16x32_bf16 a[108:111], v[116:119], v[96:99], a[108:111]
    v_mfma_f32_16x16x32_bf16 a[112:115], v[120:123], v[96:99], a[112:115]
    v_mfma_f32_16x16x32_bf16 a[116:119], v[124:127], v[96:99], a[116:119]
    v_mfma_f32_16x16x32_bf16 a[120:123], v[108:111], v[100:103], a[120:123]
    v_mfma_f32_16x16x32_bf16 a[124:127], v[112:115], v[100:103], a[124:127]
    v_mfma_f32_16x16x32_bf16 a[128:131], v[116:119], v[100:103], a[128:131]
    v_mfma_f32_16x16x32_bf16 a[132:135], v[120:123], v[100:103], a[132:135]
    v_mfma_f32_16x16x32_bf16 a[136:139], v[124:127], v[100:103], a[136:139]
    v_mfma_f32_16x16x32_bf16 a[140:143], v[108:111], v[104:107], a[140:143]
    v_mfma_f32_16x16x32_bf16 a[144:147], v[112:115], v[104:107], a[144:147]
    v_mfma_f32_16x16x32_bf16 a[148:151], v[116:119], v[104:107], a[148:151]
    v_mfma_f32_16x16x32_bf16 a[152:155], v[120:123], v[104:107], a[152:155]
    v_mfma_f32_16x16x32_bf16 a[156:159], v[124:127], v[104:107], a[156:159]
    s_waitcnt lgkmcnt(0)
    s_waitcnt vmcnt(13)
    v_mfma_f32_16x16x32_bf16 a[0:3], v[164:167], v[132:135], a[0:3]
    ds_write_b128 v13, v[188:191] offset:0
    v_mfma_f32_16x16x32_bf16 a[4:7], v[168:171], v[132:135], a[4:7]
    ds_write_b128 v13, v[192:195] offset:4608
    v_mfma_f32_16x16x32_bf16 a[8:11], v[172:175], v[132:135], a[8:11]
    ds_write_b128 v13, v[196:199] offset:9216
    v_mfma_f32_16x16x32_bf16 a[12:15], v[176:179], v[132:135], a[12:15]
    ds_write_b128 v13, v[200:203] offset:13824
    v_mfma_f32_16x16x32_bf16 a[16:19], v[180:183], v[132:135], a[16:19]
    ds_write_b128 v13, v[204:207] offset:18432
    v_mfma_f32_16x16x32_bf16 a[20:23], v[164:167], v[136:139], a[20:23]
    ds_write_b128 v13, v[208:211] offset:23040
    v_mfma_f32_16x16x32_bf16 a[24:27], v[168:171], v[136:139], a[24:27]
    ds_write_b128 v13, v[212:215] offset:27648
    v_mfma_f32_16x16x32_bf16 a[28:31], v[172:175], v[136:139], a[28:31]
    ds_write_b128 v13, v[216:219] offset:32256
    v_mfma_f32_16x16x32_bf16 a[32:35], v[176:179], v[136:139], a[32:35]
    ds_write_b128 v15, v[220:223] offset:0
    v_mfma_f32_16x16x32_bf16 a[36:39], v[180:183], v[136:139], a[36:39]
    ds_write_b128 v15, v[224:227] offset:64
    v_mfma_f32_16x16x32_bf16 a[40:43], v[164:167], v[140:143], a[40:43]
    ds_write_b128 v15, v[228:231] offset:128
    v_mfma_f32_16x16x32_bf16 a[44:47], v[168:171], v[140:143], a[44:47]
    ds_write_b128 v15, v[232:235] offset:192
    v_mfma_f32_16x16x32_bf16 a[48:51], v[172:175], v[140:143], a[48:51]
    ds_write_b128 v15, v[236:239] offset:256
    v_mfma_f32_16x16x32_bf16 a[52:55], v[176:179], v[140:143], a[52:55]
    v_mfma_f32_16x16x32_bf16 a[56:59], v[180:183], v[140:143], a[56:59]
    s_waitcnt lgkmcnt(0)
    s_barrier
    v_mfma_f32_16x16x32_bf16 a[60:63], v[164:167], v[144:147], a[60:63]
    ds_read_b64_tr_b16 v[108:109], v19 offset:0
    ds_read_b64_tr_b16 v[110:111], v19 offset:5632
    v_mfma_f32_16x16x32_bf16 a[64:67], v[168:171], v[144:147], a[64:67]
    buffer_load_dwordx4 v[188:191], v2, s[8:11], s20 offen sc1
    ds_read_b64_tr_b16 v[112:113], v19 offset:32
    v_mfma_f32_16x16x32_bf16 a[68:71], v[172:175], v[144:147], a[68:71]
    ds_read_b64_tr_b16 v[114:115], v19 offset:5664
    buffer_load_dwordx4 v[192:195], v3, s[8:11], s20 offen sc1
    v_mfma_f32_16x16x32_bf16 a[72:75], v[176:179], v[144:147], a[72:75]
    ds_read_b64_tr_b16 v[116:117], v19 offset:64
    ds_read_b64_tr_b16 v[118:119], v19 offset:5696
    v_mfma_f32_16x16x32_bf16 a[76:79], v[180:183], v[144:147], a[76:79]
    buffer_load_dwordx4 v[196:199], v4, s[8:11], s20 offen sc1
    ds_read_b64_tr_b16 v[120:121], v19 offset:96
    v_mfma_f32_16x16x32_bf16 a[80:83], v[164:167], v[148:151], a[80:83]
    ds_read_b64_tr_b16 v[122:123], v19 offset:5728
    buffer_load_dwordx4 v[200:203], v5, s[8:11], s20 offen sc1
    v_mfma_f32_16x16x32_bf16 a[84:87], v[168:171], v[148:151], a[84:87]
    ds_read_b64_tr_b16 v[124:125], v19 offset:128
    ds_read_b64_tr_b16 v[126:127], v19 offset:5760
    v_mfma_f32_16x16x32_bf16 a[88:91], v[172:175], v[148:151], a[88:91]
    buffer_load_dwordx4 v[204:207], v6, s[8:11], s20 offen sc1
    ds_read_b64 v[76:77], v17 offset:0
    v_mfma_f32_16x16x32_bf16 a[92:95], v[176:179], v[148:151], a[92:95]
    ds_read_b64 v[78:79], v17 offset:32
    buffer_load_dwordx4 v[208:211], v7, s[8:11], s20 offen sc1
    v_mfma_f32_16x16x32_bf16 a[96:99], v[180:183], v[148:151], a[96:99]
    ds_read_b64 v[80:81], v17 offset:2304
    ds_read_b64 v[82:83], v17 offset:2336
    v_mfma_f32_16x16x32_bf16 a[100:103], v[164:167], v[152:155], a[100:103]
    buffer_load_dwordx4 v[212:215], v8, s[8:11], s20 offen sc1
    ds_read_b64 v[84:85], v17 offset:4608
    v_mfma_f32_16x16x32_bf16 a[104:107], v[168:171], v[152:155], a[104:107]
    ds_read_b64 v[86:87], v17 offset:4640
    buffer_load_dwordx4 v[216:219], v9, s[8:11], s20 offen sc1
    v_mfma_f32_16x16x32_bf16 a[108:111], v[172:175], v[152:155], a[108:111]
    ds_read_b64 v[88:89], v17 offset:6912
    ds_read_b64 v[90:91], v17 offset:6944
    v_mfma_f32_16x16x32_bf16 a[112:115], v[176:179], v[152:155], a[112:115]
    buffer_load_dwordx4 v[220:223], v10, s[12:15], s21 offen offset:0
    ds_read_b64 v[92:93], v17 offset:9216
    v_mfma_f32_16x16x32_bf16 a[116:119], v[180:183], v[152:155], a[116:119]
    ds_read_b64 v[94:95], v17 offset:9248
    buffer_load_dwordx4 v[224:227], v10, s[12:15], s21 offen offset:64
    v_mfma_f32_16x16x32_bf16 a[120:123], v[164:167], v[156:159], a[120:123]
    ds_read_b64 v[96:97], v17 offset:11520
    ds_read_b64 v[98:99], v17 offset:11552
    v_mfma_f32_16x16x32_bf16 a[124:127], v[168:171], v[156:159], a[124:127]
    buffer_load_dwordx4 v[228:231], v10, s[12:15], s21 offen offset:128
    ds_read_b64 v[100:101], v17 offset:13824
    v_mfma_f32_16x16x32_bf16 a[128:131], v[172:175], v[156:159], a[128:131]
    ds_read_b64 v[102:103], v17 offset:13856
    buffer_load_dwordx4 v[232:235], v10, s[12:15], s21 offen offset:192
    v_mfma_f32_16x16x32_bf16 a[132:135], v[176:179], v[156:159], a[132:135]
    ds_read_b64 v[104:105], v17 offset:16128
    ds_read_b64 v[106:107], v17 offset:16160
    v_mfma_f32_16x16x32_bf16 a[136:139], v[180:183], v[156:159], a[136:139]
    buffer_load_dwordx4 v[236:239], v10, s[12:15], s21 offen offset:256
    v_mfma_f32_16x16x32_bf16 a[140:143], v[164:167], v[160:163], a[140:143]
    v_mfma_f32_16x16x32_bf16 a[144:147], v[168:171], v[160:163], a[144:147]
    v_mfma_f32_16x16x32_bf16 a[148:151], v[172:175], v[160:163], a[148:151]
    v_mfma_f32_16x16x32_bf16 a[152:155], v[176:179], v[160:163], a[152:155]
    v_mfma_f32_16x16x32_bf16 a[156:159], v[180:183], v[160:163], a[156:159]
    s_add_u32 s20, s20, 128
    s_add_u32 s21, s21, 81920
    s_sub_u32 s22, s22, 1
    s_cmp_eq_u32 s22, 0
    s_waitcnt lgkmcnt(0)
    s_cbranch_scc1 mdown_done
    v_mfma_f32_16x16x32_bf16 a[0:3], v[108:111], v[76:79], a[0:3]
    v_mfma_f32_16x16x32_bf16 a[4:7], v[112:115], v[76:79], a[4:7]
    ds_read_b64_tr_b16 v[164:165], v19 offset:11264
    v_mfma_f32_16x16x32_bf16 a[8:11], v[116:119], v[76:79], a[8:11]
    ds_read_b64_tr_b16 v[166:167], v19 offset:16896
    v_mfma_f32_16x16x32_bf16 a[12:15], v[120:123], v[76:79], a[12:15]
    ds_read_b64_tr_b16 v[168:169], v19 offset:11296
    v_mfma_f32_16x16x32_bf16 a[16:19], v[124:127], v[76:79], a[16:19]
    ds_read_b64_tr_b16 v[170:171], v19 offset:16928
    v_mfma_f32_16x16x32_bf16 a[20:23], v[108:111], v[80:83], a[20:23]
    ds_read_b64_tr_b16 v[172:173], v19 offset:11328
    v_mfma_f32_16x16x32_bf16 a[24:27], v[112:115], v[80:83], a[24:27]
    ds_read_b64_tr_b16 v[174:175], v19 offset:16960
    v_mfma_f32_16x16x32_bf16 a[28:31], v[116:119], v[80:83], a[28:31]
    ds_read_b64_tr_b16 v[176:177], v19 offset:11360
    v_mfma_f32_16x16x32_bf16 a[32:35], v[120:123], v[80:83], a[32:35]
    ds_read_b64_tr_b16 v[178:179], v19 offset:16992
    v_mfma_f32_16x16x32_bf16 a[36:39], v[124:127], v[80:83], a[36:39]
    ds_read_b64_tr_b16 v[180:181], v19 offset:11392
    v_mfma_f32_16x16x32_bf16 a[40:43], v[108:111], v[84:87], a[40:43]
    ds_read_b64_tr_b16 v[182:183], v19 offset:17024
    v_mfma_f32_16x16x32_bf16 a[44:47], v[112:115], v[84:87], a[44:47]
    ds_read_b64 v[132:133], v17 offset:64
    v_mfma_f32_16x16x32_bf16 a[48:51], v[116:119], v[84:87], a[48:51]
    ds_read_b64 v[134:135], v17 offset:96
    v_mfma_f32_16x16x32_bf16 a[52:55], v[120:123], v[84:87], a[52:55]
    ds_read_b64 v[136:137], v17 offset:2368
    v_mfma_f32_16x16x32_bf16 a[56:59], v[124:127], v[84:87], a[56:59]
    ds_read_b64 v[138:139], v17 offset:2400
    v_mfma_f32_16x16x32_bf16 a[60:63], v[108:111], v[88:91], a[60:63]
    ds_read_b64 v[140:141], v17 offset:4672
    v_mfma_f32_16x16x32_bf16 a[64:67], v[112:115], v[88:91], a[64:67]
    ds_read_b64 v[142:143], v17 offset:4704
    v_mfma_f32_16x16x32_bf16 a[68:71], v[116:119], v[88:91], a[68:71]
    ds_read_b64 v[144:145], v17 offset:6976
    v_mfma_f32_16x16x32_bf16 a[72:75], v[120:123], v[88:91], a[72:75]
    ds_read_b64 v[146:147], v17 offset:7008
    v_mfma_f32_16x16x32_bf16 a[76:79], v[124:127], v[88:91], a[76:79]
    ds_read_b64 v[148:149], v17 offset:9280
    v_mfma_f32_16x16x32_bf16 a[80:83], v[108:111], v[92:95], a[80:83]
    ds_read_b64 v[150:151], v17 offset:9312
    v_mfma_f32_16x16x32_bf16 a[84:87], v[112:115], v[92:95], a[84:87]
    ds_read_b64 v[152:153], v17 offset:11584
    v_mfma_f32_16x16x32_bf16 a[88:91], v[116:119], v[92:95], a[88:91]
    ds_read_b64 v[154:155], v17 offset:11616
    v_mfma_f32_16x16x32_bf16 a[92:95], v[120:123], v[92:95], a[92:95]
    ds_read_b64 v[156:157], v17 offset:13888
    v_mfma_f32_16x16x32_bf16 a[96:99], v[124:127], v[92:95], a[96:99]
    ds_read_b64 v[158:159], v17 offset:13920
    v_mfma_f32_16x16x32_bf16 a[100:103], v[108:111], v[96:99], a[100:103]
    ds_read_b64 v[160:161], v17 offset:16192
    v_mfma_f32_16x16x32_bf16 a[104:107], v[112:115], v[96:99], a[104:107]
    ds_read_b64 v[162:163], v17 offset:16224
    v_mfma_f32_16x16x32_bf16 a[108:111], v[116:119], v[96:99], a[108:111]
    v_mfma_f32_16x16x32_bf16 a[112:115], v[120:123], v[96:99], a[112:115]
    v_mfma_f32_16x16x32_bf16 a[116:119], v[124:127], v[96:99], a[116:119]
    v_mfma_f32_16x16x32_bf16 a[120:123], v[108:111], v[100:103], a[120:123]
    v_mfma_f32_16x16x32_bf16 a[124:127], v[112:115], v[100:103], a[124:127]
    v_mfma_f32_16x16x32_bf16 a[128:131], v[116:119], v[100:103], a[128:131]
    v_mfma_f32_16x16x32_bf16 a[132:135], v[120:123], v[100:103], a[132:135]
    v_mfma_f32_16x16x32_bf16 a[136:139], v[124:127], v[100:103], a[136:139]
    v_mfma_f32_16x16x32_bf16 a[140:143], v[108:111], v[104:107], a[140:143]
    v_mfma_f32_16x16x32_bf16 a[144:147], v[112:115], v[104:107], a[144:147]
    v_mfma_f32_16x16x32_bf16 a[148:151], v[116:119], v[104:107], a[148:151]
    v_mfma_f32_16x16x32_bf16 a[152:155], v[120:123], v[104:107], a[152:155]
    v_mfma_f32_16x16x32_bf16 a[156:159], v[124:127], v[104:107], a[156:159]
    s_waitcnt lgkmcnt(0)
    s_waitcnt vmcnt(13)
    v_mfma_f32_16x16x32_bf16 a[0:3], v[164:167], v[132:135], a[0:3]
    ds_write_b128 v12, v[20:23] offset:0
    v_mfma_f32_16x16x32_bf16 a[4:7], v[168:171], v[132:135], a[4:7]
    ds_write_b128 v12, v[24:27] offset:4608
    v_mfma_f32_16x16x32_bf16 a[8:11], v[172:175], v[132:135], a[8:11]
    ds_write_b128 v12, v[28:31] offset:9216
    v_mfma_f32_16x16x32_bf16 a[12:15], v[176:179], v[132:135], a[12:15]
    ds_write_b128 v12, v[32:35] offset:13824
    v_mfma_f32_16x16x32_bf16 a[16:19], v[180:183], v[132:135], a[16:19]
    ds_write_b128 v12, v[36:39] offset:18432
    v_mfma_f32_16x16x32_bf16 a[20:23], v[164:167], v[136:139], a[20:23]
    ds_write_b128 v12, v[40:43] offset:23040
    v_mfma_f32_16x16x32_bf16 a[24:27], v[168:171], v[136:139], a[24:27]
    ds_write_b128 v12, v[44:47] offset:27648
    v_mfma_f32_16x16x32_bf16 a[28:31], v[172:175], v[136:139], a[28:31]
    ds_write_b128 v12, v[48:51] offset:32256
    v_mfma_f32_16x16x32_bf16 a[32:35], v[176:179], v[136:139], a[32:35]
    ds_write_b128 v14, v[52:55] offset:0
    v_mfma_f32_16x16x32_bf16 a[36:39], v[180:183], v[136:139], a[36:39]
    ds_write_b128 v14, v[56:59] offset:64
    v_mfma_f32_16x16x32_bf16 a[40:43], v[164:167], v[140:143], a[40:43]
    ds_write_b128 v14, v[60:63] offset:128
    v_mfma_f32_16x16x32_bf16 a[44:47], v[168:171], v[140:143], a[44:47]
    ds_write_b128 v14, v[64:67] offset:192
    v_mfma_f32_16x16x32_bf16 a[48:51], v[172:175], v[140:143], a[48:51]
    ds_write_b128 v14, v[68:71] offset:256
    v_mfma_f32_16x16x32_bf16 a[52:55], v[176:179], v[140:143], a[52:55]
    v_mfma_f32_16x16x32_bf16 a[56:59], v[180:183], v[140:143], a[56:59]
    s_waitcnt lgkmcnt(0)
    s_barrier
    v_mfma_f32_16x16x32_bf16 a[60:63], v[164:167], v[144:147], a[60:63]
    ds_read_b64_tr_b16 v[108:109], v18 offset:0
    ds_read_b64_tr_b16 v[110:111], v18 offset:5632
    v_mfma_f32_16x16x32_bf16 a[64:67], v[168:171], v[144:147], a[64:67]
    buffer_load_dwordx4 v[20:23], v2, s[8:11], s20 offen sc1
    ds_read_b64_tr_b16 v[112:113], v18 offset:32
    v_mfma_f32_16x16x32_bf16 a[68:71], v[172:175], v[144:147], a[68:71]
    ds_read_b64_tr_b16 v[114:115], v18 offset:5664
    buffer_load_dwordx4 v[24:27], v3, s[8:11], s20 offen sc1
    v_mfma_f32_16x16x32_bf16 a[72:75], v[176:179], v[144:147], a[72:75]
    ds_read_b64_tr_b16 v[116:117], v18 offset:64
    ds_read_b64_tr_b16 v[118:119], v18 offset:5696
    v_mfma_f32_16x16x32_bf16 a[76:79], v[180:183], v[144:147], a[76:79]
    buffer_load_dwordx4 v[28:31], v4, s[8:11], s20 offen sc1
    ds_read_b64_tr_b16 v[120:121], v18 offset:96
    v_mfma_f32_16x16x32_bf16 a[80:83], v[164:167], v[148:151], a[80:83]
    ds_read_b64_tr_b16 v[122:123], v18 offset:5728
    buffer_load_dwordx4 v[32:35], v5, s[8:11], s20 offen sc1
    v_mfma_f32_16x16x32_bf16 a[84:87], v[168:171], v[148:151], a[84:87]
    ds_read_b64_tr_b16 v[124:125], v18 offset:128
    ds_read_b64_tr_b16 v[126:127], v18 offset:5760
    v_mfma_f32_16x16x32_bf16 a[88:91], v[172:175], v[148:151], a[88:91]
    buffer_load_dwordx4 v[36:39], v6, s[8:11], s20 offen sc1
    ds_read_b64 v[76:77], v16 offset:0
    v_mfma_f32_16x16x32_bf16 a[92:95], v[176:179], v[148:151], a[92:95]
    ds_read_b64 v[78:79], v16 offset:32
    buffer_load_dwordx4 v[40:43], v7, s[8:11], s20 offen sc1
    v_mfma_f32_16x16x32_bf16 a[96:99], v[180:183], v[148:151], a[96:99]
    ds_read_b64 v[80:81], v16 offset:2304
    ds_read_b64 v[82:83], v16 offset:2336
    v_mfma_f32_16x16x32_bf16 a[100:103], v[164:167], v[152:155], a[100:103]
    buffer_load_dwordx4 v[44:47], v8, s[8:11], s20 offen sc1
    ds_read_b64 v[84:85], v16 offset:4608
    v_mfma_f32_16x16x32_bf16 a[104:107], v[168:171], v[152:155], a[104:107]
    ds_read_b64 v[86:87], v16 offset:4640
    buffer_load_dwordx4 v[48:51], v9, s[8:11], s20 offen sc1
    v_mfma_f32_16x16x32_bf16 a[108:111], v[172:175], v[152:155], a[108:111]
    ds_read_b64 v[88:89], v16 offset:6912
    ds_read_b64 v[90:91], v16 offset:6944
    v_mfma_f32_16x16x32_bf16 a[112:115], v[176:179], v[152:155], a[112:115]
    buffer_load_dwordx4 v[52:55], v10, s[12:15], s21 offen offset:0
    ds_read_b64 v[92:93], v16 offset:9216
    v_mfma_f32_16x16x32_bf16 a[116:119], v[180:183], v[152:155], a[116:119]
    ds_read_b64 v[94:95], v16 offset:9248
    buffer_load_dwordx4 v[56:59], v10, s[12:15], s21 offen offset:64
    v_mfma_f32_16x16x32_bf16 a[120:123], v[164:167], v[156:159], a[120:123]
    ds_read_b64 v[96:97], v16 offset:11520
    ds_read_b64 v[98:99], v16 offset:11552
    v_mfma_f32_16x16x32_bf16 a[124:127], v[168:171], v[156:159], a[124:127]
    buffer_load_dwordx4 v[60:63], v10, s[12:15], s21 offen offset:128
    ds_read_b64 v[100:101], v16 offset:13824
    v_mfma_f32_16x16x32_bf16 a[128:131], v[172:175], v[156:159], a[128:131]
    ds_read_b64 v[102:103], v16 offset:13856
    buffer_load_dwordx4 v[64:67], v10, s[12:15], s21 offen offset:192
    v_mfma_f32_16x16x32_bf16 a[132:135], v[176:179], v[156:159], a[132:135]
    ds_read_b64 v[104:105], v16 offset:16128
    ds_read_b64 v[106:107], v16 offset:16160
    v_mfma_f32_16x16x32_bf16 a[136:139], v[180:183], v[156:159], a[136:139]
    buffer_load_dwordx4 v[68:71], v10, s[12:15], s21 offen offset:256
    v_mfma_f32_16x16x32_bf16 a[140:143], v[164:167], v[160:163], a[140:143]
    v_mfma_f32_16x16x32_bf16 a[144:147], v[168:171], v[160:163], a[144:147]
    v_mfma_f32_16x16x32_bf16 a[148:151], v[172:175], v[160:163], a[148:151]
    v_mfma_f32_16x16x32_bf16 a[152:155], v[176:179], v[160:163], a[152:155]
    v_mfma_f32_16x16x32_bf16 a[156:159], v[180:183], v[160:163], a[156:159]
    s_add_u32 s20, s20, 128
    s_add_u32 s21, s21, 81920
    s_sub_u32 s22, s22, 1
    s_cmp_eq_u32 s22, 0
    s_waitcnt lgkmcnt(0)
    s_cbranch_scc0 mdown_loop
mdown_done:
    s_waitcnt vmcnt(0)
    s_nop 7
    s_cmp_lg_u32 s61, 0
    s_cbranch_scc1 if_skip_26
    s_mov_b64 exec, 1
    v_accvgpr_write_b32 a255, 1
    v_mov_b32 v3, 0
    s_nop 1
    buffer_atomic_add a255, v3, s[56:59], s75 offen sc0 sc1
    s_mov_b64 exec, -1
if_skip_26:
    v_and_b32 v60, 15, v0
    v_bfe_u32 v61, v0, 4, 2
    v_lshrrev_b32 v62, 7, v0
    v_bfe_u32 v63, v0, 6, 1
    v_lshl_add_u32 v64, v62, 7, v60
    s_mov_b32 s24, 1280
    v_mul_lo_u32 v64, v64, s24
    v_mul_u32_u24 v65, 160, v63
    v_lshl_add_u32 v66, v61, 3, v65
    v_add_u32 v66, v64, v66
    v_lshl_add_u32 v65, v61, 4, v65
    v_add_u32 v60, v64, v65
    v_accvgpr_read_b32 v148, a0
    v_accvgpr_read_b32 v149, a1
    v_accvgpr_read_b32 v150, a2
    v_accvgpr_read_b32 v151, a3
    v_cvt_pk_bf16_f32 v76, v148, v149
    v_cvt_pk_bf16_f32 v77, v150, v151
    v_accvgpr_read_b32 v152, a4
    v_accvgpr_read_b32 v153, a5
    v_accvgpr_read_b32 v154, a6
    v_accvgpr_read_b32 v155, a7
    v_cvt_pk_bf16_f32 v78, v152, v153
    v_cvt_pk_bf16_f32 v79, v154, v155
    s_nop 1
    v_permlane32_swap_b32 v76, v78
    v_permlane32_swap_b32 v77, v79
    s_nop 1
    v_permlane16_swap_b32 v76, v78
    v_permlane16_swap_b32 v77, v79
    buffer_store_dwordx4 v[76:79], v60, s[16:19], s23 offen offset:0 sc1
    v_accvgpr_read_b32 v148, a8
    v_accvgpr_read_b32 v149, a9
    v_accvgpr_read_b32 v150, a10
    v_accvgpr_read_b32 v151, a11
    v_cvt_pk_bf16_f32 v84, v148, v149
    v_cvt_pk_bf16_f32 v85, v150, v151
    v_accvgpr_read_b32 v152, a12
    v_accvgpr_read_b32 v153, a13
    v_accvgpr_read_b32 v154, a14
    v_accvgpr_read_b32 v155, a15
    v_cvt_pk_bf16_f32 v86, v152, v153
    v_cvt_pk_bf16_f32 v87, v154, v155
    s_nop 1
    v_permlane32_swap_b32 v84, v86
    v_permlane32_swap_b32 v85, v87
    s_nop 1
    v_permlane16_swap_b32 v84, v86
    v_permlane16_swap_b32 v85, v87
    buffer_store_dwordx4 v[84:87], v60, s[16:19], s23 offen offset:64 sc1
    v_accvgpr_read_b32 v148, a16
    v_accvgpr_read_b32 v149, a17
    v_accvgpr_read_b32 v150, a18
    v_accvgpr_read_b32 v151, a19
    v_cvt_pk_bf16_f32 v140, v148, v149
    v_cvt_pk_bf16_f32 v141, v150, v151
    buffer_store_dwordx2 v[140:141], v66, s[16:19], s23 offen offset:128 sc1
    v_add_u32 v66, 20480, v66
    v_add_u32 v60, 20480, v60
    v_accvgpr_read_b32 v148, a20
    v_accvgpr_read_b32 v149, a21
    v_accvgpr_read_b32 v150, a22
    v_accvgpr_read_b32 v151, a23
    v_cvt_pk_bf16_f32 v100, v148, v149
    v_cvt_pk_bf16_f32 v101, v150, v151
    v_accvgpr_read_b32 v152, a24
    v_accvgpr_read_b32 v153, a25
    v_accvgpr_read_b32 v154, a26
    v_accvgpr_read_b32 v155, a27
    v_cvt_pk_bf16_f32 v102, v152, v153
    v_cvt_pk_bf16_f32 v103, v154, v155
    s_nop 1
    v_permlane32_swap_b32 v100, v102
    v_permlane32_swap_b32 v101, v103
    s_nop 1
    v_permlane16_swap_b32 v100, v102
    v_permlane16_swap_b32 v101, v103
    buffer_store_dwordx4 v[100:103], v60, s[16:19], s23 offen offset:0 sc1
    v_accvgpr_read_b32 v148, a28
    v_accvgpr_read_b32 v149, a29
    v_accvgpr_read_b32 v150, a30
    v_accvgpr_read_b32 v151, a31
    v_cvt_pk_bf16_f32 v108, v148, v149
    v_cvt_pk_bf16_f32 v109, v150, v151
    v_accvgpr_read_b32 v152, a32
    v_accvgpr_read_b32 v153, a33
    v_accvgpr_read_b32 v154, a34
    v_accvgpr_read_b32 v155, a35
    v_cvt_pk_bf16_f32 v110, v152, v153
    v_cvt_pk_bf16_f32 v111, v154, v155
    s_nop 1
    v_permlane32_swap_b32 v108, v110
    v_permlane32_swap_b32 v109, v111
    s_nop 1
    v_permlane16_swap_b32 v108, v110
    v_permlane16_swap_b32 v109, v111
    buffer_store_dwordx4 v[108:111], v60, s[16:19], s23 offen offset:64 sc1
    v_accvgpr_read_b32 v148, a36
    v_accvgpr_read_b32 v149, a37
    v_accvgpr_read_b32 v150, a38
    v_accvgpr_read_b32 v151, a39
    v_cvt_pk_bf16_f32 v142, v148, v149
    v_cvt_pk_bf16_f32 v143, v150, v151
    buffer_store_dwordx2 v[142:143], v66, s[16:19], s23 offen offset:128 sc1
    v_add_u32 v66, 20480, v66
    v_add_u32 v60, 20480, v60
    v_accvgpr_read_b32 v148, a40
    v_accvgpr_read_b32 v149, a41
    v_accvgpr_read_b32 v150, a42
    v_accvgpr_read_b32 v151, a43
    v_cvt_pk_bf16_f32 v124, v148, v149
    v_cvt_pk_bf16_f32 v125, v150, v151
    v_accvgpr_read_b32 v152, a44
    v_accvgpr_read_b32 v153, a45
    v_accvgpr_read_b32 v154, a46
    v_accvgpr_read_b32 v155, a47
    v_cvt_pk_bf16_f32 v126, v152, v153
    v_cvt_pk_bf16_f32 v127, v154, v155
    s_nop 1
    v_permlane32_swap_b32 v124, v126
    v_permlane32_swap_b32 v125, v127
    s_nop 1
    v_permlane16_swap_b32 v124, v126
    v_permlane16_swap_b32 v125, v127
    buffer_store_dwordx4 v[124:127], v60, s[16:19], s23 offen offset:0 sc1
    v_accvgpr_read_b32 v148, a48
    v_accvgpr_read_b32 v149, a49
    v_accvgpr_read_b32 v150, a50
    v_accvgpr_read_b32 v151, a51
    v_cvt_pk_bf16_f32 v132, v148, v149
    v_cvt_pk_bf16_f32 v133, v150, v151
    v_accvgpr_read_b32 v152, a52
    v_accvgpr_read_b32 v153, a53
    v_accvgpr_read_b32 v154, a54
    v_accvgpr_read_b32 v155, a55
    v_cvt_pk_bf16_f32 v134, v152, v153
    v_cvt_pk_bf16_f32 v135, v154, v155
    s_nop 1
    v_permlane32_swap_b32 v132, v134
    v_permlane32_swap_b32 v133, v135
    s_nop 1
    v_permlane16_swap_b32 v132, v134
    v_permlane16_swap_b32 v133, v135
    buffer_store_dwordx4 v[132:135], v60, s[16:19], s23 offen offset:64 sc1
    v_accvgpr_read_b32 v148, a56
    v_accvgpr_read_b32 v149, a57
    v_accvgpr_read_b32 v150, a58
    v_accvgpr_read_b32 v151, a59
    v_cvt_pk_bf16_f32 v144, v148, v149
    v_cvt_pk_bf16_f32 v145, v150, v151
    buffer_store_dwordx2 v[144:145], v66, s[16:19], s23 offen offset:128 sc1
    v_add_u32 v66, 20480, v66
    v_add_u32 v60, 20480, v60
    v_accvgpr_read_b32 v148, a60
    v_accvgpr_read_b32 v149, a61
    v_accvgpr_read_b32 v150, a62
    v_accvgpr_read_b32 v151, a63
    v_cvt_pk_bf16_f32 v84, v148, v149
    v_cvt_pk_bf16_f32 v85, v150, v151
    v_accvgpr_read_b32 v152, a64
    v_accvgpr_read_b32 v153, a65
    v_accvgpr_read_b32 v154, a66
    v_accvgpr_read_b32 v155, a67
    v_cvt_pk_bf16_f32 v86, v152, v153
    v_cvt_pk_bf16_f32 v87, v154, v155
    s_nop 1
    v_permlane32_swap_b32 v84, v86
    v_permlane32_swap_b32 v85, v87
    s_nop 1
    v_permlane16_swap_b32 v84, v86
    v_permlane16_swap_b32 v85, v87
    buffer_store_dwordx4 v[84:87], v60, s[16:19], s23 offen offset:0 sc1
    v_accvgpr_read_b32 v148, a68
    v_accvgpr_read_b32 v149, a69
    v_accvgpr_read_b32 v150, a70
    v_accvgpr_read_b32 v151, a71
    v_cvt_pk_bf16_f32 v92, v148, v149
    v_cvt_pk_bf16_f32 v93, v150, v151
    v_accvgpr_read_b32 v152, a72
    v_accvgpr_read_b32 v153, a73
    v_accvgpr_read_b32 v154, a74
    v_accvgpr_read_b32 v155, a75
    v_cvt_pk_bf16_f32 v94, v152, v153
    v_cvt_pk_bf16_f32 v95, v154, v155
    s_nop 1
    v_permlane32_swap_b32 v92, v94
    v_permlane32_swap_b32 v93, v95
    s_nop 1
    v_permlane16_swap_b32 v92, v94
    v_permlane16_swap_b32 v93, v95
    buffer_store_dwordx4 v[92:95], v60, s[16:19], s23 offen offset:64 sc1
    v_accvgpr_read_b32 v148, a76
    v_accvgpr_read_b32 v149, a77
    v_accvgpr_read_b32 v150, a78
    v_accvgpr_read_b32 v151, a79
    v_cvt_pk_bf16_f32 v146, v148, v149
    v_cvt_pk_bf16_f32 v147, v150, v151
    buffer_store_dwordx2 v[146:147], v66, s[16:19], s23 offen offset:128 sc1
    v_add_u32 v66, 20480, v66
    v_add_u32 v60, 20480, v60
    v_accvgpr_read_b32 v148, a80
    v_accvgpr_read_b32 v149, a81
    v_accvgpr_read_b32 v150, a82
    v_accvgpr_read_b32 v151, a83
    v_cvt_pk_bf16_f32 v108, v148, v149
    v_cvt_pk_bf16_f32 v109, v150, v151
    v_accvgpr_read_b32 v152, a84
    v_accvgpr_read_b32 v153, a85
    v_accvgpr_read_b32 v154, a86
    v_accvgpr_read_b32 v155, a87
    v_cvt_pk_bf16_f32 v110, v152, v153
    v_cvt_pk_bf16_f32 v111, v154, v155
    s_nop 1
    v_permlane32_swap_b32 v108, v110
    v_permlane32_swap_b32 v109, v111
    s_nop 1
    v_permlane16_swap_b32 v108, v110
    v_permlane16_swap_b32 v109, v111
    buffer_store_dwordx4 v[108:111], v60, s[16:19], s23 offen offset:0 sc1
    v_accvgpr_read_b32 v148, a88
    v_accvgpr_read_b32 v149, a89
    v_accvgpr_read_b32 v150, a90
    v_accvgpr_read_b32 v151, a91
    v_cvt_pk_bf16_f32 v116, v148, v149
    v_cvt_pk_bf16_f32 v117, v150, v151
    v_accvgpr_read_b32 v152, a92
    v_accvgpr_read_b32 v153, a93
    v_accvgpr_read_b32 v154, a94
    v_accvgpr_read_b32 v155, a95
    v_cvt_pk_bf16_f32 v118, v152, v153
    v_cvt_pk_bf16_f32 v119, v154, v155
    s_nop 1
    v_permlane32_swap_b32 v116, v118
    v_permlane32_swap_b32 v117, v119
    s_nop 1
    v_permlane16_swap_b32 v116, v118
    v_permlane16_swap_b32 v117, v119
    buffer_store_dwordx4 v[116:119], v60, s[16:19], s23 offen offset:64 sc1
    v_accvgpr_read_b32 v148, a96
    v_accvgpr_read_b32 v149, a97
    v_accvgpr_read_b32 v150, a98
    v_accvgpr_read_b32 v151, a99
    v_cvt_pk_bf16_f32 v140, v148, v149
    v_cvt_pk_bf16_f32 v141, v150, v151
    buffer_store_dwordx2 v[140:141], v66, s[16:19], s23 offen offset:128 sc1
    v_add_u32 v66, 20480, v66
    v_add_u32 v60, 20480, v60
    v_accvgpr_read_b32 v148, a100
    v_accvgpr_read_b32 v149, a101
    v_accvgpr_read_b32 v150, a102
    v_accvgpr_read_b32 v151, a103
    v_cvt_pk_bf16_f32 v132, v148, v149
    v_cvt_pk_bf16_f32 v133, v150, v151
    v_accvgpr_read_b32 v152, a104
    v_accvgpr_read_b32 v153, a105
    v_accvgpr_read_b32 v154, a106
    v_accvgpr_read_b32 v155, a107
    v_cvt_pk_bf16_f32 v134, v152, v153
    v_cvt_pk_bf16_f32 v135, v154, v155
    s_nop 1
    v_permlane32_swap_b32 v132, v134
    v_permlane32_swap_b32 v133, v135
    s_nop 1
    v_permlane16_swap_b32 v132, v134
    v_permlane16_swap_b32 v133, v135
    buffer_store_dwordx4 v[132:135], v60, s[16:19], s23 offen offset:0 sc1
    v_accvgpr_read_b32 v148, a108
    v_accvgpr_read_b32 v149, a109
    v_accvgpr_read_b32 v150, a110
    v_accvgpr_read_b32 v151, a111
    v_cvt_pk_bf16_f32 v76, v148, v149
    v_cvt_pk_bf16_f32 v77, v150, v151
    v_accvgpr_read_b32 v152, a112
    v_accvgpr_read_b32 v153, a113
    v_accvgpr_read_b32 v154, a114
    v_accvgpr_read_b32 v155, a115
    v_cvt_pk_bf16_f32 v78, v152, v153
    v_cvt_pk_bf16_f32 v79, v154, v155
    s_nop 1
    v_permlane32_swap_b32 v76, v78
    v_permlane32_swap_b32 v77, v79
    s_nop 1
    v_permlane16_swap_b32 v76, v78
    v_permlane16_swap_b32 v77, v79
    buffer_store_dwordx4 v[76:79], v60, s[16:19], s23 offen offset:64 sc1
    v_accvgpr_read_b32 v148, a116
    v_accvgpr_read_b32 v149, a117
    v_accvgpr_read_b32 v150, a118
    v_accvgpr_read_b32 v151, a119
    v_cvt_pk_bf16_f32 v142, v148, v149
    v_cvt_pk_bf16_f32 v143, v150, v151
    buffer_store_dwordx2 v[142:143], v66, s[16:19], s23 offen offset:128 sc1
    v_add_u32 v66, 20480, v66
    v_add_u32 v60, 20480, v60
    v_accvgpr_read_b32 v148, a120
    v_accvgpr_read_b32 v149, a121
    v_accvgpr_read_b32 v150, a122
    v_accvgpr_read_b32 v151, a123
    v_cvt_pk_bf16_f32 v92, v148, v149
    v_cvt_pk_bf16_f32 v93, v150, v151
    v_accvgpr_read_b32 v152, a124
    v_accvgpr_read_b32 v153, a125
    v_accvgpr_read_b32 v154, a126
    v_accvgpr_read_b32 v155, a127
    v_cvt_pk_bf16_f32 v94, v152, v153
    v_cvt_pk_bf16_f32 v95, v154, v155
    s_nop 1
    v_permlane32_swap_b32 v92, v94
    v_permlane32_swap_b32 v93, v95
    s_nop 1
    v_permlane16_swap_b32 v92, v94
    v_permlane16_swap_b32 v93, v95
    buffer_store_dwordx4 v[92:95], v60, s[16:19], s23 offen offset:0 sc1
    v_accvgpr_read_b32 v148, a128
    v_accvgpr_read_b32 v149, a129
    v_accvgpr_read_b32 v150, a130
    v_accvgpr_read_b32 v151, a131
    v_cvt_pk_bf16_f32 v100, v148, v149
    v_cvt_pk_bf16_f32 v101, v150, v151
    v_accvgpr_read_b32 v152, a132
    v_accvgpr_read_b32 v153, a133
    v_accvgpr_read_b32 v154, a134
    v_accvgpr_read_b32 v155, a135
    v_cvt_pk_bf16_f32 v102, v152, v153
    v_cvt_pk_bf16_f32 v103, v154, v155
    s_nop 1
    v_permlane32_swap_b32 v100, v102
    v_permlane32_swap_b32 v101, v103
    s_nop 1
    v_permlane16_swap_b32 v100, v102
    v_permlane16_swap_b32 v101, v103
    buffer_store_dwordx4 v[100:103], v60, s[16:19], s23 offen offset:64 sc1
    v_accvgpr_read_b32 v148, a136
    v_accvgpr_read_b32 v149, a137
    v_accvgpr_read_b32 v150, a138
    v_accvgpr_read_b32 v151, a139
    v_cvt_pk_bf16_f32 v144, v148, v149
    v_cvt_pk_bf16_f32 v145, v150, v151
    buffer_store_dwordx2 v[144:145], v66, s[16:19], s23 offen offset:128 sc1
    v_add_u32 v66, 20480, v66
    v_add_u32 v60, 20480, v60
    v_accvgpr_read_b32 v148, a140
    v_accvgpr_read_b32 v149, a141
    v_accvgpr_read_b32 v150, a142
    v_accvgpr_read_b32 v151, a143
    v_cvt_pk_bf16_f32 v116, v148, v149
    v_cvt_pk_bf16_f32 v117, v150, v151
    v_accvgpr_read_b32 v152, a144
    v_accvgpr_read_b32 v153, a145
    v_accvgpr_read_b32 v154, a146
    v_accvgpr_read_b32 v155, a147
    v_cvt_pk_bf16_f32 v118, v152, v153
    v_cvt_pk_bf16_f32 v119, v154, v155
    s_nop 1
    v_permlane32_swap_b32 v116, v118
    v_permlane32_swap_b32 v117, v119
    s_nop 1
    v_permlane16_swap_b32 v116, v118
    v_permlane16_swap_b32 v117, v119
    buffer_store_dwordx4 v[116:119], v60, s[16:19], s23 offen offset:0 sc1
    v_accvgpr_read_b32 v148, a148
    v_accvgpr_read_b32 v149, a149
    v_accvgpr_read_b32 v150, a150
    v_accvgpr_read_b32 v151, a151
    v_cvt_pk_bf16_f32 v124, v148, v149
    v_cvt_pk_bf16_f32 v125, v150, v151
    v_accvgpr_read_b32 v152, a152
    v_accvgpr_read_b32 v153, a153
    v_accvgpr_read_b32 v154, a154
    v_accvgpr_read_b32 v155, a155
    v_cvt_pk_bf16_f32 v126, v152, v153
    v_cvt_pk_bf16_f32 v127, v154, v155
    s_nop 1
    v_permlane32_swap_b32 v124, v126
    v_permlane32_swap_b32 v125, v127
    s_nop 1
    v_permlane16_swap_b32 v124, v126
    v_permlane16_swap_b32 v125, v127
    buffer_store_dwordx4 v[124:127], v60, s[16:19], s23 offen offset:64 sc1
    v_accvgpr_read_b32 v148, a156
    v_accvgpr_read_b32 v149, a157
    v_accvgpr_read_b32 v150, a158
    v_accvgpr_read_b32 v151, a159
    v_cvt_pk_bf16_f32 v146, v148, v149
    v_cvt_pk_bf16_f32 v147, v150, v151
    buffer_store_dwordx2 v[146:147], v66, s[16:19], s23 offen offset:128 sc1
    s_waitcnt vmcnt(0)
    s_xor_b32 s66, s66, 16
    v_mov_b32 v3, 160000
    v_add_u32 v3, s66, v3
    s_cmp_lg_u32 s61, 0
    s_cbranch_scc1 fi1_27
    v_accvgpr_read_b32 v2, a255
    s_mov_b64 exec, 1
    ds_write_b32 v3, v2
    s_mov_b64 exec, -1
    s_waitcnt lgkmcnt(0)
fi1_27:
    s_barrier
    ds_read_b32 v4, v3
    s_cmp_lg_u32 s61, 0
    s_cbranch_scc1 fi2_28
    s_mov_b64 exec, 1
    v_mov_b32 v6, 1
    v_mov_b32 v7, 0
    buffer_atomic_add v6, v7, s[56:59], s74 offen sc1
    s_mov_b64 exec, -1
fi2_28:
    s_waitcnt lgkmcnt(0)
    v_readfirstlane_b32 s62, v4
    s_nop 3
    s_cmp_eq_u32 s63, 0
    s_cbranch_scc1 mega_decA
    s_branch mega_decB
blk_f1:
    s_lshr_b32 s70, s3, 3
    s_add_u32 s53, s70, 24
    s_lshl_b32 s53, s53, 7
    s_mov_b32 s40, 0
wf_29:
    v_mov_b32 v2, 0
    buffer_load_dword v2, v2, s[56:59], s53 offen sc1
    s_waitcnt vmcnt(0)
    v_readfirstlane_b32 s39, v2
    s_nop 3
    s_cmp_ge_u32 s39, 32
    s_cbranch_scc1 wf_ok_30
    s_sleep 32
    s_add_u32 s40, s40, 1
    s_cmp_lt_u32 s40, 2097152
    s_cbranch_scc1 wf_29
    s_branch chain_fail
wf_ok_30:
    s_add_u32 s53, s70, 8
    s_lshl_b32 s53, s53, 7
    s_mov_b32 s40, 0
wf_31:
    v_mov_b32 v2, 0
    buffer_load_dword v2, v2, s[56:59], s53 offen sc1
    s_waitcnt vmcnt(0)
    v_readfirstlane_b32 s39, v2
    s_nop 3
    s_cmp_ge_u32 s39, 32
    s_cbranch_scc1 wf_ok_32
    s_sleep 32
    s_add_u32 s40, s40, 1
    s_cmp_lt_u32 s40, 2097152
    s_cbranch_scc1 wf_31
    s_branch chain_fail
wf_ok_32:
    s_add_u32 s53, s3, 48
    s_lshl_b32 s53, s53, 7
    s_mov_b32 s40, 0
wf_33:
    v_mov_b32 v2, 0
    buffer_load_dword v2, v2, s[56:59], s53 offen sc1
    s_waitcnt vmcnt(0)
    v_readfirstlane_b32 s39, v2
    s_nop 3
    s_cmp_ge_u32 s39, 112
    s_cbranch_scc1 wf_ok_34
    s_sleep 32
    s_add_u32 s40, s40, 1
    s_cmp_lt_u32 s40, 2097152
    s_cbranch_scc1 wf_33
    s_branch chain_fail
wf_ok_34:
    s_add_u32 s74, s3, 384
    s_lshl_b32 s74, s74, 7
    s_load_dwordx2 s[4:5], s[0:1], 104
    v_and_b32 v1, 63, v0
    v_readfirstlane_b32 s38, v0
    s_waitcnt lgkmcnt(0)
    s_lshr_b32 s38, s38, 6
    s_add_u32 s8, s4, 52953088
    s_addc_u32 s9, s5, 0
    s_mov_b32 s10, 25165824
    s_mov_b32 s11, 0x00020000
    s_add_u32 s12, s4, 2621440
    s_addc_u32 s13, s5, 0
    s_mov_b32 s14, 25165824
    s_mov_b32 s15, 0x00020000
    s_add_u32 s16, s4, 196489216
    s_addc_u32 s17, s5, 0
    s_mov_b32 s18, 6291456
    s_mov_b32 s19, 0x00020000
    s_add_u32 s20, s4, 226373632
    s_addc_u32 s21, s5, 0
    s_mov_b32 s22, 5242880
    s_mov_b32 s23, 0x00020000
    v_and_b32 v2, 15, v1
    v_lshrrev_b32 v3, 4, v1
    v_and_b32 v4, 7, v1
    v_mul_u32_u24 v5, 12288, v2
    v_lshl_add_u32 v5, v3, 4, v5
    v_add_u32 v6, 196608, v5
    v_mul_u32_u24 v7, 12288, v4
    v_lshl_add_u32 v7, v3, 4, v7
    s_lshl_b32 s50, s2, 2
    s_add_u32 s50, s50, s38
    s_mul_i32 s48, s3, 393216
    s_mul_i32 s49, s3, 98304
    s_mul_i32 s51, s50, 384
    s_add_u32 s48, s48, s51
    s_add_u32 s49, s49, s51
    s_mul_i32 s52, s3, 81920
    s_mul_i32 s51, s50, 2560
    s_add_u32 s52, s52, s51
    v_lshlrev_b32 v8, 2, v3
    v_sub_u32 v8, v2, v8
    v_mul_u32_u24 v10, 80, v2
    v_lshl_add_u32 v9, v3, 4, v10
    v_add_u32 v9, 16, v9
    v_lshl_add_u32 v10, v3, 3, v10
    v_cmp_gt_u32 vcc, 32, v1
    v_mov_b32 v11, 0x7fffffff
    s_nop 1
    v_cndmask_b32 v10, v11, v10, vcc
    buffer_load_dwordx4 v[64:67], v5, s[8:11], s48 offen offset:0 sc1
    buffer_load_dwordx4 v[68:71], v5, s[8:11], s48 offen offset:64 sc1
    buffer_load_dwordx4 v[72:75], v5, s[8:11], s48 offen offset:128 sc1
    buffer_load_dwordx4 v[76:79], v5, s[8:11], s48 offen offset:192 sc1
    buffer_load_dwordx4 v[80:83], v5, s[8:11], s48 offen offset:256 sc1
    buffer_load_dwordx4 v[84:87], v5, s[8:11], s48 offen offset:320 sc1
    buffer_load_dwordx4 v[88:91], v6, s[8:11], s48 offen offset:0 sc1
    buffer_load_dwordx4 v[92:95], v6, s[8:11], s48 offen offset:64 sc1
    buffer_load_dwordx4 v[96:99], v6, s[8:11], s48 offen offset:128 sc1
    buffer_load_dwordx4 v[100:103], v6, s[8:11], s48 offen offset:192 sc1
    buffer_load_dwordx4 v[104:107], v6, s[8:11], s48 offen offset:256 sc1
    buffer_load_dwordx4 v[108:111], v6, s[8:11], s48 offen offset:320 sc1
    buffer_load_dwordx4 v[112:115], v5, s[12:15], s48 offen offset:0 sc1
    buffer_load_dwordx4 v[116:119], v5, s[12:15], s48 offen offset:64 sc1
    buffer_load_dwordx4 v[120:123], v5, s[12:15], s48 offen offset:128 sc1
    buffer_load_dwordx4 v[124:127], v5, s[12:15], s48 offen offset:192 sc1
    buffer_load_dwordx4 v[128:131], v5, s[12:15], s48 offen offset:256 sc1
    buffer_load_dwordx4 v[132:135], v5, s[12:15], s48 offen offset:320 sc1
    buffer_load_dwordx4 v[136:139], v6, s[12:15], s48 offen offset:0 sc1
    buffer_load_dwordx4 v[140:143], v6, s[12:15], s48 offen offset:64 sc1
    buffer_load_dwordx4 v[144:147], v6, s[12:15], s48 offen offset:128 sc1
    buffer_load_dwordx4 v[148:151], v6, s[12:15], s48 offen offset:192 sc1
    buffer_load_dwordx4 v[152:155], v6, s[12:15], s48 offen offset:256 sc1
    buffer_load_dwordx4 v[156:159], v6, s[12:15], s48 offen offset:320 sc1
    buffer_load_dwordx4 v[160:163], v7, s[16:19], s49 offen offset:0 sc1
    buffer_load_dwordx4 v[164:167], v7, s[16:19], s49 offen offset:64 sc1
    buffer_load_dwordx4 v[168:171], v7, s[16:19], s49 offen offset:128 sc1
    buffer_load_dwordx4 v[172:175], v7, s[16:19], s49 offen offset:192 sc1
    buffer_load_dwordx4 v[176:179], v7, s[16:19], s49 offen offset:256 sc1
    buffer_load_dwordx4 v[180:183], v7, s[16:19], s49 offen offset:320 sc1
    s_add_u32 s48, s48, 384
    s_add_u32 s49, s49, 384
    s_waitcnt vmcnt(0)
    v_mfma_f32_16x16x32_bf16 v[16:19], v[160:163], v[64:67], 0
    v_mfma_f32_16x16x32_bf16 v[20:23], v[112:115], v[64:67], 0
    v_mfma_f32_16x16x32_bf16 v[28:31], v[160:163], v[88:91], 0
    v_mfma_f32_16x16x32_bf16 v[32:35], v[112:115], v[88:91], 0
    v_mfma_f32_16x16x32_bf16 v[36:39], v[136:139], v[88:91], 0
    v_mfma_f32_16x16x32_bf16 v[16:19], v[164:167], v[68:71], v[16:19]
    v_mfma_f32_16x16x32_bf16 v[20:23], v[116:119], v[68:71], v[20:23]
    v_mfma_f32_16x16x32_bf16 v[28:31], v[164:167], v[92:95], v[28:31]
    v_mfma_f32_16x16x32_bf16 v[32:35], v[116:119], v[92:95], v[32:35]
    v_mfma_f32_16x16x32_bf16 v[36:39], v[140:143], v[92:95], v[36:39]
    v_mfma_f32_16x16x32_bf16 v[16:19], v[168:171], v[72:75], v[16:19]
    v_mfma_f32_16x16x32_bf16 v[20:23], v[120:123], v[72:75], v[20:23]
    v_mfma_f32_16x16x32_bf16 v[28:31], v[168:171], v[96:99], v[28:31]
    v_mfma_f32_16x16x32_bf16 v[32:35], v[120:123], v[96:99], v[32:35]
    v_mfma_f32_16x16x32_bf16 v[36:39], v[144:147], v[96:99], v[36:39]
    v_mfma_f32_16x16x32_bf16 v[16:19], v[172:175], v[76:79], v[16:19]
    v_mfma_f32_16x16x32_bf16 v[20:23], v[124:127], v[76:79], v[20:23]
    v_mfma_f32_16x16x32_bf16 v[28:31], v[172:175], v[100:103], v[28:31]
    v_mfma_f32_16x16x32_bf16 v[32:35], v[124:127], v[100:103], v[32:35]
    v_mfma_f32_16x16x32_bf16 v[36:39], v[148:151], v[100:103], v[36:39]
    v_mfma_f32_16x16x32_bf16 v[16:19], v[176:179], v[80:83], v[16:19]
    v_mfma_f32_16x16x32_bf16 v[20:23], v[128:131], v[80:83], v[20:23]
    v_mfma_f32_16x16x32_bf16 v[28:31], v[176:179], v[104:107], v[28:31]
    v_mfma_f32_16x16x32_bf16 v[32:35], v[128:131], v[104:107], v[32:35]
    v_mfma_f32_16x16x32_bf16 v[36:39], v[152:155], v[104:107], v[36:39]
    v_mfma_f32_16x16x32_bf16 v[16:19], v[180:183], v[84:87], v[16:19]
    v_mfma_f32_16x16x32_bf16 v[20:23], v[132:135], v[84:87], v[20:23]
    v_mfma_f32_16x16x32_bf16 v[28:31], v[180:183], v[108:111], v[28:31]
    v_mfma_f32_16x16x32_bf16 v[32:35], v[132:135], v[108:111], v[32:35]
    v_mfma_f32_16x16x32_bf16 v[36:39], v[156:159], v[108:111], v[36:39]
    s_nop 7
    s_mov_b32 s42, 0x3d93cd3a
    v_cvt_pk_bf16_f32 v40, v16, v17
    v_lshlrev_b32 v16, 16, v40
    v_and_b32 v17, 0xffff0000, v40
    v_mul_f32 v16, s42, v16
    v_mul_f32 v17, s42, v17
    v_cvt_pk_bf16_f32 v40, v16, v17
    v_lshlrev_b32 v16, 16, v40
    v_and_b32 v17, 0xffff0000, v40
    v_cvt_pk_bf16_f32 v40, v18, v19
    v_lshlrev_b32 v18, 16, v40
    v_and_b32 v19, 0xffff0000, v40
    v_mul_f32 v18, s42, v18
    v_mul_f32 v19, s42, v19
    v_cvt_pk_bf16_f32 v40, v18, v19
    v_lshlrev_b32 v18, 16, v40
    v_and_b32 v19, 0xffff0000, v40
    v_cvt_pk_bf16_f32 v40, v20, v21
    v_lshlrev_b32 v20, 16, v40
    v_and_b32 v21, 0xffff0000, v40
    v_mul_f32 v20, s42, v20
    v_mul_f32 v21, s42, v21
    v_cvt_pk_bf16_f32 v40, v20, v21
    v_lshlrev_b32 v20, 16, v40
    v_and_b32 v21, 0xffff0000, v40
    v_cvt_pk_bf16_f32 v40, v22, v23
    v_lshlrev_b32 v22, 16, v40
    v_and_b32 v23, 0xffff0000, v40
    v_mul_f32 v22, s42, v22
    v_mul_f32 v23, s42, v23
    v_cvt_pk_bf16_f32 v40, v22, v23
    v_lshlrev_b32 v22, 16, v40
    v_and_b32 v23, 0xffff0000, v40
    v_cmp_gt_u32 vcc, 32, v1
    v_mov_b32 v40, 0xff800000
    s_nop 1
    v_cndmask_b32 v16, v40, v16, vcc
    v_cndmask_b32 v17, v40, v17, vcc
    v_cndmask_b32 v18, v40, v18, vcc
    v_cndmask_b32 v19, v40, v19, vcc
    v_mov_b32 v40, 0xce6e0000
    v_cmp_gt_i32 vcc, 0, v8
    s_nop 1
    v_cndmask_b32 v20, v20, v40, vcc
    v_cmp_gt_i32 vcc, 1, v8
    s_nop 1
    v_cndmask_b32 v21, v21, v40, vcc
    v_cmp_gt_i32 vcc, 2, v8
    s_nop 1
    v_cndmask_b32 v22, v22, v40, vcc
    v_cmp_gt_i32 vcc, 3, v8
    s_nop 1
    v_cndmask_b32 v23, v23, v40, vcc
    v_mov_b32 v24, v40
    v_mov_b32 v25, v40
    v_mov_b32 v26, v40
    v_mov_b32 v27, v40
    v_max3_f32 v41, v16, v17, v18
    v_max3_f32 v41, v41, v19, v20
    v_max3_f32 v41, v41, v21, v22
    v_max3_f32 v41, v41, v23, v24
    v_max3_f32 v41, v41, v25, v26
    v_max_f32 v41, v41, v27
    v_mov_b32 v42, v41
    s_nop 1
    v_permlane32_swap_b32 v41, v42
    s_nop 1
    v_max_f32 v41, v41, v42
    v_mov_b32 v42, v41
    s_nop 1
    v_permlane16_swap_b32 v41, v42
    s_nop 1
    v_max_f32 v41, v41, v42
    s_mov_b32 s42, 0x3fb8aa3b
    v_sub_f32 v16, v16, v41
    v_mul_f32 v16, s42, v16
    v_exp_f32 v16, v16
    v_sub_f32 v17, v17, v41
    v_mul_f32 v17, s42, v17
    v_exp_f32 v17, v17
    v_sub_f32 v18, v18, v41
    v_mul_f32 v18, s42, v18
    v_exp_f32 v18, v18
    v_sub_f32 v19, v19, v41
    v_mul_f32 v19, s42, v19
    v_exp_f32 v19, v19
    v_sub_f32 v20, v20, v41
    v_mul_f32 v20, s42, v20
    v_exp_f32 v20, v20
    v_sub_f32 v21, v21, v41
    v_mul_f32 v21, s42, v21
    v_exp_f32 v21, v21
    v_sub_f32 v22, v22, v41
    v_mul_f32 v22, s42, v22
    v_exp_f32 v22, v22
    v_sub_f32 v23, v23, v41
    v_mul_f32 v23, s42, v23
    v_exp_f32 v23, v23
    v_sub_f32 v24, v24, v41
    v_mul_f32 v24, s42, v24
    v_exp_f32 v24, v24
    v_sub_f32 v25, v25, v41
    v_mul_f32 v25, s42, v25
    v_exp_f32 v25, v25
    v_sub_f32 v26, v26, v41
    v_mul_f32 v26, s42, v26
    v_exp_f32 v26, v26
    v_sub_f32 v27, v27, v41
    v_mul_f32 v27, s42, v27
    v_exp_f32 v27, v27
    s_nop 0
    v_add_f32 v43, v16, v17
    v_add_f32 v43, v43, v18
    v_add_f32 v43, v43, v19
    v_add_f32 v43, v43, v20
    v_add_f32 v43, v43, v21
    v_add_f32 v43, v43, v22
    v_add_f32 v43, v43, v23
    v_add_f32 v43, v43, v24
    v_add_f32 v43, v43, v25
    v_add_f32 v43, v43, v26
    v_add_f32 v43, v43, v27
    v_mov_b32 v42, v43
    s_nop 1
    v_permlane32_swap_b32 v43, v42
    s_nop 1
    v_add_f32 v43, v43, v42
    v_mov_b32 v42, v43
    s_nop 1
    v_permlane16_swap_b32 v43, v42
    s_nop 1
    v_add_f32 v43, v43, v42
    v_rcp_f32 v43, v43
    s_nop 0
    v_mul_f32 v16, v16, v43
    v_mul_f32 v17, v17, v43
    v_mul_f32 v18, v18, v43
    v_mul_f32 v19, v19, v43
    v_mul_f32 v20, v20, v43
    v_mul_f32 v21, v21, v43
    v_mul_f32 v22, v22, v43
    v_mul_f32 v23, v23, v43
    v_mul_f32 v24, v24, v43
    v_mul_f32 v25, v25, v43
    v_mul_f32 v26, v26, v43
    v_mul_f32 v27, v27, v43
    v_cvt_pk_bf16_f32 v44, v16, v17
    v_cvt_pk_bf16_f32 v45, v18, v19
    v_cvt_pk_bf16_f32 v46, v20, v21
    v_cvt_pk_bf16_f32 v47, v22, v23
    v_cvt_pk_bf16_f32 v48, v24, v25
    v_cvt_pk_bf16_f32 v49, v26, v27
    s_nop 1
    v_permlane32_swap_b32 v46, v48
    v_permlane32_swap_b32 v47, v49
    s_nop 1
    v_permlane16_swap_b32 v46, v48
    v_permlane16_swap_b32 v47, v49
    buffer_store_dwordx4 v[46:49], v9, s[20:23], s52 offen offset:0 sc1
    buffer_store_dwordx2 v[44:45], v10, s[20:23], s52 offen offset:0 sc1
    s_mov_b32 s42, 0x3d93cd3a
    v_cvt_pk_bf16_f32 v40, v28, v29
    v_lshlrev_b32 v28, 16, v40
    v_and_b32 v29, 0xffff0000, v40
    v_mul_f32 v28, s42, v28
    v_mul_f32 v29, s42, v29
    v_cvt_pk_bf16_f32 v40, v28, v29
    v_lshlrev_b32 v28, 16, v40
    v_and_b32 v29, 0xffff0000, v40
    v_cvt_pk_bf16_f32 v40, v30, v31
    v_lshlrev_b32 v30, 16, v40
    v_and_b32 v31, 0xffff0000, v40
    v_mul_f32 v30, s42, v30
    v_mul_f32 v31, s42, v31
    v_cvt_pk_bf16_f32 v40, v30, v31
    v_lshlrev_b32 v30, 16, v40
    v_and_b32 v31, 0xffff0000, v40
    v_cvt_pk_bf16_f32 v40, v32, v33
    v_lshlrev_b32 v32, 16, v40
    v_and_b32 v33, 0xffff0000, v40
    v_mul_f32 v32, s42, v32
    v_mul_f32 v33, s42, v33
    v_cvt_pk_bf16_f32 v40, v32, v33
    v_lshlrev_b32 v32, 16, v40
    v_and_b32 v33, 0xffff0000, v40
    v_cvt_pk_bf16_f32 v40, v34, v35
    v_lshlrev_b32 v34, 16, v40
    v_and_b32 v35, 0xffff0000, v40
    v_mul_f32 v34, s42, v34
    v_mul_f32 v35, s42, v35
    v_cvt_pk_bf16_f32 v40, v34, v35
    v_lshlrev_b32 v34, 16, v40
    v_and_b32 v35, 0xffff0000, v40
    v_cvt_pk_bf16_f32 v40, v36, v37
    v_lshlrev_b32 v36, 16, v40
    v_and_b32 v37, 0xffff0000, v40
    v_mul_f32 v36, s42, v36
    v_mul_f32 v37, s42, v37
    v_cvt_pk_bf16_f32 v40, v36, v37
    v_lshlrev_b32 v36, 16, v40
    v_and_b32 v37, 0xffff0000, v40
    v_cvt_pk_bf16_f32 v40, v38, v39
    v_lshlrev_b32 v38, 16, v40
    v_and_b32 v39, 0xffff0000, v40
    v_mul_f32 v38, s42, v38
    v_mul_f32 v39, s42, v39
    v_cvt_pk_bf16_f32 v40, v38, v39
    v_lshlrev_b32 v38, 16, v40
    v_and_b32 v39, 0xffff0000, v40
    v_cmp_gt_u32 vcc, 32, v1
    v_mov_b32 v40, 0xff800000
    s_nop 1
    v_cndmask_b32 v28, v40, v28, vcc
    v_cndmask_b32 v29, v40, v29, vcc
    v_cndmask_b32 v30, v40, v30, vcc
    v_cndmask_b32 v31, v40, v31, vcc
    v_mov_b32 v40, 0xce6e0000
    v_cmp_gt_i32 vcc, 0, v8
    s_nop 1
    v_cndmask_b32 v36, v36, v40, vcc
    v_cmp_gt_i32 vcc, 1, v8
    s_nop 1
    v_cndmask_b32 v37, v37, v40, vcc
    v_cmp_gt_i32 vcc, 2, v8
    s_nop 1
    v_cndmask_b32 v38, v38, v40, vcc
    v_cmp_gt_i32 vcc, 3, v8
    s_nop 1
    v_cndmask_b32 v39, v39, v40, vcc
    v_max3_f32 v41, v28, v29, v30
    v_max3_f32 v41, v41, v31, v32
    v_max3_f32 v41, v41, v33, v34
    v_max3_f32 v41, v41, v35, v36
    v_max3_f32 v41, v41, v37, v38
    v_max_f32 v41, v41, v39
    v_mov_b32 v42, v41
    s_nop 1
    v_permlane32_swap_b32 v41, v42
    s_nop 1
    v_max_f32 v41, v41, v42
    v_mov_b32 v42, v41
    s_nop 1
    v_permlane16_swap_b32 v41, v42
    s_nop 1
    v_max_f32 v41, v41, v42
    s_mov_b32 s42, 0x3fb8aa3b
    v_sub_f32 v28, v28, v41
    v_mul_f32 v28, s42, v28
    v_exp_f32 v28, v28
    v_sub_f32 v29, v29, v41
    v_mul_f32 v29, s42, v29
    v_exp_f32 v29, v29
    v_sub_f32 v30, v30, v41
    v_mul_f32 v30, s42, v30
    v_exp_f32 v30, v30
    v_sub_f32 v31, v31, v41
    v_mul_f32 v31, s42, v31
    v_exp_f32 v31, v31
    v_sub_f32 v32, v32, v41
    v_mul_f32 v32, s42, v32
    v_exp_f32 v32, v32
    v_sub_f32 v33, v33, v41
    v_mul_f32 v33, s42, v33
    v_exp_f32 v33, v33
    v_sub_f32 v34, v34, v41
    v_mul_f32 v34, s42, v34
    v_exp_f32 v34, v34
    v_sub_f32 v35, v35, v41
    v_mul_f32 v35, s42, v35
    v_exp_f32 v35, v35
    v_sub_f32 v36, v36, v41
    v_mul_f32 v36, s42, v36
    v_exp_f32 v36, v36
    v_sub_f32 v37, v37, v41
    v_mul_f32 v37, s42, v37
    v_exp_f32 v37, v37
    v_sub_f32 v38, v38, v41
    v_mul_f32 v38, s42, v38
    v_exp_f32 v38, v38
    v_sub_f32 v39, v39, v41
    v_mul_f32 v39, s42, v39
    v_exp_f32 v39, v39
    s_nop 0
    v_add_f32 v43, v28, v29
    v_add_f32 v43, v43, v30
    v_add_f32 v43, v43, v31
    v_add_f32 v43, v43, v32
    v_add_f32 v43, v43, v33
    v_add_f32 v43, v43, v34
    v_add_f32 v43, v43, v35
    v_add_f32 v43, v43, v36
    v_add_f32 v43, v43, v37
    v_add_f32 v43, v43, v38
    v_add_f32 v43, v43, v39
    v_mov_b32 v42, v43
    s_nop 1
    v_permlane32_swap_b32 v43, v42
    s_nop 1
    v_add_f32 v43, v43, v42
    v_mov_b32 v42, v43
    s_nop 1
    v_permlane16_swap_b32 v43, v42
    s_nop 1
    v_add_f32 v43, v43, v42
    v_rcp_f32 v43, v43
    s_nop 0
    v_mul_f32 v28, v28, v43
    v_mul_f32 v29, v29, v43
    v_mul_f32 v30, v30, v43
    v_mul_f32 v31, v31, v43
    v_mul_f32 v32, v32, v43
    v_mul_f32 v33, v33, v43
    v_mul_f32 v34, v34, v43
    v_mul_f32 v35, v35, v43
    v_mul_f32 v36, v36, v43
    v_mul_f32 v37, v37, v43
    v_mul_f32 v38, v38, v43
    v_mul_f32 v39, v39, v43
    v_cvt_pk_bf16_f32 v50, v28, v29
    v_cvt_pk_bf16_f32 v51, v30, v31
    v_cvt_pk_bf16_f32 v52, v32, v33
    v_cvt_pk_bf16_f32 v53, v34, v35
    v_cvt_pk_bf16_f32 v54, v36, v37
    v_cvt_pk_bf16_f32 v55, v38, v39
    s_nop 1
    v_permlane32_swap_b32 v52, v54
    v_permlane32_swap_b32 v53, v55
    s_nop 1
    v_permlane16_swap_b32 v52, v54
    v_permlane16_swap_b32 v53, v55
    buffer_store_dwordx4 v[52:55], v9, s[20:23], s52 offen offset:1280 sc1
    buffer_store_dwordx2 v[50:51], v10, s[20:23], s52 offen offset:1280 sc1
    s_cmp_lg_u32 s61, 0
    s_cbranch_scc1 if_skip_35
    s_mov_b64 exec, 1
    v_accvgpr_write_b32 a255, 1
    v_mov_b32 v3, 0
    s_nop 1
    buffer_atomic_add a255, v3, s[56:59], s75 offen sc0 sc1
    s_mov_b64 exec, -1
if_skip_35:
    s_waitcnt vmcnt(0)
    s_xor_b32 s66, s66, 16
    v_mov_b32 v3, 160000
    v_add_u32 v3, s66, v3
    s_cmp_lg_u32 s61, 0
    s_cbranch_scc1 fi1_36
    v_accvgpr_read_b32 v2, a255
    s_mov_b64 exec, 1
    ds_write_b32 v3, v2
    s_mov_b64 exec, -1
    s_waitcnt lgkmcnt(0)
fi1_36:
    s_barrier
    ds_read_b32 v4, v3
    s_cmp_lg_u32 s61, 0
    s_cbranch_scc1 fi2_37
    s_mov_b64 exec, 1
    v_mov_b32 v6, 1
    v_mov_b32 v7, 0
    buffer_atomic_add v6, v7, s[56:59], s74 offen sc1
    s_mov_b64 exec, -1
fi2_37:
    s_waitcnt lgkmcnt(0)
    v_readfirstlane_b32 s62, v4
    s_nop 3
    s_cmp_eq_u32 s63, 0
    s_cbranch_scc1 mega_decA
    s_branch mega_decB
blk_f2:
    s_lshr_b32 s70, s3, 3
    s_add_u32 s53, s70, 16
    s_lshl_b32 s53, s53, 7
    s_mov_b32 s40, 0
wf_38:
    v_mov_b32 v2, 0
    buffer_load_dword v2, v2, s[56:59], s53 offen sc1
    s_waitcnt vmcnt(0)
    v_readfirstlane_b32 s39, v2
    s_nop 3
    s_cmp_ge_u32 s39, 160
    s_cbranch_scc1 wf_ok_39
    s_sleep 32
    s_add_u32 s40, s40, 1
    s_cmp_lt_u32 s40, 2097152
    s_cbranch_scc1 wf_38
    s_branch chain_fail
wf_ok_39:
    s_add_u32 s53, s70, 40
    s_lshl_b32 s53, s53, 7
    s_mov_b32 s40, 0
wf_40:
    v_mov_b32 v2, 0
    buffer_load_dword v2, v2, s[56:59], s53 offen sc1
    s_waitcnt vmcnt(0)
    v_readfirstlane_b32 s39, v2
    s_nop 3
    s_cmp_ge_u32 s39, 4
    s_cbranch_scc1 wf_ok_41
    s_sleep 32
    s_add_u32 s40, s40, 1
    s_cmp_lt_u32 s40, 2097152
    s_cbranch_scc1 wf_40
    s_branch chain_fail
wf_ok_41:
    s_add_u32 s53, s3, 384
    s_lshl_b32 s53, s53, 7
    s_mov_b32 s40, 0
wf_42:
    v_mov_b32 v2, 0
    buffer_load_dword v2, v2, s[56:59], s53 offen sc1
    s_waitcnt vmcnt(0)
    v_readfirstlane_b32 s39, v2
    s_nop 3
    s_cmp_ge_u32 s39, 8
    s_cbranch_scc1 wf_ok_43
    s_sleep 8
    s_add_u32 s40, s40, 1
    s_cmp_lt_u32 s40, 2097152
    s_cbranch_scc1 wf_42
    s_branch chain_fail
wf_ok_43:
    s_load_dwordx2 s[4:5], s[0:1], 104
    s_load_dwordx2 s[6:7], s[0:1], 0
    s_load_dwordx2 s[36:37], s[0:1], 88
    v_and_b32 v1, 63, v0
    v_readfirstlane_b32 s38, v0
    s_waitcnt lgkmcnt(0)
    s_lshr_b32 s38, s38, 6
    s_add_u32 s8, s4, 226373632
    s_addc_u32 s9, s5, 0
    s_mov_b32 s10, 5242880
    s_mov_b32 s11, 0x00020000
    s_add_u32 s20, s4, 104333312
    s_addc_u32 s21, s5, 0
    s_mov_b32 s22, 83886080
    s_mov_b32 s23, 0x00020000
    s_add_u32 s24, s4, 202780672
    s_addc_u32 s25, s5, 0
    s_mov_b32 s26, 20971520
    s_mov_b32 s27, 0x00020000
    s_mov_b32 s28, s6
    s_mov_b32 s29, s7
    s_mov_b32 s30, 2621440
    s_mov_b32 s31, 0x00020000
    s_add_u32 s40, s4, 223752192
    s_addc_u32 s41, s5, 0
    s_mov_b32 s42, 2621440
    s_mov_b32 s43, 0x00020000
    s_mov_b32 s44, s36
    s_mov_b32 s45, s37
    s_mov_b32 s46, 2621440
    s_mov_b32 s47, 0x00020000
    v_and_b32 v2, 15, v1
    v_lshrrev_b32 v3, 4, v1
    s_and_b32 s50, s38, 1
    s_lshr_b32 s51, s38, 1
    s_lshl_b32 s52, s2, 6
    s_lshl_b32 s53, s51, 5
    s_add_u32 s52, s52, s53
    v_add_u32 v5, s52, v2
    v_lshlrev_b32 v6, 6, v5
    v_lshl_add_u32 v6, v3, 4, v6
    v_add_u32 v13, 4096, v6
    s_mul_i32 s48, s3, 1310720
    v_mul_u32_u24 v7, 640, v3
    v_add_u32 v7, v7, v5
    v_lshlrev_b32 v7, 4, v7
    s_mul_i32 s49, s3, 327680
    s_lshl_b32 s53, s50, 4
    v_add_u32 v9, s53, v2
    v_mul_u32_u24 v9, 80, v9
    v_mul_u32_u24 v10, 2560, v3
    v_add_u32 v10, v10, v9
    v_lshl_add_u32 v9, v3, 4, v9
    v_add_u32 v9, 16, v9
    s_mul_i32 s54, s3, 81920
    s_mov_b32 s55, s54
    s_lshl_b32 s53, s3, 5
    s_lshl_b32 s39, s50, 4
    s_add_u32 s53, s53, s39
    v_add_u32 v5, s53, v2
    v_mul_u32_u24 v5, 1280, v5
    v_lshl_add_u32 v5, v3, 3, v5
    s_lshl_b32 s52, s52, 1
    v_add_u32 v5, s52, v5
    buffer_load_dwordx2 v[40:41], v5, s[28:31], 0 offen offset:0
    buffer_load_dwordx2 v[42:43], v5, s[40:43], 0 offen offset:0 sc1
    buffer_load_dwordx2 v[44:45], v5, s[28:31], 0 offen offset:32
    buffer_load_dwordx2 v[46:47], v5, s[40:43], 0 offen offset:32 sc1
    buffer_load_dwordx4 v[64:67], v6, s[20:23], s48 offen offset:0 sc1
    buffer_load_dwordx4 v[68:71], v6, s[20:23], s48 offen offset:1024 sc1
    buffer_load_dwordx4 v[72:75], v9, s[8:11], s54 offen sc1
    s_add_u32 s48, s48, 40960
    s_add_u32 s54, s54, 2560
    buffer_load_dwordx4 v[76:79], v6, s[20:23], s48 offen offset:0 sc1
    buffer_load_dwordx4 v[80:83], v6, s[20:23], s48 offen offset:1024 sc1
    buffer_load_dwordx4 v[84:87], v9, s[8:11], s54 offen sc1
    s_add_u32 s48, s48, 40960
    s_add_u32 s54, s54, 2560
    buffer_load_dwordx4 v[88:91], v6, s[20:23], s48 offen offset:0 sc1
    buffer_load_dwordx4 v[92:95], v6, s[20:23], s48 offen offset:1024 sc1
    buffer_load_dwordx4 v[96:99], v9, s[8:11], s54 offen sc1
    s_add_u32 s48, s48, 40960
    s_add_u32 s54, s54, 2560
    buffer_load_dwordx4 v[100:103], v6, s[20:23], s48 offen offset:0 sc1
    buffer_load_dwordx4 v[104:107], v6, s[20:23], s48 offen offset:1024 sc1
    buffer_load_dwordx4 v[108:111], v9, s[8:11], s54 offen sc1
    s_add_u32 s48, s48, 40960
    s_add_u32 s54, s54, 2560
    buffer_load_dwordx4 v[112:115], v6, s[20:23], s48 offen offset:0 sc1
    buffer_load_dwordx4 v[116:119], v6, s[20:23], s48 offen offset:1024 sc1
    buffer_load_dwordx4 v[120:123], v9, s[8:11], s54 offen sc1
    s_add_u32 s48, s48, 40960
    s_add_u32 s54, s54, 2560
    buffer_load_dwordx4 v[124:127], v6, s[20:23], s48 offen offset:0 sc1
    buffer_load_dwordx4 v[128:131], v6, s[20:23], s48 offen offset:1024 sc1
    buffer_load_dwordx4 v[132:135], v9, s[8:11], s54 offen sc1
    s_add_u32 s48, s48, 40960
    s_add_u32 s54, s54, 2560
    buffer_load_dwordx4 v[136:139], v6, s[20:23], s48 offen offset:0 sc1
    buffer_load_dwordx4 v[140:143], v6, s[20:23], s48 offen offset:1024 sc1
    buffer_load_dwordx4 v[144:147], v9, s[8:11], s54 offen sc1
    s_add_u32 s48, s48, 40960
    s_add_u32 s54, s54, 2560
    buffer_load_dwordx4 v[148:151], v6, s[20:23], s48 offen offset:0 sc1
    buffer_load_dwordx4 v[152:155], v6, s[20:23], s48 offen offset:1024 sc1
    buffer_load_dwordx4 v[156:159], v9, s[8:11], s54 offen sc1
    s_add_u32 s48, s48, 40960
    s_add_u32 s54, s54, 2560
    buffer_load_dwordx4 v[160:163], v6, s[20:23], s48 offen offset:0 sc1
    buffer_load_dwordx4 v[164:167], v6, s[20:23], s48 offen offset:1024 sc1
    buffer_load_dwordx4 v[168:171], v9, s[8:11], s54 offen sc1
    s_add_u32 s48, s48, 40960
    s_add_u32 s54, s54, 2560
    buffer_load_dwordx4 v[172:175], v6, s[20:23], s48 offen offset:0 sc1
    buffer_load_dwordx4 v[176:179], v6, s[20:23], s48 offen offset:1024 sc1
    buffer_load_dwordx4 v[180:183], v9, s[8:11], s54 offen sc1
    s_add_u32 s48, s48, 40960
    s_add_u32 s54, s54, 2560
    buffer_load_dwordx4 v[184:187], v6, s[20:23], s48 offen offset:0 sc1
    buffer_load_dwordx4 v[188:191], v6, s[20:23], s48 offen offset:1024 sc1
    buffer_load_dwordx4 v[192:195], v9, s[8:11], s54 offen sc1
    s_add_u32 s48, s48, 40960
    s_add_u32 s54, s54, 2560
    buffer_load_dwordx4 v[196:199], v6, s[20:23], s48 offen offset:0 sc1
    buffer_load_dwordx4 v[200:203], v6, s[20:23], s48 offen offset:1024 sc1
    buffer_load_dwordx4 v[204:207], v9, s[8:11], s54 offen sc1
    s_add_u32 s48, s48, 40960
    s_add_u32 s54, s54, 2560
    buffer_load_dwordx4 v[208:211], v6, s[20:23], s48 offen offset:0 sc1
    buffer_load_dwordx4 v[212:215], v6, s[20:23], s48 offen offset:1024 sc1
    buffer_load_dwordx4 v[216:219], v9, s[8:11], s54 offen sc1
    s_add_u32 s48, s48, 40960
    s_add_u32 s54, s54, 2560
    buffer_load_dwordx4 v[220:223], v6, s[20:23], s48 offen offset:0 sc1
    buffer_load_dwordx4 v[224:227], v6, s[20:23], s48 offen offset:1024 sc1
    buffer_load_dwordx4 v[228:231], v9, s[8:11], s54 offen sc1
    s_add_u32 s48, s48, 40960
    s_add_u32 s54, s54, 2560
    buffer_load_dwordx4 v[232:235], v6, s[20:23], s48 offen offset:0 sc1
    buffer_load_dwordx4 v[236:239], v6, s[20:23], s48 offen offset:1024 sc1
    buffer_load_dwordx4 v[240:243], v9, s[8:11], s54 offen sc1
    s_add_u32 s48, s48, 40960
    s_add_u32 s54, s54, 2560
    buffer_load_dwordx4 v[244:247], v6, s[20:23], s48 offen offset:0 sc1
    buffer_load_dwordx4 v[248:251], v6, s[20:23], s48 offen offset:1024 sc1
    buffer_load_dwordx4 v[252:255], v9, s[8:11], s54 offen sc1
    s_add_u32 s48, s48, 40960
    s_add_u32 s54, s54, 2560
    s_waitcnt vmcnt(45)
    v_mfma_f32_16x16x32_bf16 v[16:19], v[64:67], v[72:75], 0
    v_mfma_f32_16x16x32_bf16 v[20:23], v[68:71], v[72:75], 0
    buffer_load_dwordx4 v[64:67], v6, s[20:23], s48 offen offset:0 sc1
    buffer_load_dwordx4 v[68:71], v6, s[20:23], s48 offen offset:1024 sc1
    buffer_load_dwordx4 v[72:75], v9, s[8:11], s54 offen sc1
    s_add_u32 s48, s48, 40960
    s_add_u32 s54, s54, 2560
    s_waitcnt vmcnt(45)
    v_mfma_f32_16x16x32_bf16 v[16:19], v[76:79], v[84:87], v[16:19]
    v_mfma_f32_16x16x32_bf16 v[20:23], v[80:83], v[84:87], v[20:23]
    buffer_load_dwordx4 v[76:79], v6, s[20:23], s48 offen offset:0 sc1
    buffer_load_dwordx4 v[80:83], v6, s[20:23], s48 offen offset:1024 sc1
    buffer_load_dwordx4 v[84:87], v9, s[8:11], s54 offen sc1
    s_add_u32 s48, s48, 40960
    s_add_u32 s54, s54, 2560
    s_waitcnt vmcnt(45)
    v_mfma_f32_16x16x32_bf16 v[16:19], v[88:91], v[96:99], v[16:19]
    v_mfma_f32_16x16x32_bf16 v[20:23], v[92:95], v[96:99], v[20:23]
    buffer_load_dwordx4 v[88:91], v6, s[20:23], s48 offen offset:0 sc1
    buffer_load_dwordx4 v[92:95], v6, s[20:23], s48 offen offset:1024 sc1
    buffer_load_dwordx4 v[96:99], v9, s[8:11], s54 offen sc1
    s_add_u32 s48, s48, 40960
    s_add_u32 s54, s54, 2560
    s_waitcnt vmcnt(45)
    v_mfma_f32_16x16x32_bf16 v[16:19], v[100:103], v[108:111], v[16:19]
    v_mfma_f32_16x16x32_bf16 v[20:23], v[104:107], v[108:111], v[20:23]
    buffer_load_dwordx4 v[100:103], v6, s[20:23], s48 offen offset:0 sc1
    buffer_load_dwordx4 v[104:107], v6, s[20:23], s48 offen offset:1024 sc1
    buffer_load_dwordx4 v[108:111], v9, s[8:11], s54 offen sc1
    s_add_u32 s48, s48, 40960
    s_add_u32 s54, s54, 2560
    s_waitcnt vmcnt(45)
    v_mfma_f32_16x16x32_bf16 v[16:19], v[112:115], v[120:123], v[16:19]
    v_mfma_f32_16x16x32_bf16 v[20:23], v[116:119], v[120:123], v[20:23]
    buffer_load_dwordx4 v[112:115], v6, s[20:23], s48 offen offset:0 sc1
    buffer_load_dwordx4 v[116:119], v6, s[20:23], s48 offen offset:1024 sc1
    buffer_load_dwordx4 v[120:123], v9, s[8:11], s54 offen sc1
    s_add_u32 s48, s48, 40960
    s_add_u32 s54, s54, 2560
    s_waitcnt vmcnt(45)
    v_mfma_f32_16x16x32_bf16 v[16:19], v[124:127], v[132:135], v[16:19]
    v_mfma_f32_16x16x32_bf16 v[20:23], v[128:131], v[132:135], v[20:23]
    buffer_load_dwordx4 v[124:127], v6, s[20:23], s48 offen offset:0 sc1
    buffer_load_dwordx4 v[128:131], v6, s[20:23], s48 offen offset:1024 sc1
    buffer_load_dwordx4 v[132:135], v9, s[8:11], s54 offen sc1
    s_add_u32 s48, s48, 40960
    s_add_u32 s54, s54, 2560
    s_waitcnt vmcnt(45)
    v_mfma_f32_16x16x32_bf16 v[16:19], v[136:139], v[144:147], v[16:19]
    v_mfma_f32_16x16x32_bf16 v[20:23], v[140:143], v[144:147], v[20:23]
    buffer_load_dwordx4 v[136:139], v6, s[20:23], s48 offen offset:0 sc1
    buffer_load_dwordx4 v[140:143], v6, s[20:23], s48 offen offset:1024 sc1
    buffer_load_dwordx4 v[144:147], v9, s[8:11], s54 offen sc1
    s_add_u32 s48, s48, 40960
    s_add_u32 s54, s54, 2560
    s_waitcnt vmcnt(45)
    v_mfma_f32_16x16x32_bf16 v[16:19], v[148:151], v[156:159], v[16:19]
    v_mfma_f32_16x16x32_bf16 v[20:23], v[152:155], v[156:159], v[20:23]
    buffer_load_dwordx4 v[148:151], v6, s[20:23], s48 offen offset:0 sc1
    buffer_load_dwordx4 v[152:155], v6, s[20:23], s48 offen offset:1024 sc1
    buffer_load_dwordx4 v[156:159], v9, s[8:11], s54 offen sc1
    s_add_u32 s48, s48, 40960
    s_add_u32 s54, s54, 2560
    s_waitcnt vmcnt(45)
    v_mfma_f32_16x16x32_bf16 v[16:19], v[160:163], v[168:171], v[16:19]
    v_mfma_f32_16x16x32_bf16 v[20:23], v[164:167], v[168:171], v[20:23]
    buffer_load_dwordx4 v[160:163], v6, s[20:23], s48 offen offset:0 sc1
    buffer_load_dwordx4 v[164:167], v6, s[20:23], s48 offen offset:1024 sc1
    buffer_load_dwordx4 v[168:171], v9, s[8:11], s54 offen sc1
    s_add_u32 s48, s48, 40960
    s_add_u32 s54, s54, 2560
    s_waitcnt vmcnt(45)
    v_mfma_f32_16x16x32_bf16 v[16:19], v[172:175], v[180:183], v[16:19]
    v_mfma_f32_16x16x32_bf16 v[20:23], v[176:179], v[180:183], v[20:23]
    buffer_load_dwordx4 v[172:175], v6, s[20:23], s48 offen offset:0 sc1
    buffer_load_dwordx4 v[176:179], v6, s[20:23], s48 offen offset:1024 sc1
    buffer_load_dwordx4 v[180:183], v9, s[8:11], s54 offen sc1
    s_add_u32 s48, s48, 40960
    s_add_u32 s54, s54, 2560
    s_waitcnt vmcnt(45)
    v_mfma_f32_16x16x32_bf16 v[16:19], v[184:187], v[192:195], v[16:19]
    v_mfma_f32_16x16x32_bf16 v[20:23], v[188:191], v[192:195], v[20:23]
    buffer_load_dwordx4 v[184:187], v6, s[20:23], s48 offen offset:0 sc1
    buffer_load_dwordx4 v[188:191], v6, s[20:23], s48 offen offset:1024 sc1
    buffer_load_dwordx4 v[192:195], v9, s[8:11], s54 offen sc1
    s_add_u32 s48, s48, 40960
    s_add_u32 s54, s54, 2560
    s_waitcnt vmcnt(45)
    v_mfma_f32_16x16x32_bf16 v[16:19], v[196:199], v[204:207], v[16:19]
    v_mfma_f32_16x16x32_bf16 v[20:23], v[200:203], v[204:207], v[20:23]
    buffer_load_dwordx4 v[196:199], v6, s[20:23], s48 offen offset:0 sc1
    buffer_load_dwordx4 v[200:203], v6, s[20:23], s48 offen offset:1024 sc1
    buffer_load_dwordx4 v[204:207], v9, s[8:11], s54 offen sc1
    s_add_u32 s48, s48, 40960
    s_add_u32 s54, s54, 2560
    s_waitcnt vmcnt(45)
    v_mfma_f32_16x16x32_bf16 v[16:19], v[208:211], v[216:219], v[16:19]
    v_mfma_f32_16x16x32_bf16 v[20:23], v[212:215], v[216:219], v[20:23]
    buffer_load_dwordx4 v[208:211], v6, s[20:23], s48 offen offset:0 sc1
    buffer_load_dwordx4 v[212:215], v6, s[20:23], s48 offen offset:1024 sc1
    buffer_load_dwordx4 v[216:219], v9, s[8:11], s54 offen sc1
    s_add_u32 s48, s48, 40960
    s_add_u32 s54, s54, 2560
    s_waitcnt vmcnt(45)
    v_mfma_f32_16x16x32_bf16 v[16:19], v[220:223], v[228:231], v[16:19]
    v_mfma_f32_16x16x32_bf16 v[20:23], v[224:227], v[228:231], v[20:23]
    buffer_load_dwordx4 v[220:223], v6, s[20:23], s48 offen offset:0 sc1
    buffer_load_dwordx4 v[224:227], v6, s[20:23], s48 offen offset:1024 sc1
    buffer_load_dwordx4 v[228:231], v9, s[8:11], s54 offen sc1
    s_add_u32 s48, s48, 40960
    s_add_u32 s54, s54, 2560
    s_waitcnt vmcnt(45)
    v_mfma_f32_16x16x32_bf16 v[16:19], v[232:235], v[240:243], v[16:19]
    v_mfma_f32_16x16x32_bf16 v[20:23], v[236:239], v[240:243], v[20:23]
    buffer_load_dwordx4 v[232:235], v6, s[20:23], s48 offen offset:0 sc1
    buffer_load_dwordx4 v[236:239], v6, s[20:23], s48 offen offset:1024 sc1
    buffer_load_dwordx4 v[240:243], v9, s[8:11], s54 offen sc1
    s_add_u32 s48, s48, 40960
    s_add_u32 s54, s54, 2560
    s_waitcnt vmcnt(45)
    v_mfma_f32_16x16x32_bf16 v[16:19], v[244:247], v[252:255], v[16:19]
    v_mfma_f32_16x16x32_bf16 v[20:23], v[248:251], v[252:255], v[20:23]
    buffer_load_dwordx4 v[244:247], v6, s[20:23], s48 offen offset:0 sc1
    buffer_load_dwordx4 v[248:251], v6, s[20:23], s48 offen offset:1024 sc1
    buffer_load_dwordx4 v[252:255], v9, s[8:11], s54 offen sc1
    s_add_u32 s48, s48, 40960
    s_add_u32 s54, s54, 2560
    s_waitcnt vmcnt(45)
    v_mfma_f32_16x16x32_bf16 v[16:19], v[64:67], v[72:75], v[16:19]
    v_mfma_f32_16x16x32_bf16 v[20:23], v[68:71], v[72:75], v[20:23]
    buffer_load_dwordx4 v[64:67], v7, s[24:27], s49 offen offset:0 sc1
    buffer_load_dwordx4 v[68:71], v7, s[24:27], s49 offen offset:256 sc1
    buffer_load_dwordx4 v[72:75], v10, s[8:11], s55 offen sc1
    s_add_u32 s49, s49, 40960
    s_add_u32 s55, s55, 10240
    s_waitcnt vmcnt(45)
    v_mfma_f32_16x16x32_bf16 v[16:19], v[76:79], v[84:87], v[16:19]
    v_mfma_f32_16x16x32_bf16 v[20:23], v[80:83], v[84:87], v[20:23]
    buffer_load_dwordx4 v[76:79], v7, s[24:27], s49 offen offset:0 sc1
    buffer_load_dwordx4 v[80:83], v7, s[24:27], s49 offen offset:256 sc1
    buffer_load_dwordx4 v[84:87], v10, s[8:11], s55 offen sc1
    s_add_u32 s49, s49, 40960
    s_add_u32 s55, s55, 10240
    s_waitcnt vmcnt(45)
    v_mfma_f32_16x16x32_bf16 v[16:19], v[88:91], v[96:99], v[16:19]
    v_mfma_f32_16x16x32_bf16 v[20:23], v[92:95], v[96:99], v[20:23]
    buffer_load_dwordx4 v[88:91], v7, s[24:27], s49 offen offset:0 sc1
    buffer_load_dwordx4 v[92:95], v7, s[24:27], s49 offen offset:256 sc1
    buffer_load_dwordx4 v[96:99], v10, s[8:11], s55 offen sc1
    s_add_u32 s49, s49, 40960
    s_add_u32 s55, s55, 10240
    s_waitcnt vmcnt(45)
    v_mfma_f32_16x16x32_bf16 v[16:19], v[100:103], v[108:111], v[16:19]
    v_mfma_f32_16x16x32_bf16 v[20:23], v[104:107], v[108:111], v[20:23]
    buffer_load_dwordx4 v[100:103], v7, s[24:27], s49 offen offset:0 sc1
    buffer_load_dwordx4 v[104:107], v7, s[24:27], s49 offen offset:256 sc1
    buffer_load_dwordx4 v[108:111], v10, s[8:11], s55 offen sc1
    s_add_u32 s49, s49, 40960
    s_add_u32 s55, s55, 10240
    s_waitcnt vmcnt(45)
    v_mfma_f32_16x16x32_bf16 v[16:19], v[112:115], v[120:123], v[16:19]
    v_mfma_f32_16x16x32_bf16 v[20:23], v[116:119], v[120:123], v[20:23]
    buffer_load_dwordx4 v[112:115], v7, s[24:27], s49 offen offset:0 sc1
    buffer_load_dwordx4 v[116:119], v7, s[24:27], s49 offen offset:256 sc1
    buffer_load_dwordx4 v[120:123], v10, s[8:11], s55 offen sc1
    s_add_u32 s49, s49, 40960
    s_add_u32 s55, s55, 10240
    s_waitcnt vmcnt(45)
    v_mfma_f32_16x16x32_bf16 v[16:19], v[124:127], v[132:135], v[16:19]
    v_mfma_f32_16x16x32_bf16 v[20:23], v[128:131], v[132:135], v[20:23]
    buffer_load_dwordx4 v[124:127], v7, s[24:27], s49 offen offset:0 sc1
    buffer_load_dwordx4 v[128:131], v7, s[24:27], s49 offen offset:256 sc1
    buffer_load_dwordx4 v[132:135], v10, s[8:11], s55 offen sc1
    s_add_u32 s49, s49, 40960
    s_add_u32 s55, s55, 10240
    s_waitcnt vmcnt(45)
    v_mfma_f32_16x16x32_bf16 v[16:19], v[136:139], v[144:147], v[16:19]
    v_mfma_f32_16x16x32_bf16 v[20:23], v[140:143], v[144:147], v[20:23]
    buffer_load_dwordx4 v[136:139], v7, s[24:27], s49 offen offset:0 sc1
    buffer_load_dwordx4 v[140:143], v7, s[24:27], s49 offen offset:256 sc1
    buffer_load_dwordx4 v[144:147], v10, s[8:11], s55 offen sc1
    s_add_u32 s49, s49, 40960
    s_add_u32 s55, s55, 10240
    s_waitcnt vmcnt(45)
    v_mfma_f32_16x16x32_bf16 v[16:19], v[148:151], v[156:159], v[16:19]
    v_mfma_f32_16x16x32_bf16 v[20:23], v[152:155], v[156:159], v[20:23]
    buffer_load_dwordx4 v[148:151], v7, s[24:27], s49 offen offset:0 sc1
    buffer_load_dwordx4 v[152:155], v7, s[24:27], s49 offen offset:256 sc1
    buffer_load_dwordx4 v[156:159], v10, s[8:11], s55 offen sc1
    s_add_u32 s49, s49, 40960
    s_add_u32 s55, s55, 10240
    s_waitcnt vmcnt(45)
    v_mfma_f32_16x16x32_bf16 v[16:19], v[160:163], v[168:171], v[16:19]
    v_mfma_f32_16x16x32_bf16 v[20:23], v[164:167], v[168:171], v[20:23]
    s_waitcnt vmcnt(42)
    v_mfma_f32_16x16x32_bf16 v[16:19], v[172:175], v[180:183], v[16:19]
    v_mfma_f32_16x16x32_bf16 v[20:23], v[176:179], v[180:183], v[20:23]
    s_waitcnt vmcnt(39)
    v_mfma_f32_16x16x32_bf16 v[16:19], v[184:187], v[192:195], v[16:19]
    v_mfma_f32_16x16x32_bf16 v[20:23], v[188:191], v[192:195], v[20:23]
    s_waitcnt vmcnt(36)
    v_mfma_f32_16x16x32_bf16 v[16:19], v[196:199], v[204:207], v[16:19]
    v_mfma_f32_16x16x32_bf16 v[20:23], v[200:203], v[204:207], v[20:23]
    s_waitcnt vmcnt(33)
    v_mfma_f32_16x16x32_bf16 v[16:19], v[208:211], v[216:219], v[16:19]
    v_mfma_f32_16x16x32_bf16 v[20:23], v[212:215], v[216:219], v[20:23]
    s_waitcnt vmcnt(30)
    v_mfma_f32_16x16x32_bf16 v[16:19], v[220:223], v[228:231], v[16:19]
    v_mfma_f32_16x16x32_bf16 v[20:23], v[224:227], v[228:231], v[20:23]
    s_waitcnt vmcnt(27)
    v_mfma_f32_16x16x32_bf16 v[16:19], v[232:235], v[240:243], v[16:19]
    v_mfma_f32_16x16x32_bf16 v[20:23], v[236:239], v[240:243], v[20:23]
    s_waitcnt vmcnt(24)
    v_mfma_f32_16x16x32_bf16 v[16:19], v[244:247], v[252:255], v[16:19]
    v_mfma_f32_16x16x32_bf16 v[20:23], v[248:251], v[252:255], v[20:23]
    s_waitcnt vmcnt(21)
    v_mfma_f32_16x16x32_bf16 v[16:19], v[64:67], v[72:75], v[16:19]
    v_mfma_f32_16x16x32_bf16 v[20:23], v[68:71], v[72:75], v[20:23]
    s_waitcnt vmcnt(18)
    v_mfma_f32_16x16x32_bf16 v[16:19], v[76:79], v[84:87], v[16:19]
    v_mfma_f32_16x16x32_bf16 v[20:23], v[80:83], v[84:87], v[20:23]
    s_waitcnt vmcnt(15)
    v_mfma_f32_16x16x32_bf16 v[16:19], v[88:91], v[96:99], v[16:19]
    v_mfma_f32_16x16x32_bf16 v[20:23], v[92:95], v[96:99], v[20:23]
    s_waitcnt vmcnt(12)
    v_mfma_f32_16x16x32_bf16 v[16:19], v[100:103], v[108:111], v[16:19]
    v_mfma_f32_16x16x32_bf16 v[20:23], v[104:107], v[108:111], v[20:23]
    s_waitcnt vmcnt(9)
    v_mfma_f32_16x16x32_bf16 v[16:19], v[112:115], v[120:123], v[16:19]
    v_mfma_f32_16x16x32_bf16 v[20:23], v[116:119], v[120:123], v[20:23]
    s_waitcnt vmcnt(6)
    v_mfma_f32_16x16x32_bf16 v[16:19], v[124:127], v[132:135], v[16:19]
    v_mfma_f32_16x16x32_bf16 v[20:23], v[128:131], v[132:135], v[20:23]
    s_waitcnt vmcnt(3)
    v_mfma_f32_16x16x32_bf16 v[16:19], v[136:139], v[144:147], v[16:19]
    v_mfma_f32_16x16x32_bf16 v[20:23], v[140:143], v[144:147], v[20:23]
    s_waitcnt vmcnt(0)
    v_mfma_f32_16x16x32_bf16 v[16:19], v[148:151], v[156:159], v[16:19]
    v_mfma_f32_16x16x32_bf16 v[20:23], v[152:155], v[156:159], v[20:23]
    s_nop 7
    v_cvt_pk_bf16_f32 v64, v16, v17
    v_cvt_pk_bf16_f32 v65, v18, v19
    v_lshlrev_b32 v66, 16, v64
    v_and_b32 v67, 0xffff0000, v64
    v_lshlrev_b32 v68, 16, v40
    v_and_b32 v69, 0xffff0000, v40
    v_add_f32 v66, v68, v66
    v_add_f32 v67, v69, v67
    v_cvt_pk_bf16_f32 v70, v66, v67
    v_lshlrev_b32 v66, 16, v70
    v_and_b32 v67, 0xffff0000, v70
    v_lshlrev_b32 v68, 16, v42
    v_and_b32 v69, 0xffff0000, v42
    v_add_f32 v66, v66, v68
    v_add_f32 v67, v67, v69
    v_cvt_pk_bf16_f32 v72, v66, v67
    v_lshlrev_b32 v66, 16, v65
    v_and_b32 v67, 0xffff0000, v65
    v_lshlrev_b32 v68, 16, v41
    v_and_b32 v69, 0xffff0000, v41
    v_add_f32 v66, v68, v66
    v_add_f32 v67, v69, v67
    v_cvt_pk_bf16_f32 v70, v66, v67
    v_lshlrev_b32 v66, 16, v70
    v_and_b32 v67, 0xffff0000, v70
    v_lshlrev_b32 v68, 16, v43
    v_and_b32 v69, 0xffff0000, v43
    v_add_f32 v66, v66, v68
    v_add_f32 v67, v67, v69
    v_cvt_pk_bf16_f32 v73, v66, v67
    buffer_store_dwordx2 v[72:73], v5, s[44:47], 0 offen offset:0
    v_cvt_pk_bf16_f32 v64, v20, v21
    v_cvt_pk_bf16_f32 v65, v22, v23
    v_lshlrev_b32 v66, 16, v64
    v_and_b32 v67, 0xffff0000, v64
    v_lshlrev_b32 v68, 16, v44
    v_and_b32 v69, 0xffff0000, v44
    v_add_f32 v66, v68, v66
    v_add_f32 v67, v69, v67
    v_cvt_pk_bf16_f32 v70, v66, v67
    v_lshlrev_b32 v66, 16, v70
    v_and_b32 v67, 0xffff0000, v70
    v_lshlrev_b32 v68, 16, v46
    v_and_b32 v69, 0xffff0000, v46
    v_add_f32 v66, v66, v68
    v_add_f32 v67, v67, v69
    v_cvt_pk_bf16_f32 v74, v66, v67
    v_lshlrev_b32 v66, 16, v65
    v_and_b32 v67, 0xffff0000, v65
    v_lshlrev_b32 v68, 16, v45
    v_and_b32 v69, 0xffff0000, v45
    v_add_f32 v66, v68, v66
    v_add_f32 v67, v69, v67
    v_cvt_pk_bf16_f32 v70, v66, v67
    v_lshlrev_b32 v66, 16, v70
    v_and_b32 v67, 0xffff0000, v70
    v_lshlrev_b32 v68, 16, v47
    v_and_b32 v69, 0xffff0000, v47
    v_add_f32 v66, v66, v68
    v_add_f32 v67, v67, v69
    v_cvt_pk_bf16_f32 v75, v66, v67
    buffer_store_dwordx2 v[74:75], v5, s[44:47], 0 offen offset:32
    s_cmp_lg_u32 s61, 0
    s_cbranch_scc1 if_skip_44
    s_mov_b64 exec, 1
    v_accvgpr_write_b32 a255, 1
    v_mov_b32 v3, 0
    s_nop 1
    buffer_atomic_add a255, v3, s[56:59], s75 offen sc0 sc1
    s_mov_b64 exec, -1
if_skip_44:
    s_waitcnt vmcnt(0)
    s_xor_b32 s66, s66, 16
    v_mov_b32 v3, 160000
    v_add_u32 v3, s66, v3
    s_cmp_lg_u32 s61, 0
    s_cbranch_scc1 fi1_45
    v_accvgpr_read_b32 v2, a255
    s_mov_b64 exec, 1
    ds_write_b32 v3, v2
    s_mov_b64 exec, -1
    s_waitcnt lgkmcnt(0)
fi1_45:
    s_barrier
    ds_read_b32 v4, v3
    s_waitcnt lgkmcnt(0)
    v_readfirstlane_b32 s62, v4
    s_nop 3
    s_cmp_eq_u32 s63, 0
    s_cbranch_scc1 mega_decA
    s_branch mega_decB
chain_entry:
    s_load_dwordx2 s[4:5], s[0:1], 104
    s_load_dwordx4 s[32:35], s[0:1], 16
    s_load_dwordx2 s[36:37], s[0:1], 96
    v_and_b32 v1, 63, v0
    v_lshlrev_b32 v4, 4, v0
    v_add_u32 v6, 4096, v4
    v_and_b32 v5, 127, v0
    v_lshlrev_b32 v5, 4, v5
    v_add_u32 v5, 8192, v5
    v_readfirstlane_b32 s38, v0
    s_waitcnt lgkmcnt(0)
    s_lshr_b32 s38, s38, 6
    s_add_u32 s8, s4, 194510848
    s_addc_u32 s9, s5, 0
    s_mov_b32 s10, 665600
    s_mov_b32 s11, 0x00020000
    s_add_u32 s12, s4, 195178496
    s_addc_u32 s13, s5, 0
    s_mov_b32 s14, 1310720
    s_mov_b32 s15, 0x00020000
    s_add_u32 s56, s4, 231616512
    s_addc_u32 s57, s5, 0
    s_mov_b32 s58, 131072
    s_mov_b32 s59, 0x00020000
    s_cmp_ge_u32 s2, 32
    s_cbranch_scc1 o_role
qk_role:
    s_mov_b32 s16, s32
    s_mov_b32 s17, s33
    s_mov_b32 s18, 7864320
    s_mov_b32 s19, 0x00020000
    s_mov_b32 s20, s34
    s_mov_b32 s21, s35
    s_mov_b32 s22, 7864320
    s_mov_b32 s23, 0x00020000
    s_add_u32 s24, s4, 2621440
    s_addc_u32 s25, s5, 0
    s_mov_b32 s26, 25165824
    s_mov_b32 s27, 0x00020000
    s_add_u32 s28, s4, 196489216
    s_addc_u32 s29, s5, 0
    s_mov_b32 s30, 6291456
    s_mov_b32 s31, 0x00020000
    v_lshrrev_b32 v7, 3, v0
    v_and_b32 v8, 7, v0
    s_mov_b32 s42, 12288
    v_mul_lo_u32 v9, v7, s42
    v_lshl_add_u32 v9, v8, 4, v9
    v_mul_u32_u24 v10, 800, v7
    v_lshl_add_u32 v10, v8, 4, v10
    v_add_u32 v10, 133120, v10
    v_and_b32 v11, 15, v1
    v_lshrrev_b32 v12, 4, v1
    v_lshrrev_b32 v13, 2, v11
    v_lshl_add_u32 v13, v12, 3, v13
    v_mul_u32_u24 v13, 800, v13
    v_and_b32 v14, 3, v11
    v_lshl_add_u32 v13, v14, 3, v13
    s_mul_i32 s42, s38, 192
    s_add_u32 s42, s42, 133120
    v_add_u32 v13, s42, v13
    s_mul_i32 s42, s38, 28672
    s_add_u32 s42, s42, 18432
    v_lshlrev_b32 v14, 4, v1
    v_add_u32 v14, s42, v14
    s_mul_i32 s41, s2, 384
    buffer_load_dwordx4 v[16:19], v9, s[16:19], s41 offen offset:0
    buffer_load_dwordx4 v[20:23], v9, s[16:19], s41 offen offset:128
    buffer_load_dwordx4 v[24:27], v9, s[16:19], s41 offen offset:256
    buffer_load_dwordx4 v[28:31], v9, s[20:23], s41 offen offset:0
    buffer_load_dwordx4 v[32:35], v9, s[20:23], s41 offen offset:128
    buffer_load_dwordx4 v[36:39], v9, s[20:23], s41 offen offset:256
    s_add_u32 s41, s41, 393216
    buffer_load_dwordx4 v[44:47], v9, s[16:19], s41 offen offset:0
    buffer_load_dwordx4 v[48:51], v9, s[16:19], s41 offen offset:128
    buffer_load_dwordx4 v[52:55], v9, s[16:19], s41 offen offset:256
    buffer_load_dwordx4 v[56:59], v9, s[20:23], s41 offen offset:0
    buffer_load_dwordx4 v[60:63], v9, s[20:23], s41 offen offset:128
    buffer_load_dwordx4 v[64:67], v9, s[20:23], s41 offen offset:256
    s_add_u32 s41, s41, 393216
    s_waitcnt vmcnt(6)
    s_barrier
    ds_write_b128 v10, v[16:19] offset:0
    ds_write_b128 v10, v[20:23] offset:128
    ds_write_b128 v10, v[24:27] offset:256
    ds_write_b128 v10, v[28:31] offset:384
    ds_write_b128 v10, v[32:35] offset:512
    ds_write_b128 v10, v[36:39] offset:640
    s_waitcnt lgkmcnt(0)
    s_barrier
    ds_read_b64_tr_b16 a[0:1], v13 offset:0
    ds_read_b64_tr_b16 a[2:3], v13 offset:3200
    ds_read_b64_tr_b16 a[4:5], v13 offset:32
    ds_read_b64_tr_b16 a[6:7], v13 offset:3232
    ds_read_b64_tr_b16 a[8:9], v13 offset:64
    ds_read_b64_tr_b16 a[10:11], v13 offset:3264
    ds_read_b64_tr_b16 v[40:41], v13 offset:96
    ds_read_b64_tr_b16 v[42:43], v13 offset:3296
    s_waitcnt lgkmcnt(0)
    ds_write_b128 v14, v[40:43] offset:0
    ds_read_b64_tr_b16 a[12:13], v13 offset:128
    ds_read_b64_tr_b16 a[14:15], v13 offset:3328
    ds_read_b64_tr_b16 a[16:17], v13 offset:160
    ds_read_b64_tr_b16 a[18:19], v13 offset:3360
    s_waitcnt lgkmcnt(0)
    buffer_load_dwordx4 v[16:19], v9, s[16:19], s41 offen offset:0
    buffer_load_dwordx4 v[20:23], v9, s[16:19], s41 offen offset:128
    buffer_load_dwordx4 v[24:27], v9, s[16:19], s41 offen offset:256
    buffer_load_dwordx4 v[28:31], v9, s[20:23], s41 offen offset:0
    buffer_load_dwordx4 v[32:35], v9, s[20:23], s41 offen offset:128
    buffer_load_dwordx4 v[36:39], v9, s[20:23], s41 offen offset:256
    s_add_u32 s41, s41, 393216
    s_waitcnt vmcnt(6)
    s_barrier
    ds_write_b128 v10, v[44:47] offset:0
    ds_write_b128 v10, v[48:51] offset:128
    ds_write_b128 v10, v[52:55] offset:256
    ds_write_b128 v10, v[56:59] offset:384
    ds_write_b128 v10, v[60:63] offset:512
    ds_write_b128 v10, v[64:67] offset:640
    s_waitcnt lgkmcnt(0)
    s_barrier
    ds_read_b64_tr_b16 a[20:21], v13 offset:0
    ds_read_b64_tr_b16 a[22:23], v13 offset:3200
    ds_read_b64_tr_b16 v[40:41], v13 offset:32
    ds_read_b64_tr_b16 v[42:43], v13 offset:3232
    s_waitcnt lgkmcnt(0)
    ds_write_b128 v14, v[40:43] offset:1024
    ds_read_b64_tr_b16 a[24:25], v13 offset:64
    ds_read_b64_tr_b16 a[26:27], v13 offset:3264
    ds_read_b64_tr_b16 a[28:29], v13 offset:96
    ds_read_b64_tr_b16 a[30:31], v13 offset:3296
    ds_read_b64_tr_b16 a[32:33], v13 offset:128
    ds_read_b64_tr_b16 a[34:35], v13 offset:3328
    ds_read_b64_tr_b16 v[40:41], v13 offset:160
    ds_read_b64_tr_b16 v[42:43], v13 offset:3360
    s_waitcnt lgkmcnt(0)
    ds_write_b128 v14, v[40:43] offset:2048
    s_waitcnt lgkmcnt(0)
    buffer_load_dwordx4 v[44:47], v9, s[16:19], s41 offen offset:0
    buffer_load_dwordx4 v[48:51], v9, s[16:19], s41 offen offset:128
    buffer_load_dwordx4 v[52:55], v9, s[16:19], s41 offen offset:256
    buffer_load_dwordx4 v[56:59], v9, s[20:23], s41 offen offset:0
    buffer_load_dwordx4 v[60:63], v9, s[20:23], s41 offen offset:128
    buffer_load_dwordx4 v[64:67], v9, s[20:23], s41 offen offset:256
    s_add_u32 s41, s41, 393216
    s_waitcnt vmcnt(6)
    s_barrier
    ds_write_b128 v10, v[16:19] offset:0
    ds_write_b128 v10, v[20:23] offset:128
    ds_write_b128 v10, v[24:27] offset:256
    ds_write_b128 v10, v[28:31] offset:384
    ds_write_b128 v10, v[32:35] offset:512
    ds_write_b128 v10, v[36:39] offset:640
    s_waitcnt lgkmcnt(0)
    s_barrier
    ds_read_b64_tr_b16 a[36:37], v13 offset:0
    ds_read_b64_tr_b16 a[38:39], v13 offset:3200
    ds_read_b64_tr_b16 a[40:41], v13 offset:32
    ds_read_b64_tr_b16 a[42:43], v13 offset:3232
    ds_read_b64_tr_b16 a[44:45], v13 offset:64
    ds_read_b64_tr_b16 a[46:47], v13 offset:3264
    ds_read_b64_tr_b16 v[40:41], v13 offset:96
    ds_read_b64_tr_b16 v[42:43], v13 offset:3296
    s_waitcnt lgkmcnt(0)
    ds_write_b128 v14, v[40:43] offset:3072
    ds_read_b64_tr_b16 a[48:49], v13 offset:128
    ds_read_b64_tr_b16 a[50:51], v13 offset:3328
    ds_read_b64_tr_b16 a[52:53], v13 offset:160
    ds_read_b64_tr_b16 a[54:55], v13 offset:3360
    s_waitcnt lgkmcnt(0)
    buffer_load_dwordx4 v[16:19], v9, s[16:19], s41 offen offset:0
    buffer_load_dwordx4 v[20:23], v9, s[16:19], s41 offen offset:128
    buffer_load_dwordx4 v[24:27], v9, s[16:19], s41 offen offset:256
    buffer_load_dwordx4 v[28:31], v9, s[20:23], s41 offen offset:0
    buffer_load_dwordx4 v[32:35], v9, s[20:23], s41 offen offset:128
    buffer_load_dwordx4 v[36:39], v9, s[20:23], s41 offen offset:256
    s_add_u32 s41, s41, 393216
    s_waitcnt vmcnt(6)
    s_barrier
    ds_write_b128 v10, v[44:47] offset:0
    ds_write_b128 v10, v[48:51] offset:128
    ds_write_b128 v10, v[52:55] offset:256
    ds_write_b128 v10, v[56:59] offset:384
    ds_write_b128 v10, v[60:63] offset:512
    ds_write_b128 v10, v[64:67] offset:640
    s_waitcnt lgkmcnt(0)
    s_barrier
    ds_read_b64_tr_b16 a[56:57], v13 offset:0
    ds_read_b64_tr_b16 a[58:59], v13 offset:3200
    ds_read_b64_tr_b16 v[40:41], v13 offset:32
    ds_read_b64_tr_b16 v[42:43], v13 offset:3232
    s_waitcnt lgkmcnt(0)
    ds_write_b128 v14, v[40:43] offset:4096
    ds_read_b64_tr_b16 a[60:61], v13 offset:64
    ds_read_b64_tr_b16 a[62:63], v13 offset:3264
    ds_read_b64_tr_b16 a[64:65], v13 offset:96
    ds_read_b64_tr_b16 a[66:67], v13 offset:3296
    ds_read_b64_tr_b16 a[68:69], v13 offset:128
    ds_read_b64_tr_b16 a[70:71], v13 offset:3328
    ds_read_b64_tr_b16 v[40:41], v13 offset:160
    ds_read_b64_tr_b16 v[42:43], v13 offset:3360
    s_waitcnt lgkmcnt(0)
    ds_write_b128 v14, v[40:43] offset:5120
    s_waitcnt lgkmcnt(0)
    buffer_load_dwordx4 v[44:47], v9, s[16:19], s41 offen offset:0
    buffer_load_dwordx4 v[48:51], v9, s[16:19], s41 offen offset:128
    buffer_load_dwordx4 v[52:55], v9, s[16:19], s41 offen offset:256
    buffer_load_dwordx4 v[56:59], v9, s[20:23], s41 offen offset:0
    buffer_load_dwordx4 v[60:63], v9, s[20:23], s41 offen offset:128
    buffer_load_dwordx4 v[64:67], v9, s[20:23], s41 offen offset:256
    s_add_u32 s41, s41, 393216
    s_waitcnt vmcnt(6)
    s_barrier
    ds_write_b128 v10, v[16:19] offset:0
    ds_write_b128 v10, v[20:23] offset:128
    ds_write_b128 v10, v[24:27] offset:256
    ds_write_b128 v10, v[28:31] offset:384
    ds_write_b128 v10, v[32:35] offset:512
    ds_write_b128 v10, v[36:39] offset:640
    s_waitcnt lgkmcnt(0)
    s_barrier
    ds_read_b64_tr_b16 a[72:73], v13 offset:0
    ds_read_b64_tr_b16 a[74:75], v13 offset:3200
    ds_read_b64_tr_b16 a[76:77], v13 offset:32
    ds_read_b64_tr_b16 a[78:79], v13 offset:3232
    ds_read_b64_tr_b16 a[80:81], v13 offset:64
    ds_read_b64_tr_b16 a[82:83], v13 offset:3264
    ds_read_b64_tr_b16 v[40:41], v13 offset:96
    ds_read_b64_tr_b16 v[42:43], v13 offset:3296
    s_waitcnt lgkmcnt(0)
    ds_write_b128 v14, v[40:43] offset:6144
    ds_read_b64_tr_b16 a[84:85], v13 offset:128
    ds_read_b64_tr_b16 a[86:87], v13 offset:3328
    ds_read_b64_tr_b16 a[88:89], v13 offset:160
    ds_read_b64_tr_b16 a[90:91], v13 offset:3360
    s_waitcnt lgkmcnt(0)
    buffer_load_dwordx4 v[16:19], v9, s[16:19], s41 offen offset:0
    buffer_load_dwordx4 v[20:23], v9, s[16:19], s41 offen offset:128
    buffer_load_dwordx4 v[24:27], v9, s[16:19], s41 offen offset:256
    buffer_load_dwordx4 v[28:31], v9, s[20:23], s41 offen offset:0
    buffer_load_dwordx4 v[32:35], v9, s[20:23], s41 offen offset:128
    buffer_load_dwordx4 v[36:39], v9, s[20:23], s41 offen offset:256
    s_add_u32 s41, s41, 393216
    s_waitcnt vmcnt(6)
    s_barrier
    ds_write_b128 v10, v[44:47] offset:0
    ds_write_b128 v10, v[48:51] offset:128
    ds_write_b128 v10, v[52:55] offset:256
    ds_write_b128 v10, v[56:59] offset:384
    ds_write_b128 v10, v[60:63] offset:512
    ds_write_b128 v10, v[64:67] offset:640
    s_waitcnt lgkmcnt(0)
    s_barrier
    ds_read_b64_tr_b16 a[92:93], v13 offset:0
    ds_read_b64_tr_b16 a[94:95], v13 offset:3200
    ds_read_b64_tr_b16 v[40:41], v13 offset:32
    ds_read_b64_tr_b16 v[42:43], v13 offset:3232
    s_waitcnt lgkmcnt(0)
    ds_write_b128 v14, v[40:43] offset:7168
    ds_read_b64_tr_b16 a[96:97], v13 offset:64
    ds_read_b64_tr_b16 a[98:99], v13 offset:3264
    ds_read_b64_tr_b16 a[100:101], v13 offset:96
    ds_read_b64_tr_b16 a[102:103], v13 offset:3296
    ds_read_b64_tr_b16 a[104:105], v13 offset:128
    ds_read_b64_tr_b16 a[106:107], v13 offset:3328
    ds_read_b64_tr_b16 v[40:41], v13 offset:160
    ds_read_b64_tr_b16 v[42:43], v13 offset:3360
    s_waitcnt lgkmcnt(0)
    ds_write_b128 v14, v[40:43] offset:8192
    s_waitcnt lgkmcnt(0)
    buffer_load_dwordx4 v[44:47], v9, s[16:19], s41 offen offset:0
    buffer_load_dwordx4 v[48:51], v9, s[16:19], s41 offen offset:128
    buffer_load_dwordx4 v[52:55], v9, s[16:19], s41 offen offset:256
    buffer_load_dwordx4 v[56:59], v9, s[20:23], s41 offen offset:0
    buffer_load_dwordx4 v[60:63], v9, s[20:23], s41 offen offset:128
    buffer_load_dwordx4 v[64:67], v9, s[20:23], s41 offen offset:256
    s_add_u32 s41, s41, 393216
    s_waitcnt vmcnt(6)
    s_barrier
    ds_write_b128 v10, v[16:19] offset:0
    ds_write_b128 v10, v[20:23] offset:128
    ds_write_b128 v10, v[24:27] offset:256
    ds_write_b128 v10, v[28:31] offset:384
    ds_write_b128 v10, v[32:35] offset:512
    ds_write_b128 v10, v[36:39] offset:640
    s_waitcnt lgkmcnt(0)
    s_barrier
    ds_read_b64_tr_b16 a[108:109], v13 offset:0
    ds_read_b64_tr_b16 a[110:111], v13 offset:3200
    ds_read_b64_tr_b16 a[112:113], v13 offset:32
    ds_read_b64_tr_b16 a[114:115], v13 offset:3232
    ds_read_b64_tr_b16 a[116:117], v13 offset:64
    ds_read_b64_tr_b16 a[118:119], v13 offset:3264
    ds_read_b64_tr_b16 v[40:41], v13 offset:96
    ds_read_b64_tr_b16 v[42:43], v13 offset:3296
    s_waitcnt lgkmcnt(0)
    ds_write_b128 v14, v[40:43] offset:9216
    ds_read_b64_tr_b16 a[120:121], v13 offset:128
    ds_read_b64_tr_b16 a[122:123], v13 offset:3328
    ds_read_b64_tr_b16 a[124:125], v13 offset:160
    ds_read_b64_tr_b16 a[126:127], v13 offset:3360
    s_waitcnt lgkmcnt(0)
    buffer_load_dwordx4 v[16:19], v9, s[16:19], s41 offen offset:0
    buffer_load_dwordx4 v[20:23], v9, s[16:19], s41 offen offset:128
    buffer_load_dwordx4 v[24:27], v9, s[16:19], s41 offen offset:256
    buffer_load_dwordx4 v[28:31], v9, s[20:23], s41 offen offset:0
    buffer_load_dwordx4 v[32:35], v9, s[20:23], s41 offen offset:128
    buffer_load_dwordx4 v[36:39], v9, s[20:23], s41 offen offset:256
    s_add_u32 s41, s41, 393216
    s_waitcnt vmcnt(6)
    s_barrier
    ds_write_b128 v10, v[44:47] offset:0
    ds_write_b128 v10, v[48:51] offset:128
    ds_write_b128 v10, v[52:55] offset:256
    ds_write_b128 v10, v[56:59] offset:384
    ds_write_b128 v10, v[60:63] offset:512
    ds_write_b128 v10, v[64:67] offset:640
    s_waitcnt lgkmcnt(0)
    s_barrier
    ds_read_b64_tr_b16 a[128:129], v13 offset:0
    ds_read_b64_tr_b16 a[130:131], v13 offset:3200
    ds_read_b64_tr_b16 v[40:41], v13 offset:32
    ds_read_b64_tr_b16 v[42:43], v13 offset:3232
    s_waitcnt lgkmcnt(0)
    ds_write_b128 v14, v[40:43] offset:10240
    ds_read_b64_tr_b16 a[132:133], v13 offset:64
    ds_read_b64_tr_b16 a[134:135], v13 offset:3264
    ds_read_b64_tr_b16 a[136:137], v13 offset:96
    ds_read_b64_tr_b16 a[138:139], v13 offset:3296
    ds_read_b64_tr_b16 a[140:141], v13 offset:128
    ds_read_b64_tr_b16 a[142:143], v13 offset:3328
    ds_read_b64_tr_b16 v[40:41], v13 offset:160
    ds_read_b64_tr_b16 v[42:43], v13 offset:3360
    s_waitcnt lgkmcnt(0)
    ds_write_b128 v14, v[40:43] offset:11264
    s_waitcnt lgkmcnt(0)
    buffer_load_dwordx4 v[44:47], v9, s[16:19], s41 offen offset:0
    buffer_load_dwordx4 v[48:51], v9, s[16:19], s41 offen offset:128
    buffer_load_dwordx4 v[52:55], v9, s[16:19], s41 offen offset:256
    buffer_load_dwordx4 v[56:59], v9, s[20:23], s41 offen offset:0
    buffer_load_dwordx4 v[60:63], v9, s[20:23], s41 offen offset:128
    buffer_load_dwordx4 v[64:67], v9, s[20:23], s41 offen offset:256
    s_add_u32 s41, s41, 393216
    s_waitcnt vmcnt(6)
    s_barrier
    ds_write_b128 v10, v[16:19] offset:0
    ds_write_b128 v10, v[20:23] offset:128
    ds_write_b128 v10, v[24:27] offset:256
    ds_write_b128 v10, v[28:31] offset:384
    ds_write_b128 v10, v[32:35] offset:512
    ds_write_b128 v10, v[36:39] offset:640
    s_waitcnt lgkmcnt(0)
    s_barrier
    ds_read_b64_tr_b16 a[144:145], v13 offset:0
    ds_read_b64_tr_b16 a[146:147], v13 offset:3200
    ds_read_b64_tr_b16 a[148:149], v13 offset:32
    ds_read_b64_tr_b16 a[150:151], v13 offset:3232
    ds_read_b64_tr_b16 a[152:153], v13 offset:64
    ds_read_b64_tr_b16 a[154:155], v13 offset:3264
    ds_read_b64_tr_b16 v[40:41], v13 offset:96
    ds_read_b64_tr_b16 v[42:43], v13 offset:3296
    s_waitcnt lgkmcnt(0)
    ds_write_b128 v14, v[40:43] offset:12288
    ds_read_b64_tr_b16 a[156:157], v13 offset:128
    ds_read_b64_tr_b16 a[158:159], v13 offset:3328
    ds_read_b64_tr_b16 a[160:161], v13 offset:160
    ds_read_b64_tr_b16 a[162:163], v13 offset:3360
    s_waitcnt lgkmcnt(0)
    buffer_load_dwordx4 v[16:19], v9, s[16:19], s41 offen offset:0
    buffer_load_dwordx4 v[20:23], v9, s[16:19], s41 offen offset:128
    buffer_load_dwordx4 v[24:27], v9, s[16:19], s41 offen offset:256
    buffer_load_dwordx4 v[28:31], v9, s[20:23], s41 offen offset:0
    buffer_load_dwordx4 v[32:35], v9, s[20:23], s41 offen offset:128
    buffer_load_dwordx4 v[36:39], v9, s[20:23], s41 offen offset:256
    s_add_u32 s41, s41, 393216
    s_waitcnt vmcnt(6)
    s_barrier
    ds_write_b128 v10, v[44:47] offset:0
    ds_write_b128 v10, v[48:51] offset:128
    ds_write_b128 v10, v[52:55] offset:256
    ds_write_b128 v10, v[56:59] offset:384
    ds_write_b128 v10, v[60:63] offset:512
    ds_write_b128 v10, v[64:67] offset:640
    s_waitcnt lgkmcnt(0)
    s_barrier
    ds_read_b64_tr_b16 a[164:165], v13 offset:0
    ds_read_b64_tr_b16 a[166:167], v13 offset:3200
    ds_read_b64_tr_b16 v[40:41], v13 offset:32
    ds_read_b64_tr_b16 v[42:43], v13 offset:3232
    s_waitcnt lgkmcnt(0)
    ds_write_b128 v14, v[40:43] offset:13312
    ds_read_b64_tr_b16 a[168:169], v13 offset:64
    ds_read_b64_tr_b16 a[170:171], v13 offset:3264
    ds_read_b64_tr_b16 a[172:173], v13 offset:96
    ds_read_b64_tr_b16 a[174:175], v13 offset:3296
    ds_read_b64_tr_b16 a[176:177], v13 offset:128
    ds_read_b64_tr_b16 a[178:179], v13 offset:3328
    ds_read_b64_tr_b16 v[40:41], v13 offset:160
    ds_read_b64_tr_b16 v[42:43], v13 offset:3360
    s_waitcnt lgkmcnt(0)
    ds_write_b128 v14, v[40:43] offset:14336
    s_waitcnt lgkmcnt(0)
    buffer_load_dwordx4 v[44:47], v9, s[16:19], s41 offen offset:0
    buffer_load_dwordx4 v[48:51], v9, s[16:19], s41 offen offset:128
    buffer_load_dwordx4 v[52:55], v9, s[16:19], s41 offen offset:256
    buffer_load_dwordx4 v[56:59], v9, s[20:23], s41 offen offset:0
    buffer_load_dwordx4 v[60:63], v9, s[20:23], s41 offen offset:128
    buffer_load_dwordx4 v[64:67], v9, s[20:23], s41 offen offset:256
    s_add_u32 s41, s41, 393216
    s_waitcnt vmcnt(6)
    s_barrier
    ds_write_b128 v10, v[16:19] offset:0
    ds_write_b128 v10, v[20:23] offset:128
    ds_write_b128 v10, v[24:27] offset:256
    ds_write_b128 v10, v[28:31] offset:384
    ds_write_b128 v10, v[32:35] offset:512
    ds_write_b128 v10, v[36:39] offset:640
    s_waitcnt lgkmcnt(0)
    s_barrier
    ds_read_b64_tr_b16 a[180:181], v13 offset:0
    ds_read_b64_tr_b16 a[182:183], v13 offset:3200
    ds_read_b64_tr_b16 a[184:185], v13 offset:32
    ds_read_b64_tr_b16 a[186:187], v13 offset:3232
    ds_read_b64_tr_b16 a[188:189], v13 offset:64
    ds_read_b64_tr_b16 a[190:191], v13 offset:3264
    ds_read_b64_tr_b16 v[40:41], v13 offset:96
    ds_read_b64_tr_b16 v[42:43], v13 offset:3296
    s_waitcnt lgkmcnt(0)
    ds_write_b128 v14, v[40:43] offset:15360
    ds_read_b64_tr_b16 a[192:193], v13 offset:128
    ds_read_b64_tr_b16 a[194:195], v13 offset:3328
    ds_read_b64_tr_b16 a[196:197], v13 offset:160
    ds_read_b64_tr_b16 a[198:199], v13 offset:3360
    s_waitcnt lgkmcnt(0)
    buffer_load_dwordx4 v[16:19], v9, s[16:19], s41 offen offset:0
    buffer_load_dwordx4 v[20:23], v9, s[16:19], s41 offen offset:128
    buffer_load_dwordx4 v[24:27], v9, s[16:19], s41 offen offset:256
    buffer_load_dwordx4 v[28:31], v9, s[20:23], s41 offen offset:0
    buffer_load_dwordx4 v[32:35], v9, s[20:23], s41 offen offset:128
    buffer_load_dwordx4 v[36:39], v9, s[20:23], s41 offen offset:256
    s_add_u32 s41, s41, 393216
    s_waitcnt vmcnt(6)
    s_barrier
    ds_write_b128 v10, v[44:47] offset:0
    ds_write_b128 v10, v[48:51] offset:128
    ds_write_b128 v10, v[52:55] offset:256
    ds_write_b128 v10, v[56:59] offset:384
    ds_write_b128 v10, v[60:63] offset:512
    ds_write_b128 v10, v[64:67] offset:640
    s_waitcnt lgkmcnt(0)
    s_barrier
    ds_read_b64_tr_b16 a[200:201], v13 offset:0
    ds_read_b64_tr_b16 a[202:203], v13 offset:3200
    ds_read_b64_tr_b16 v[40:41], v13 offset:32
    ds_read_b64_tr_b16 v[42:43], v13 offset:3232
    s_waitcnt lgkmcnt(0)
    ds_write_b128 v14, v[40:43] offset:16384
    ds_read_b64_tr_b16 a[204:205], v13 offset:64
    ds_read_b64_tr_b16 a[206:207], v13 offset:3264
    ds_read_b64_tr_b16 a[208:209], v13 offset:96
    ds_read_b64_tr_b16 a[210:211], v13 offset:3296
    ds_read_b64_tr_b16 a[212:213], v13 offset:128
    ds_read_b64_tr_b16 a[214:215], v13 offset:3328
    ds_read_b64_tr_b16 v[40:41], v13 offset:160
    ds_read_b64_tr_b16 v[42:43], v13 offset:3360
    s_waitcnt lgkmcnt(0)
    ds_write_b128 v14, v[40:43] offset:17408
    s_waitcnt lgkmcnt(0)
    buffer_load_dwordx4 v[44:47], v9, s[16:19], s41 offen offset:0
    buffer_load_dwordx4 v[48:51], v9, s[16:19], s41 offen offset:128
    buffer_load_dwordx4 v[52:55], v9, s[16:19], s41 offen offset:256
    buffer_load_dwordx4 v[56:59], v9, s[20:23], s41 offen offset:0
    buffer_load_dwordx4 v[60:63], v9, s[20:23], s41 offen offset:128
    buffer_load_dwordx4 v[64:67], v9, s[20:23], s41 offen offset:256
    s_add_u32 s41, s41, 393216
    s_waitcnt vmcnt(6)
    s_barrier
    ds_write_b128 v10, v[16:19] offset:0
    ds_write_b128 v10, v[20:23] offset:128
    ds_write_b128 v10, v[24:27] offset:256
    ds_write_b128 v10, v[28:31] offset:384
    ds_write_b128 v10, v[32:35] offset:512
    ds_write_b128 v10, v[36:39] offset:640
    s_waitcnt lgkmcnt(0)
    s_barrier
    ds_read_b64_tr_b16 a[216:217], v13 offset:0
    ds_read_b64_tr_b16 a[218:219], v13 offset:3200
    ds_read_b64_tr_b16 a[220:221], v13 offset:32
    ds_read_b64_tr_b16 a[222:223], v13 offset:3232
    ds_read_b64_tr_b16 a[224:225], v13 offset:64
    ds_read_b64_tr_b16 a[226:227], v13 offset:3264
    ds_read_b64_tr_b16 v[40:41], v13 offset:96
    ds_read_b64_tr_b16 v[42:43], v13 offset:3296
    s_waitcnt lgkmcnt(0)
    ds_write_b128 v14, v[40:43] offset:18432
    ds_read_b64_tr_b16 a[228:229], v13 offset:128
    ds_read_b64_tr_b16 a[230:231], v13 offset:3328
    ds_read_b64_tr_b16 a[232:233], v13 offset:160
    ds_read_b64_tr_b16 a[234:235], v13 offset:3360
    s_waitcnt lgkmcnt(0)
    buffer_load_dwordx4 v[16:19], v9, s[16:19], s41 offen offset:0
    buffer_load_dwordx4 v[20:23], v9, s[16:19], s41 offen offset:128
    buffer_load_dwordx4 v[24:27], v9, s[16:19], s41 offen offset:256
    buffer_load_dwordx4 v[28:31], v9, s[20:23], s41 offen offset:0
    buffer_load_dwordx4 v[32:35], v9, s[20:23], s41 offen offset:128
    buffer_load_dwordx4 v[36:39], v9, s[20:23], s41 offen offset:256
    s_add_u32 s41, s41, 393216
    s_waitcnt vmcnt(6)
    s_barrier
    ds_write_b128 v10, v[44:47] offset:0
    ds_write_b128 v10, v[48:51] offset:128
    ds_write_b128 v10, v[52:55] offset:256
    ds_write_b128 v10, v[56:59] offset:384
    ds_write_b128 v10, v[60:63] offset:512
    ds_write_b128 v10, v[64:67] offset:640
    s_waitcnt lgkmcnt(0)
    s_barrier
    ds_read_b64_tr_b16 a[236:237], v13 offset:0
    ds_read_b64_tr_b16 a[238:239], v13 offset:3200
    ds_read_b64_tr_b16 v[40:41], v13 offset:32
    ds_read_b64_tr_b16 v[42:43], v13 offset:3232
    s_waitcnt lgkmcnt(0)
    ds_write_b128 v14, v[40:43] offset:19456
    ds_read_b64_tr_b16 a[240:241], v13 offset:64
    ds_read_b64_tr_b16 a[242:243], v13 offset:3264
    ds_read_b64_tr_b16 a[244:245], v13 offset:96
    ds_read_b64_tr_b16 a[246:247], v13 offset:3296
    ds_read_b64_tr_b16 a[248:249], v13 offset:128
    ds_read_b64_tr_b16 a[250:251], v13 offset:3328
    ds_read_b64_tr_b16 v[40:41], v13 offset:160
    ds_read_b64_tr_b16 v[42:43], v13 offset:3360
    s_waitcnt lgkmcnt(0)
    ds_write_b128 v14, v[40:43] offset:20480
    s_waitcnt lgkmcnt(0)
    buffer_load_dwordx4 v[44:47], v9, s[16:19], s41 offen offset:0
    buffer_load_dwordx4 v[48:51], v9, s[16:19], s41 offen offset:128
    buffer_load_dwordx4 v[52:55], v9, s[16:19], s41 offen offset:256
    buffer_load_dwordx4 v[56:59], v9, s[20:23], s41 offen offset:0
    buffer_load_dwordx4 v[60:63], v9, s[20:23], s41 offen offset:128
    buffer_load_dwordx4 v[64:67], v9, s[20:23], s41 offen offset:256
    s_add_u32 s41, s41, 393216
    s_waitcnt vmcnt(6)
    s_barrier
    ds_write_b128 v10, v[16:19] offset:0
    ds_write_b128 v10, v[20:23] offset:128
    ds_write_b128 v10, v[24:27] offset:256
    ds_write_b128 v10, v[28:31] offset:384
    ds_write_b128 v10, v[32:35] offset:512
    ds_write_b128 v10, v[36:39] offset:640
    s_waitcnt lgkmcnt(0)
    s_barrier
    ds_read_b64_tr_b16 a[252:253], v13 offset:0
    ds_read_b64_tr_b16 a[254:255], v13 offset:3200
    ds_read_b64_tr_b16 v[144:145], v13 offset:32
    ds_read_b64_tr_b16 v[146:147], v13 offset:3232
    ds_read_b64_tr_b16 v[148:149], v13 offset:64
    ds_read_b64_tr_b16 v[150:151], v13 offset:3264
    ds_read_b64_tr_b16 v[40:41], v13 offset:96
    ds_read_b64_tr_b16 v[42:43], v13 offset:3296
    s_waitcnt lgkmcnt(0)
    ds_write_b128 v14, v[40:43] offset:21504
    ds_read_b64_tr_b16 v[152:153], v13 offset:128
    ds_read_b64_tr_b16 v[154:155], v13 offset:3328
    ds_read_b64_tr_b16 v[156:157], v13 offset:160
    ds_read_b64_tr_b16 v[158:159], v13 offset:3360
    s_waitcnt lgkmcnt(0)
    buffer_load_dwordx4 v[16:19], v9, s[16:19], s41 offen offset:0
    buffer_load_dwordx4 v[20:23], v9, s[16:19], s41 offen offset:128
    buffer_load_dwordx4 v[24:27], v9, s[16:19], s41 offen offset:256
    buffer_load_dwordx4 v[28:31], v9, s[20:23], s41 offen offset:0
    buffer_load_dwordx4 v[32:35], v9, s[20:23], s41 offen offset:128
    buffer_load_dwordx4 v[36:39], v9, s[20:23], s41 offen offset:256
    s_add_u32 s41, s41, 393216
    s_waitcnt vmcnt(6)
    s_barrier
    ds_write_b128 v10, v[44:47] offset:0
    ds_write_b128 v10, v[48:51] offset:128
    ds_write_b128 v10, v[52:55] offset:256
    ds_write_b128 v10, v[56:59] offset:384
    ds_write_b128 v10, v[60:63] offset:512
    ds_write_b128 v10, v[64:67] offset:640
    s_waitcnt lgkmcnt(0)
    s_barrier
    ds_read_b64_tr_b16 v[160:161], v13 offset:0
    ds_read_b64_tr_b16 v[162:163], v13 offset:3200
    ds_read_b64_tr_b16 v[40:41], v13 offset:32
    ds_read_b64_tr_b16 v[42:43], v13 offset:3232
    s_waitcnt lgkmcnt(0)
    ds_write_b128 v14, v[40:43] offset:22528
    ds_read_b64_tr_b16 v[164:165], v13 offset:64
    ds_read_b64_tr_b16 v[166:167], v13 offset:3264
    ds_read_b64_tr_b16 v[168:169], v13 offset:96
    ds_read_b64_tr_b16 v[170:171], v13 offset:3296
    ds_read_b64_tr_b16 v[172:173], v13 offset:128
    ds_read_b64_tr_b16 v[174:175], v13 offset:3328
    ds_read_b64_tr_b16 v[40:41], v13 offset:160
    ds_read_b64_tr_b16 v[42:43], v13 offset:3360
    s_waitcnt lgkmcnt(0)
    ds_write_b128 v14, v[40:43] offset:23552
    s_waitcnt lgkmcnt(0)
    buffer_load_dwordx4 v[44:47], v9, s[16:19], s41 offen offset:0
    buffer_load_dwordx4 v[48:51], v9, s[16:19], s41 offen offset:128
    buffer_load_dwordx4 v[52:55], v9, s[16:19], s41 offen offset:256
    buffer_load_dwordx4 v[56:59], v9, s[20:23], s41 offen offset:0
    buffer_load_dwordx4 v[60:63], v9, s[20:23], s41 offen offset:128
    buffer_load_dwordx4 v[64:67], v9, s[20:23], s41 offen offset:256
    s_add_u32 s41, s41, 393216
    s_waitcnt vmcnt(6)
    s_barrier
    ds_write_b128 v10, v[16:19] offset:0
    ds_write_b128 v10, v[20:23] offset:128
    ds_write_b128 v10, v[24:27] offset:256
    ds_write_b128 v10, v[28:31] offset:384
    ds_write_b128 v10, v[32:35] offset:512
    ds_write_b128 v10, v[36:39] offset:640
    s_waitcnt lgkmcnt(0)
    s_barrier
    ds_read_b64_tr_b16 v[176:177], v13 offset:0
    ds_read_b64_tr_b16 v[178:179], v13 offset:3200
    ds_read_b64_tr_b16 v[180:181], v13 offset:32
    ds_read_b64_tr_b16 v[182:183], v13 offset:3232
    ds_read_b64_tr_b16 v[184:185], v13 offset:64
    ds_read_b64_tr_b16 v[186:187], v13 offset:3264
    ds_read_b64_tr_b16 v[40:41], v13 offset:96
    ds_read_b64_tr_b16 v[42:43], v13 offset:3296
    s_waitcnt lgkmcnt(0)
    ds_write_b128 v14, v[40:43] offset:24576
    ds_read_b64_tr_b16 v[188:189], v13 offset:128
    ds_read_b64_tr_b16 v[190:191], v13 offset:3328
    ds_read_b64_tr_b16 v[192:193], v13 offset:160
    ds_read_b64_tr_b16 v[194:195], v13 offset:3360
    s_waitcnt lgkmcnt(0)
    buffer_load_dwordx4 v[16:19], v9, s[16:19], s41 offen offset:0
    buffer_load_dwordx4 v[20:23], v9, s[16:19], s41 offen offset:128
    buffer_load_dwordx4 v[24:27], v9, s[16:19], s41 offen offset:256
    buffer_load_dwordx4 v[28:31], v9, s[20:23], s41 offen offset:0
    buffer_load_dwordx4 v[32:35], v9, s[20:23], s41 offen offset:128
    buffer_load_dwordx4 v[36:39], v9, s[20:23], s41 offen offset:256
    s_add_u32 s41, s41, 393216
    s_waitcnt vmcnt(6)
    s_barrier
    ds_write_b128 v10, v[44:47] offset:0
    ds_write_b128 v10, v[48:51] offset:128
    ds_write_b128 v10, v[52:55] offset:256
    ds_write_b128 v10, v[56:59] offset:384
    ds_write_b128 v10, v[60:63] offset:512
    ds_write_b128 v10, v[64:67] offset:640
    s_waitcnt lgkmcnt(0)
    s_barrier
    ds_read_b64_tr_b16 v[196:197], v13 offset:0
    ds_read_b64_tr_b16 v[198:199], v13 offset:3200
    ds_read_b64_tr_b16 v[40:41], v13 offset:32
    ds_read_b64_tr_b16 v[42:43], v13 offset:3232
    s_waitcnt lgkmcnt(0)
    ds_write_b128 v14, v[40:43] offset:25600
    ds_read_b64_tr_b16 v[200:201], v13 offset:64
    ds_read_b64_tr_b16 v[202:203], v13 offset:3264
    ds_read_b64_tr_b16 v[204:205], v13 offset:96
    ds_read_b64_tr_b16 v[206:207], v13 offset:3296
    ds_read_b64_tr_b16 v[208:209], v13 offset:128
    ds_read_b64_tr_b16 v[210:211], v13 offset:3328
    ds_read_b64_tr_b16 v[40:41], v13 offset:160
    ds_read_b64_tr_b16 v[42:43], v13 offset:3360
    s_waitcnt lgkmcnt(0)
    ds_write_b128 v14, v[40:43] offset:26624
    s_waitcnt lgkmcnt(0)
    buffer_load_dwordx4 v[44:47], v9, s[16:19], s41 offen offset:0
    buffer_load_dwordx4 v[48:51], v9, s[16:19], s41 offen offset:128
    buffer_load_dwordx4 v[52:55], v9, s[16:19], s41 offen offset:256
    buffer_load_dwordx4 v[56:59], v9, s[20:23], s41 offen offset:0
    buffer_load_dwordx4 v[60:63], v9, s[20:23], s41 offen offset:128
    buffer_load_dwordx4 v[64:67], v9, s[20:23], s41 offen offset:256
    s_add_u32 s41, s41, 393216
    s_waitcnt vmcnt(6)
    s_barrier
    ds_write_b128 v10, v[16:19] offset:0
    ds_write_b128 v10, v[20:23] offset:128
    ds_write_b128 v10, v[24:27] offset:256
    ds_write_b128 v10, v[28:31] offset:384
    ds_write_b128 v10, v[32:35] offset:512
    ds_write_b128 v10, v[36:39] offset:640
    s_waitcnt lgkmcnt(0)
    s_barrier
    ds_read_b64_tr_b16 v[212:213], v13 offset:0
    ds_read_b64_tr_b16 v[214:215], v13 offset:3200
    ds_read_b64_tr_b16 v[216:217], v13 offset:32
    ds_read_b64_tr_b16 v[218:219], v13 offset:3232
    ds_read_b64_tr_b16 v[220:221], v13 offset:64
    ds_read_b64_tr_b16 v[222:223], v13 offset:3264
    ds_read_b64_tr_b16 v[40:41], v13 offset:96
    ds_read_b64_tr_b16 v[42:43], v13 offset:3296
    s_waitcnt lgkmcnt(0)
    ds_write_b128 v14, v[40:43] offset:27648
    ds_read_b64_tr_b16 v[224:225], v13 offset:128
    ds_read_b64_tr_b16 v[226:227], v13 offset:3328
    ds_read_b64_tr_b16 v[228:229], v13 offset:160
    ds_read_b64_tr_b16 v[230:231], v13 offset:3360
    s_waitcnt lgkmcnt(0)
    s_waitcnt vmcnt(0)
    s_barrier
    ds_write_b128 v10, v[44:47] offset:0
    ds_write_b128 v10, v[48:51] offset:128
    ds_write_b128 v10, v[52:55] offset:256
    ds_write_b128 v10, v[56:59] offset:384
    ds_write_b128 v10, v[60:63] offset:512
    ds_write_b128 v10, v[64:67] offset:640
    s_waitcnt lgkmcnt(0)
    s_barrier
    ds_read_b64_tr_b16 v[232:233], v13 offset:0
    ds_read_b64_tr_b16 v[234:235], v13 offset:3200
    ds_read_b64_tr_b16 v[236:237], v13 offset:32
    ds_read_b64_tr_b16 v[238:239], v13 offset:3232
    ds_read_b64_tr_b16 v[240:241], v13 offset:64
    ds_read_b64_tr_b16 v[242:243], v13 offset:3264
    ds_read_b64_tr_b16 v[244:245], v13 offset:96
    ds_read_b64_tr_b16 v[246:247], v13 offset:3296
    ds_read_b64_tr_b16 v[248:249], v13 offset:128
    ds_read_b64_tr_b16 v[250:251], v13 offset:3328
    ds_read_b64_tr_b16 v[252:253], v13 offset:160
    ds_read_b64_tr_b16 v[254:255], v13 offset:3360
    s_waitcnt lgkmcnt(0)
    s_barrier
    v_lshrrev_b32 v12, 4, v1
    v_and_b32 v11, 7, v1
    v_lshlrev_b32 v7, 7, v12
    v_lshl_add_u32 v7, v11, 4, v7
    v_add_u32 v7, 0, v7
    v_mul_u32_u24 v8, 400, v11
    v_lshl_add_u32 v8, v12, 3, v8
    s_and_b32 s42, s38, 1
    s_mul_i32 s42, s42, 192
    s_lshr_b32 s43, s38, 1
    s_mul_i32 s43, s43, 3200
    s_add_u32 s42, s42, s43
    s_add_u32 s42, s42, 10240
    v_add_u32 v8, s42, v8
    v_mul_u32_u24 v9, 400, v11
    v_lshl_add_u32 v9, v12, 4, v9
    v_add_u32 v9, 10240, v9
    v_mul_u32_u24 v10, 12288, v11
    v_lshl_add_u32 v10, v12, 3, v10
    s_mul_i32 s42, s2, 384
    s_and_b32 s43, s38, 1
    s_mul_i32 s43, s43, 192
    s_add_u32 s42, s42, s43
    v_add_u32 v10, s42, v10
    v_and_b32 v13, 8, v1
    v_cmp_eq_u32 vcc, 0, v13
    v_mov_b32 v13, 0x7fffffff
    s_nop 1
    v_cndmask_b32 v10, v13, v10, vcc
    v_and_b32 v15, 15, v1
    v_mul_u32_u24 v11, 12288, v15
    v_lshl_add_u32 v11, v12, 4, v11
    s_mul_i32 s42, s2, 384
    v_add_u32 v11, s42, v11
    s_cmp_eq_u32 s38, 2
    s_cselect_b32 s42, 196608, 0
    v_add_u32 v11, s42, v11
    v_and_b32 v3, 7, v1
    v_mul_u32_u24 v3, 80, v3
    s_mov_b32 s42, 17152
    s_cmp_eq_u32 s38, 1
    s_cselect_b32 s43, 16, 0
    s_add_u32 s42, s42, s43
    s_cmp_eq_u32 s38, 2
    s_cselect_b32 s43, 48, 0
    s_add_u32 s42, s42, s43
    v_add_u32 v3, s42, v3
    v_lshl_add_u32 v3, v12, 3, v3
    s_cmp_eq_u32 s38, 0
    s_cselect_b32 s43, 0x28, 8
    v_and_b32 v116, s43, v1
    v_cmp_eq_u32 vcc, 0, v116
    v_mov_b32 v2, 17856
    s_nop 1
    v_cndmask_b32 v3, v2, v3, vcc
    v_lshlrev_b32 v96, 4, v1
    v_add_u32 v95, 17152, v96
    s_mul_i32 s42, s2, 640
    v_add_u32 v96, s42, v96
    v_cmp_gt_u32 vcc, 40, v1
    v_mov_b32 v2, 0x7fffffff
    s_nop 1
    v_cndmask_b32 v96, v2, v96, vcc
    s_cmp_eq_u32 s38, 0
    s_cselect_b32 s43, 32, 64
    v_cmp_gt_u32 vcc, s43, v1
    v_mov_b32 v2, 0xff800000
    s_nop 1
    v_cndmask_b32 v92, v2, 0, vcc
    v_and_b32 v94, 15, v1
    v_lshlrev_b32 v94, 3, v94
    v_add_u32 v94, 16640, v94
    s_lshl_b32 s43, s38, 7
    v_add_u32 v93, s43, v94
    s_mov_b32 s3, 0
    s_mov_b32 s41, 0
    s_mov_b32 s44, 0
    s_mov_b32 s45, 0
    s_mov_b32 s46, 0
    s_mov_b32 s52, 0
    s_cmp_eq_u32 s38, 0
    s_cbranch_scc1 qk_loop
    s_cmp_eq_u32 s38, 3
    s_cbranch_scc1 qk_loop
    s_and_b32 s53, s52, 7
    s_cmp_lg_u32 s53, 0
    s_cbranch_scc1 kxw_47
    s_cmp_ge_u32 s52, 64
    s_cbranch_scc1 kxw_47
    s_lshr_b32 s53, s52, 3
    s_add_u32 s53, s53, 8
    s_lshl_b32 s53, s53, 7
    s_mov_b32 s40, 0
wf_48:
    v_mov_b32 v122, 0
    buffer_load_dword v122, v122, s[56:59], s53 offen sc1
    s_waitcnt vmcnt(0)
    v_readfirstlane_b32 s39, v122
    s_nop 3
    s_cmp_ge_u32 s39, 32
    s_cbranch_scc1 wf_ok_49
    s_add_u32 s40, s40, 1
    s_cmp_lt_u32 s40, 2097152
    s_cbranch_scc1 wf_48
    s_branch chain_fail
wf_ok_49:
kxw_47:
    s_add_u32 s52, s52, 1
    buffer_load_dwordx4 v[68:71], v11, s[24:27], s44 offen offset:0 sc1
    buffer_load_dwordx4 v[72:75], v11, s[24:27], s44 offen offset:64 sc1
    buffer_load_dwordx4 v[76:79], v11, s[24:27], s44 offen offset:128 sc1
    buffer_load_dwordx4 v[80:83], v11, s[24:27], s44 offen offset:192 sc1
    buffer_load_dwordx4 v[84:87], v11, s[24:27], s44 offen offset:256 sc1
    buffer_load_dwordx4 v[88:91], v11, s[24:27], s44 offen offset:320 sc1
qk_loop:
    s_mov_b32 s40, 0
qk_poll_50:
    buffer_load_dwordx4 v[116:119], v4, s[8:11], s41 offen offset:0 sc1
    buffer_load_dwordx4 v[120:123], v6, s[8:11], s41 offen offset:0 sc1
    buffer_load_dwordx4 v[124:127], v5, s[8:11], s41 offen offset:0 sc1
    s_waitcnt vmcnt(0)
    v_max3_u32 v2, v116, v117, v118
    v_max3_u32 v2, v2, v119, v120
    v_max3_u32 v2, v2, v121, v122
    v_max3_u32 v2, v2, v123, v124
    v_max3_u32 v2, v2, v125, v126
    v_max_u32 v2, v2, v127
    v_cmp_eq_u32 vcc, -1, v2
    s_cbranch_vccz qk_ok_51
    s_add_u32 s40, s40, 1
    s_cmp_lt_u32 s40, 2097152
    s_cbranch_scc1 qk_poll_50
    s_branch chain_fail
qk_ok_51:
    ds_write_b128 v4, v[116:119] offset:0
    ds_write_b128 v6, v[120:123] offset:0
    ds_write_b128 v5, v[124:127] offset:0
    s_waitcnt lgkmcnt(0)
    s_barrier
    s_cmp_lg_u32 s38, 1
    s_cbranch_scc1 qk_cd_52
    s_cmp_eq_u32 s3, 0
    s_cbranch_scc1 qk_cd_52
    s_add_u32 s53, s3, 47
    s_lshl_b32 s53, s53, 7
    s_mov_b64 exec, 1
    v_mov_b32 v124, 1
    v_mov_b32 v125, 0
    buffer_atomic_add v124, v125, s[56:59], s53 offen sc1
    s_mov_b64 exec, -1
qk_cd_52:
    ds_read_b128 v[40:43], v7 offset:0
    ds_read_b128 v[44:47], v7 offset:512
    ds_read_b128 v[52:55], v14 offset:0
    ds_read_b128 v[56:59], v14 offset:1024
    ds_read_b128 v[60:63], v14 offset:2048
    ds_read_b128 v[48:51], v7 offset:1024
    s_waitcnt lgkmcnt(5)
    v_mfma_f32_16x16x32_bf16 v[16:19], a[0:3], v[40:43], 0
    v_mfma_f32_16x16x32_bf16 v[20:23], a[4:7], v[40:43], 0
    v_mfma_f32_16x16x32_bf16 v[24:27], a[8:11], v[40:43], 0
    s_waitcnt lgkmcnt(3)
    v_mfma_f32_16x16x32_bf16 v[28:31], v[52:55], v[40:43], 0
    ds_read_b128 v[64:67], v14 offset:3072
    v_mfma_f32_16x16x32_bf16 v[32:35], a[12:15], v[40:43], 0
    v_mfma_f32_16x16x32_bf16 v[36:39], a[16:19], v[40:43], 0
    ds_read_b128 v[40:43], v7 offset:1536
    v_mfma_f32_16x16x32_bf16 v[16:19], a[20:23], v[44:47], v[16:19]
    s_waitcnt lgkmcnt(4)
    v_mfma_f32_16x16x32_bf16 v[20:23], v[56:59], v[44:47], v[20:23]
    ds_read_b128 v[52:55], v14 offset:4096
    v_mfma_f32_16x16x32_bf16 v[24:27], a[24:27], v[44:47], v[24:27]
    v_mfma_f32_16x16x32_bf16 v[28:31], a[28:31], v[44:47], v[28:31]
    v_mfma_f32_16x16x32_bf16 v[32:35], a[32:35], v[44:47], v[32:35]
    s_waitcnt lgkmcnt(4)
    v_mfma_f32_16x16x32_bf16 v[36:39], v[60:63], v[44:47], v[36:39]
    ds_read_b128 v[56:59], v14 offset:5120
    ds_read_b128 v[44:47], v7 offset:2048
    s_waitcnt lgkmcnt(5)
    v_mfma_f32_16x16x32_bf16 v[16:19], a[36:39], v[48:51], v[16:19]
    v_mfma_f32_16x16x32_bf16 v[20:23], a[40:43], v[48:51], v[20:23]
    v_mfma_f32_16x16x32_bf16 v[24:27], a[44:47], v[48:51], v[24:27]
    s_waitcnt lgkmcnt(4)
    v_mfma_f32_16x16x32_bf16 v[28:31], v[64:67], v[48:51], v[28:31]
    ds_read_b128 v[60:63], v14 offset:6144
    v_mfma_f32_16x16x32_bf16 v[32:35], a[48:51], v[48:51], v[32:35]
    v_mfma_f32_16x16x32_bf16 v[36:39], a[52:55], v[48:51], v[36:39]
    ds_read_b128 v[48:51], v7 offset:2560
    s_waitcnt lgkmcnt(5)
    v_mfma_f32_16x16x32_bf16 v[16:19], a[56:59], v[40:43], v[16:19]
    s_waitcnt lgkmcnt(4)
    v_mfma_f32_16x16x32_bf16 v[20:23], v[52:55], v[40:43], v[20:23]
    ds_read_b128 v[64:67], v14 offset:7168
    v_mfma_f32_16x16x32_bf16 v[24:27], a[60:63], v[40:43], v[24:27]
    v_mfma_f32_16x16x32_bf16 v[28:31], a[64:67], v[40:43], v[28:31]
    v_mfma_f32_16x16x32_bf16 v[32:35], a[68:71], v[40:43], v[32:35]
    s_waitcnt lgkmcnt(4)
    v_mfma_f32_16x16x32_bf16 v[36:39], v[56:59], v[40:43], v[36:39]
    ds_read_b128 v[52:55], v14 offset:8192
    ds_read_b128 v[40:43], v7 offset:3072
    s_waitcnt lgkmcnt(5)
    v_mfma_f32_16x16x32_bf16 v[16:19], a[72:75], v[44:47], v[16:19]
    v_mfma_f32_16x16x32_bf16 v[20:23], a[76:79], v[44:47], v[20:23]
    v_mfma_f32_16x16x32_bf16 v[24:27], a[80:83], v[44:47], v[24:27]
    s_waitcnt lgkmcnt(4)
    v_mfma_f32_16x16x32_bf16 v[28:31], v[60:63], v[44:47], v[28:31]
    ds_read_b128 v[56:59], v14 offset:9216
    v_mfma_f32_16x16x32_bf16 v[32:35], a[84:87], v[44:47], v[32:35]
    v_mfma_f32_16x16x32_bf16 v[36:39], a[88:91], v[44:47], v[36:39]
    ds_read_b128 v[44:47], v7 offset:3584
    s_waitcnt lgkmcnt(5)
    v_mfma_f32_16x16x32_bf16 v[16:19], a[92:95], v[48:51], v[16:19]
    s_waitcnt lgkmcnt(4)
    v_mfma_f32_16x16x32_bf16 v[20:23], v[64:67], v[48:51], v[20:23]
    ds_read_b128 v[60:63], v14 offset:10240
    v_mfma_f32_16x16x32_bf16 v[24:27], a[96:99], v[48:51], v[24:27]
    v_mfma_f32_16x16x32_bf16 v[28:31], a[100:103], v[48:51], v[28:31]
    v_mfma_f32_16x16x32_bf16 v[32:35], a[104:107], v[48:51], v[32:35]
    s_waitcnt lgkmcnt(4)
    v_mfma_f32_16x16x32_bf16 v[36:39], v[52:55], v[48:51], v[36:39]
    ds_read_b128 v[64:67], v14 offset:11264
    ds_read_b128 v[48:51], v7 offset:4096
    s_waitcnt lgkmcnt(5)
    v_mfma_f32_16x16x32_bf16 v[16:19], a[108:111], v[40:43], v[16:19]
    v_mfma_f32_16x16x32_bf16 v[20:23], a[112:115], v[40:43], v[20:23]
    v_mfma_f32_16x16x32_bf16 v[24:27], a[116:119], v[40:43], v[24:27]
    s_waitcnt lgkmcnt(4)
    v_mfma_f32_16x16x32_bf16 v[28:31], v[56:59], v[40:43], v[28:31]
    ds_read_b128 v[52:55], v14 offset:12288
    v_mfma_f32_16x16x32_bf16 v[32:35], a[120:123], v[40:43], v[32:35]
    v_mfma_f32_16x16x32_bf16 v[36:39], a[124:127], v[40:43], v[36:39]
    ds_read_b128 v[40:43], v7 offset:4608
    s_waitcnt lgkmcnt(5)
    v_mfma_f32_16x16x32_bf16 v[16:19], a[128:131], v[44:47], v[16:19]
    s_waitcnt lgkmcnt(4)
    v_mfma_f32_16x16x32_bf16 v[20:23], v[60:63], v[44:47], v[20:23]
    ds_read_b128 v[56:59], v14 offset:13312
    v_mfma_f32_16x16x32_bf16 v[24:27], a[132:135], v[44:47], v[24:27]
    v_mfma_f32_16x16x32_bf16 v[28:31], a[136:139], v[44:47], v[28:31]
    v_mfma_f32_16x16x32_bf16 v[32:35], a[140:143], v[44:47], v[32:35]
    s_waitcnt lgkmcnt(4)
    v_mfma_f32_16x16x32_bf16 v[36:39], v[64:67], v[44:47], v[36:39]
    ds_read_b128 v[60:63], v14 offset:14336
    ds_read_b128 v[44:47], v7 offset:5120
    s_waitcnt lgkmcnt(5)
    v_mfma_f32_16x16x32_bf16 v[16:19], a[144:147], v[48:51], v[16:19]
    v_mfma_f32_16x16x32_bf16 v[20:23], a[148:151], v[48:51], v[20:23]
    v_mfma_f32_16x16x32_bf16 v[24:27], a[152:155], v[48:51], v[24:27]
    s_waitcnt lgkmcnt(4)
    v_mfma_f32_16x16x32_bf16 v[28:31], v[52:55], v[48:51], v[28:31]
    ds_read_b128 v[64:67], v14 offset:15360
    v_mfma_f32_16x16x32_bf16 v[32:35], a[156:159], v[48:51], v[32:35]
    v_mfma_f32_16x16x32_bf16 v[36:39], a[160:163], v[48:51], v[36:39]
    ds_read_b128 v[48:51], v7 offset:5632
    s_waitcnt lgkmcnt(5)
    v_mfma_f32_16x16x32_bf16 v[16:19], a[164:167], v[40:43], v[16:19]
    s_waitcnt lgkmcnt(4)
    v_mfma_f32_16x16x32_bf16 v[20:23], v[56:59], v[40:43], v[20:23]
    ds_read_b128 v[52:55], v14 offset:16384
    v_mfma_f32_16x16x32_bf16 v[24:27], a[168:171], v[40:43], v[24:27]
    v_mfma_f32_16x16x32_bf16 v[28:31], a[172:175], v[40:43], v[28:31]
    v_mfma_f32_16x16x32_bf16 v[32:35], a[176:179], v[40:43], v[32:35]
    s_waitcnt lgkmcnt(4)
    v_mfma_f32_16x16x32_bf16 v[36:39], v[60:63], v[40:43], v[36:39]
    ds_read_b128 v[56:59], v14 offset:17408
    ds_read_b128 v[40:43], v7 offset:6144
    s_waitcnt lgkmcnt(5)
    v_mfma_f32_16x16x32_bf16 v[16:19], a[180:183], v[44:47], v[16:19]
    v_mfma_f32_16x16x32_bf16 v[20:23], a[184:187], v[44:47], v[20:23]
    v_mfma_f32_16x16x32_bf16 v[24:27], a[188:191], v[44:47], v[24:27]
    s_waitcnt lgkmcnt(4)
    v_mfma_f32_16x16x32_bf16 v[28:31], v[64:67], v[44:47], v[28:31]
    ds_read_b128 v[60:63], v14 offset:18432
    v_mfma_f32_16x16x32_bf16 v[32:35], a[192:195], v[44:47], v[32:35]
    v_mfma_f32_16x16x32_bf16 v[36:39], a[196:199], v[44:47], v[36:39]
    ds_read_b128 v[44:47], v7 offset:6656
    s_waitcnt lgkmcnt(5)
    v_mfma_f32_16x16x32_bf16 v[16:19], a[200:203], v[48:51], v[16:19]
    s_waitcnt lgkmcnt(4)
    v_mfma_f32_16x16x32_bf16 v[20:23], v[52:55], v[48:51], v[20:23]
    ds_read_b128 v[64:67], v14 offset:19456
    v_mfma_f32_16x16x32_bf16 v[24:27], a[204:207], v[48:51], v[24:27]
    v_mfma_f32_16x16x32_bf16 v[28:31], a[208:211], v[48:51], v[28:31]
    v_mfma_f32_16x16x32_bf16 v[32:35], a[212:215], v[48:51], v[32:35]
    s_waitcnt lgkmcnt(4)
    v_mfma_f32_16x16x32_bf16 v[36:39], v[56:59], v[48:51], v[36:39]
    ds_read_b128 v[52:55], v14 offset:20480
    ds_read_b128 v[48:51], v7 offset:7168
    s_waitcnt lgkmcnt(5)
    v_mfma_f32_16x16x32_bf16 v[16:19], a[216:219], v[40:43], v[16:19]
    v_mfma_f32_16x16x32_bf16 v[20:23], a[220:223], v[40:43], v[20:23]
    v_mfma_f32_16x16x32_bf16 v[24:27], a[224:227], v[40:43], v[24:27]
    s_waitcnt lgkmcnt(4)
    v_mfma_f32_16x16x32_bf16 v[28:31], v[60:63], v[40:43], v[28:31]
    ds_read_b128 v[56:59], v14 offset:21504
    v_mfma_f32_16x16x32_bf16 v[32:35], a[228:231], v[40:43], v[32:35]
    v_mfma_f32_16x16x32_bf16 v[36:39], a[232:235], v[40:43], v[36:39]
    ds_read_b128 v[40:43], v7 offset:7680
    s_waitcnt lgkmcnt(5)
    v_mfma_f32_16x16x32_bf16 v[16:19], a[236:239], v[44:47], v[16:19]
    s_waitcnt lgkmcnt(4)
    v_mfma_f32_16x16x32_bf16 v[20:23], v[64:67], v[44:47], v[20:23]
    ds_read_b128 v[60:63], v14 offset:22528
    v_mfma_f32_16x16x32_bf16 v[24:27], a[240:243], v[44:47], v[24:27]
    v_mfma_f32_16x16x32_bf16 v[28:31], a[244:247], v[44:47], v[28:31]
    v_mfma_f32_16x16x32_bf16 v[32:35], a[248:251], v[44:47], v[32:35]
    s_waitcnt lgkmcnt(4)
    v_mfma_f32_16x16x32_bf16 v[36:39], v[52:55], v[44:47], v[36:39]
    ds_read_b128 v[64:67], v14 offset:23552
    ds_read_b128 v[44:47], v7 offset:8192
    s_waitcnt lgkmcnt(5)
    v_mfma_f32_16x16x32_bf16 v[16:19], a[252:255], v[48:51], v[16:19]
    v_mfma_f32_16x16x32_bf16 v[20:23], v[144:147], v[48:51], v[20:23]
    v_mfma_f32_16x16x32_bf16 v[24:27], v[148:151], v[48:51], v[24:27]
    s_waitcnt lgkmcnt(4)
    v_mfma_f32_16x16x32_bf16 v[28:31], v[56:59], v[48:51], v[28:31]
    ds_read_b128 v[52:55], v14 offset:24576
    v_mfma_f32_16x16x32_bf16 v[32:35], v[152:155], v[48:51], v[32:35]
    v_mfma_f32_16x16x32_bf16 v[36:39], v[156:159], v[48:51], v[36:39]
    ds_read_b128 v[48:51], v7 offset:8704
    s_waitcnt lgkmcnt(5)
    v_mfma_f32_16x16x32_bf16 v[16:19], v[160:163], v[40:43], v[16:19]
    s_waitcnt lgkmcnt(4)
    v_mfma_f32_16x16x32_bf16 v[20:23], v[60:63], v[40:43], v[20:23]
    ds_read_b128 v[56:59], v14 offset:25600
    v_mfma_f32_16x16x32_bf16 v[24:27], v[164:167], v[40:43], v[24:27]
    v_mfma_f32_16x16x32_bf16 v[28:31], v[168:171], v[40:43], v[28:31]
    v_mfma_f32_16x16x32_bf16 v[32:35], v[172:175], v[40:43], v[32:35]
    s_waitcnt lgkmcnt(4)
    v_mfma_f32_16x16x32_bf16 v[36:39], v[64:67], v[40:43], v[36:39]
    ds_read_b128 v[60:63], v14 offset:26624
    ds_read_b128 v[40:43], v7 offset:9216
    s_waitcnt lgkmcnt(5)
    v_mfma_f32_16x16x32_bf16 v[16:19], v[176:179], v[44:47], v[16:19]
    v_mfma_f32_16x16x32_bf16 v[20:23], v[180:183], v[44:47], v[20:23]
    v_mfma_f32_16x16x32_bf16 v[24:27], v[184:187], v[44:47], v[24:27]
    s_waitcnt lgkmcnt(4)
    v_mfma_f32_16x16x32_bf16 v[28:31], v[52:55], v[44:47], v[28:31]
    ds_read_b128 v[64:67], v14 offset:27648
    v_mfma_f32_16x16x32_bf16 v[32:35], v[188:191], v[44:47], v[32:35]
    v_mfma_f32_16x16x32_bf16 v[36:39], v[192:195], v[44:47], v[36:39]
    ds_read_b128 v[44:47], v7 offset:9728
    s_waitcnt lgkmcnt(5)
    v_mfma_f32_16x16x32_bf16 v[16:19], v[196:199], v[48:51], v[16:19]
    s_waitcnt lgkmcnt(4)
    v_mfma_f32_16x16x32_bf16 v[20:23], v[56:59], v[48:51], v[20:23]
    v_mfma_f32_16x16x32_bf16 v[24:27], v[200:203], v[48:51], v[24:27]
    v_mfma_f32_16x16x32_bf16 v[28:31], v[204:207], v[48:51], v[28:31]
    v_mfma_f32_16x16x32_bf16 v[32:35], v[208:211], v[48:51], v[32:35]
    s_waitcnt lgkmcnt(3)
    v_mfma_f32_16x16x32_bf16 v[36:39], v[60:63], v[48:51], v[36:39]
    s_waitcnt lgkmcnt(2)
    v_mfma_f32_16x16x32_bf16 v[16:19], v[212:215], v[40:43], v[16:19]
    v_mfma_f32_16x16x32_bf16 v[20:23], v[216:219], v[40:43], v[20:23]
    v_mfma_f32_16x16x32_bf16 v[24:27], v[220:223], v[40:43], v[24:27]
    s_waitcnt lgkmcnt(1)
    v_mfma_f32_16x16x32_bf16 v[28:31], v[64:67], v[40:43], v[28:31]
    v_mfma_f32_16x16x32_bf16 v[32:35], v[224:227], v[40:43], v[32:35]
    v_mfma_f32_16x16x32_bf16 v[36:39], v[228:231], v[40:43], v[36:39]
    s_waitcnt lgkmcnt(0)
    v_mfma_f32_16x16x32_bf16 v[16:19], v[232:235], v[44:47], v[16:19]
    v_mfma_f32_16x16x32_bf16 v[20:23], v[236:239], v[44:47], v[20:23]
    v_mfma_f32_16x16x32_bf16 v[24:27], v[240:243], v[44:47], v[24:27]
    v_mfma_f32_16x16x32_bf16 v[28:31], v[244:247], v[44:47], v[28:31]
    v_mfma_f32_16x16x32_bf16 v[32:35], v[248:251], v[44:47], v[32:35]
    v_mfma_f32_16x16x32_bf16 v[36:39], v[252:255], v[44:47], v[36:39]
    s_nop 7
    v_cvt_pk_bf16_f32 v116, v16, v17
    v_cvt_pk_bf16_f32 v117, v18, v19
    ds_write_b64 v8, v[116:117] offset:0
    v_cvt_pk_bf16_f32 v118, v20, v21
    v_cvt_pk_bf16_f32 v119, v22, v23
    ds_write_b64 v8, v[118:119] offset:32
    v_cvt_pk_bf16_f32 v120, v24, v25
    v_cvt_pk_bf16_f32 v121, v26, v27
    ds_write_b64 v8, v[120:121] offset:64
    v_cvt_pk_bf16_f32 v122, v28, v29
    v_cvt_pk_bf16_f32 v123, v30, v31
    ds_write_b64 v8, v[122:123] offset:96
    v_cvt_pk_bf16_f32 v124, v32, v33
    v_cvt_pk_bf16_f32 v125, v34, v35
    ds_write_b64 v8, v[124:125] offset:128
    v_cvt_pk_bf16_f32 v126, v36, v37
    v_cvt_pk_bf16_f32 v127, v38, v39
    ds_write_b64 v8, v[126:127] offset:160
    s_waitcnt lgkmcnt(0)
    s_barrier
    s_cmp_eq_u32 s38, 3
    s_cbranch_scc1 qk_w3
    ds_read_b128 v[28:31], v9 offset:0
    ds_read_b128 v[32:35], v9 offset:64
    ds_read_b128 v[36:39], v9 offset:128
    ds_read_b128 v[40:43], v9 offset:192
    ds_read_b128 v[44:47], v9 offset:256
    ds_read_b128 v[48:51], v9 offset:320
    s_cmp_lg_u32 s38, 0
    s_cbranch_scc1 qk_sx
    ds_read_b128 v[68:71], v9 offset:3200
    ds_read_b128 v[72:75], v9 offset:3264
    ds_read_b128 v[76:79], v9 offset:3328
    ds_read_b128 v[80:83], v9 offset:3392
    ds_read_b128 v[84:87], v9 offset:3456
    ds_read_b128 v[88:91], v9 offset:3520
qk_sx:
    s_waitcnt vmcnt(0) lgkmcnt(0)
    v_mfma_f32_16x16x32_bf16 v[16:19], v[68:71], v[28:31], 0
    v_mfma_f32_16x16x32_bf16 v[16:19], v[72:75], v[32:35], v[16:19]
    v_mfma_f32_16x16x32_bf16 v[16:19], v[76:79], v[36:39], v[16:19]
    v_mfma_f32_16x16x32_bf16 v[16:19], v[80:83], v[40:43], v[16:19]
    v_mfma_f32_16x16x32_bf16 v[16:19], v[84:87], v[44:47], v[16:19]
    v_mfma_f32_16x16x32_bf16 v[16:19], v[88:91], v[48:51], v[16:19]
    s_add_u32 s44, s44, 393216
    s_mov_b32 s42, 0x3d93cd3a
    s_nop 6
    v_cvt_pk_bf16_f32 v2, v16, v17
    v_lshlrev_b32 v16, 16, v2
    v_and_b32 v17, 0xffff0000, v2
    v_mul_f32 v16, s42, v16
    v_mul_f32 v17, s42, v17
    v_cvt_pk_bf16_f32 v2, v16, v17
    v_lshlrev_b32 v16, 16, v2
    v_and_b32 v17, 0xffff0000, v2
    v_cvt_pk_bf16_f32 v2, v18, v19
    v_lshlrev_b32 v18, 16, v2
    v_and_b32 v19, 0xffff0000, v2
    v_mul_f32 v18, s42, v18
    v_mul_f32 v19, s42, v19
    v_cvt_pk_bf16_f32 v2, v18, v19
    v_lshlrev_b32 v18, 16, v2
    v_and_b32 v19, 0xffff0000, v2
    v_add_f32 v16, v16, v92
    v_add_f32 v17, v17, v92
    v_add_f32 v18, v18, v92
    v_add_f32 v19, v19, v92
    v_max3_f32 v28, v16, v17, v18
    v_max_f32 v28, v28, v19
    v_mov_b32 v29, v28
    s_nop 1
    v_permlane32_swap_b32 v28, v29
    s_nop 1
    v_max_f32 v28, v28, v29
    v_mov_b32 v29, v28
    s_nop 1
    v_permlane16_swap_b32 v28, v29
    s_nop 1
    v_max_f32 v28, v28, v29
    s_mov_b32 s42, 0x3fb8aa3b
    v_sub_f32 v16, v16, v28
    v_sub_f32 v17, v17, v28
    v_sub_f32 v18, v18, v28
    v_sub_f32 v19, v19, v28
    v_mul_f32 v16, s42, v16
    v_mul_f32 v17, s42, v17
    v_mul_f32 v18, s42, v18
    v_mul_f32 v19, s42, v19
    v_exp_f32 v16, v16
    v_exp_f32 v17, v17
    v_exp_f32 v18, v18
    v_exp_f32 v19, v19
    s_nop 0
    v_add_f32 v30, v16, v17
    v_add_f32 v31, v18, v19
    v_add_f32 v29, v30, v31
    v_mov_b32 v30, v29
    s_nop 1
    v_permlane32_swap_b32 v29, v30
    s_nop 1
    v_add_f32 v29, v29, v30
    v_mov_b32 v30, v29
    s_nop 1
    v_permlane16_swap_b32 v29, v30
    s_nop 1
    v_add_f32 v29, v29, v30
    ds_write_b64 v93, v[28:29]
    s_waitcnt lgkmcnt(0)
    s_barrier
    ds_read_b64 v[32:33], v94 offset:0
    ds_read_b64 v[34:35], v94 offset:128
    ds_read_b64 v[36:37], v94 offset:256
    s_waitcnt lgkmcnt(0)
    v_max3_f32 v30, v32, v34, v36
    v_sub_f32 v32, v32, v30
    v_sub_f32 v34, v34, v30
    v_sub_f32 v36, v36, v30
    v_sub_f32 v28, v28, v30
    v_mul_f32 v32, s42, v32
    v_mul_f32 v34, s42, v34
    v_mul_f32 v36, s42, v36
    v_mul_f32 v28, s42, v28
    v_exp_f32 v32, v32
    v_exp_f32 v34, v34
    v_exp_f32 v36, v36
    v_exp_f32 v28, v28
    s_nop 0
    v_mul_f32 v31, v32, v33
    v_fmac_f32 v31, v34, v35
    v_fmac_f32 v31, v36, v37
    v_rcp_f32 v31, v31
    s_nop 0
    v_mul_f32 v31, v31, v28
    v_mul_f32 v16, v16, v31
    v_mul_f32 v17, v17, v31
    v_mul_f32 v18, v18, v31
    v_mul_f32 v19, v19, v31
    v_cvt_pk_bf16_f32 v32, v16, v17
    v_cvt_pk_bf16_f32 v33, v18, v19
    v_min_u32 v32, -2, v32
    v_min_u32 v33, -2, v33
    ds_write_b64 v3, v[32:33]
    s_waitcnt lgkmcnt(0)
    s_barrier
    s_cmp_lg_u32 s38, 0
    s_cbranch_scc1 qk_post
    ds_read_b128 v[32:35], v95
    s_waitcnt lgkmcnt(0)
    buffer_store_dwordx4 v[32:35], v96, s[12:15], s46 offen sc1
    s_branch qk_next
qk_w3:
    s_barrier
    s_barrier
qk_post:
    s_cmp_lt_u32 s38, 2
    s_cbranch_scc1 qk_nokm
    buffer_store_dwordx2 v[116:117], v10, s[28:31], s45 offen offset:0 sc1
    buffer_store_dwordx2 v[118:119], v10, s[28:31], s45 offen offset:32 sc1
    buffer_store_dwordx2 v[120:121], v10, s[28:31], s45 offen offset:64 sc1
    buffer_store_dwordx2 v[122:123], v10, s[28:31], s45 offen offset:96 sc1
    buffer_store_dwordx2 v[124:125], v10, s[28:31], s45 offen offset:128 sc1
    buffer_store_dwordx2 v[126:127], v10, s[28:31], s45 offen offset:160 sc1
qk_nokm:
    s_cmp_eq_u32 s38, 3
    s_cbranch_scc1 qk_next
    s_and_b32 s53, s52, 7
    s_cmp_lg_u32 s53, 0
    s_cbranch_scc1 kxw_53
    s_cmp_ge_u32 s52, 64
    s_cbranch_scc1 kxw_53
    s_lshr_b32 s53, s52, 3
    s_add_u32 s53, s53, 8
    s_lshl_b32 s53, s53, 7
    s_mov_b32 s40, 0
wf_54:
    v_mov_b32 v122, 0
    buffer_load_dword v122, v122, s[56:59], s53 offen sc1
    s_waitcnt vmcnt(0)
    v_readfirstlane_b32 s39, v122
    s_nop 3
    s_cmp_ge_u32 s39, 32
    s_cbranch_scc1 wf_ok_55
    s_add_u32 s40, s40, 1
    s_cmp_lt_u32 s40, 2097152
    s_cbranch_scc1 wf_54
    s_branch chain_fail
wf_ok_55:
kxw_53:
    s_add_u32 s52, s52, 1
    buffer_load_dwordx4 v[68:71], v11, s[24:27], s44 offen offset:0 sc1
    buffer_load_dwordx4 v[72:75], v11, s[24:27], s44 offen offset:64 sc1
    buffer_load_dwordx4 v[76:79], v11, s[24:27], s44 offen offset:128 sc1
    buffer_load_dwordx4 v[80:83], v11, s[24:27], s44 offen offset:192 sc1
    buffer_load_dwordx4 v[84:87], v11, s[24:27], s44 offen offset:256 sc1
    buffer_load_dwordx4 v[88:91], v11, s[24:27], s44 offen offset:320 sc1
qk_next:
    s_add_u32 s3, s3, 1
    s_add_u32 s41, s41, 10240
    s_add_u32 s45, s45, 98304
    s_add_u32 s46, s46, 20480
    s_cmp_lt_u32 s3, 64
    s_cbranch_scc1 qk_loop
    s_waitcnt vmcnt(0)
    s_barrier
    s_cmp_lg_u32 s38, 1
    s_cbranch_scc1 chain_end
    s_mov_b32 s53, 14208
    s_mov_b64 exec, 1
    v_mov_b32 v124, 1
    v_mov_b32 v125, 0
    buffer_atomic_add v124, v125, s[56:59], s53 offen sc1
    s_mov_b64 exec, -1
    s_endpgm
o_role:
    s_sub_u32 s2, s2, 32
    s_add_u32 s16, s4, 78118912
    s_addc_u32 s17, s5, 0
    s_mov_b32 s18, 26214400
    s_mov_b32 s19, 0x00020000
    s_add_u32 s20, s4, 104333312
    s_addc_u32 s21, s5, 0
    s_mov_b32 s22, 83886080
    s_mov_b32 s23, 0x00020000
    s_add_u32 s24, s4, 202780672
    s_addc_u32 s25, s5, 0
    s_mov_b32 s26, 20971520
    s_mov_b32 s27, 0x00020000
    v_and_b32 v11, 15, v1
    v_lshrrev_b32 v12, 4, v1
    v_and_b32 v13, 7, v1
    v_lshrrev_b32 v14, 3, v11
    v_mul_u32_u24 v14, 640, v14
    v_add_u32 v14, v14, v13
    s_mul_i32 s42, s38, 5120
    s_lshl_b32 s43, s2, 3
    s_add_u32 s42, s42, s43
    v_add_u32 v14, s42, v14
    v_mul_u32_u24 v14, 1280, v14
    v_lshl_add_u32 v14, v12, 4, v14
    s_mov_b32 s53, 256
    s_mov_b32 s40, 0
wf_56:
    v_mov_b32 v124, 0
    buffer_load_dword v124, v124, s[56:59], s53 offen sc1
    s_waitcnt vmcnt(0)
    v_readfirstlane_b32 s39, v124
    s_nop 3
    s_cmp_ge_u32 s39, 96
    s_cbranch_scc1 wf_ok_57
    s_sleep 4
    s_add_u32 s40, s40, 1
    s_cmp_lt_u32 s40, 2097152
    s_cbranch_scc1 wf_56
    s_branch chain_fail
wf_ok_57:
    s_lshl_b32 s42, s2, 2
    s_add_u32 s42, s42, s38
    s_mul_i32 s42, s42, 81920
    v_lshlrev_b32 v14, 4, v1
    buffer_load_dwordx4 a[0:3], v14, s[16:19], s42 offen offset:0 sc1
    buffer_load_dwordx4 a[4:7], v14, s[16:19], s42 offen offset:1024 sc1
    buffer_load_dwordx4 a[8:11], v14, s[16:19], s42 offen offset:2048 sc1
    buffer_load_dwordx4 a[12:15], v14, s[16:19], s42 offen offset:3072 sc1
    s_add_u32 s42, s42, 4096
    buffer_load_dwordx4 a[16:19], v14, s[16:19], s42 offen offset:0 sc1
    buffer_load_dwordx4 a[20:23], v14, s[16:19], s42 offen offset:1024 sc1
    buffer_load_dwordx4 a[24:27], v14, s[16:19], s42 offen offset:2048 sc1
    buffer_load_dwordx4 a[28:31], v14, s[16:19], s42 offen offset:3072 sc1
    s_add_u32 s42, s42, 4096
    buffer_load_dwordx4 a[32:35], v14, s[16:19], s42 offen offset:0 sc1
    buffer_load_dwordx4 a[36:39], v14, s[16:19], s42 offen offset:1024 sc1
    buffer_load_dwordx4 a[40:43], v14, s[16:19], s42 offen offset:2048 sc1
    buffer_load_dwordx4 a[44:47], v14, s[16:19], s42 offen offset:3072 sc1
    s_add_u32 s42, s42, 4096
    buffer_load_dwordx4 a[48:51], v14, s[16:19], s42 offen offset:0 sc1
    buffer_load_dwordx4 a[52:55], v14, s[16:19], s42 offen offset:1024 sc1
    buffer_load_dwordx4 a[56:59], v14, s[16:19], s42 offen offset:2048 sc1
    buffer_load_dwordx4 a[60:63], v14, s[16:19], s42 offen offset:3072 sc1
    s_add_u32 s42, s42, 4096
    buffer_load_dwordx4 a[64:67], v14, s[16:19], s42 offen offset:0 sc1
    buffer_load_dwordx4 a[68:71], v14, s[16:19], s42 offen offset:1024 sc1
    buffer_load_dwordx4 a[72:75], v14, s[16:19], s42 offen offset:2048 sc1
    buffer_load_dwordx4 a[76:79], v14, s[16:19], s42 offen offset:3072 sc1
    s_add_u32 s42, s42, 4096
    buffer_load_dwordx4 a[80:83], v14, s[16:19], s42 offen offset:0 sc1
    buffer_load_dwordx4 a[84:87], v14, s[16:19], s42 offen offset:1024 sc1
    buffer_load_dwordx4 a[88:91], v14, s[16:19], s42 offen offset:2048 sc1
    buffer_load_dwordx4 a[92:95], v14, s[16:19], s42 offen offset:3072 sc1
    s_add_u32 s42, s42, 4096
    buffer_load_dwordx4 a[96:99], v14, s[16:19], s42 offen offset:0 sc1
    buffer_load_dwordx4 a[100:103], v14, s[16:19], s42 offen offset:1024 sc1
    buffer_load_dwordx4 a[104:107], v14, s[16:19], s42 offen offset:2048 sc1
    buffer_load_dwordx4 a[108:111], v14, s[16:19], s42 offen offset:3072 sc1
    s_add_u32 s42, s42, 4096
    buffer_load_dwordx4 a[112:115], v14, s[16:19], s42 offen offset:0 sc1
    buffer_load_dwordx4 a[116:119], v14, s[16:19], s42 offen offset:1024 sc1
    buffer_load_dwordx4 a[120:123], v14, s[16:19], s42 offen offset:2048 sc1
    buffer_load_dwordx4 a[124:127], v14, s[16:19], s42 offen offset:3072 sc1
    s_add_u32 s42, s42, 4096
    buffer_load_dwordx4 a[128:131], v14, s[16:19], s42 offen offset:0 sc1
    buffer_load_dwordx4 a[132:135], v14, s[16:19], s42 offen offset:1024 sc1
    buffer_load_dwordx4 a[136:139], v14, s[16:19], s42 offen offset:2048 sc1
    buffer_load_dwordx4 a[140:143], v14, s[16:19], s42 offen offset:3072 sc1
    s_add_u32 s42, s42, 4096
    buffer_load_dwordx4 a[144:147], v14, s[16:19], s42 offen offset:0 sc1
    buffer_load_dwordx4 a[148:151], v14, s[16:19], s42 offen offset:1024 sc1
    buffer_load_dwordx4 a[152:155], v14, s[16:19], s42 offen offset:2048 sc1
    buffer_load_dwordx4 a[156:159], v14, s[16:19], s42 offen offset:3072 sc1
    s_add_u32 s42, s42, 4096
    buffer_load_dwordx4 a[160:163], v14, s[16:19], s42 offen offset:0 sc1
    buffer_load_dwordx4 a[164:167], v14, s[16:19], s42 offen offset:1024 sc1
    buffer_load_dwordx4 a[168:171], v14, s[16:19], s42 offen offset:2048 sc1
    buffer_load_dwordx4 a[172:175], v14, s[16:19], s42 offen offset:3072 sc1
    s_add_u32 s42, s42, 4096
    buffer_load_dwordx4 a[176:179], v14, s[16:19], s42 offen offset:0 sc1
    buffer_load_dwordx4 a[180:183], v14, s[16:19], s42 offen offset:1024 sc1
    buffer_load_dwordx4 a[184:187], v14, s[16:19], s42 offen offset:2048 sc1
    buffer_load_dwordx4 a[188:191], v14, s[16:19], s42 offen offset:3072 sc1
    s_add_u32 s42, s42, 4096
    buffer_load_dwordx4 a[192:195], v14, s[16:19], s42 offen offset:0 sc1
    buffer_load_dwordx4 a[196:199], v14, s[16:19], s42 offen offset:1024 sc1
    buffer_load_dwordx4 a[200:203], v14, s[16:19], s42 offen offset:2048 sc1
    buffer_load_dwordx4 a[204:207], v14, s[16:19], s42 offen offset:3072 sc1
    s_add_u32 s42, s42, 4096
    buffer_load_dwordx4 a[208:211], v14, s[16:19], s42 offen offset:0 sc1
    buffer_load_dwordx4 a[212:215], v14, s[16:19], s42 offen offset:1024 sc1
    buffer_load_dwordx4 a[216:219], v14, s[16:19], s42 offen offset:2048 sc1
    buffer_load_dwordx4 a[220:223], v14, s[16:19], s42 offen offset:3072 sc1
    s_add_u32 s42, s42, 4096
    buffer_load_dwordx4 a[224:227], v14, s[16:19], s42 offen offset:0 sc1
    buffer_load_dwordx4 a[228:231], v14, s[16:19], s42 offen offset:1024 sc1
    buffer_load_dwordx4 a[232:235], v14, s[16:19], s42 offen offset:2048 sc1
    buffer_load_dwordx4 a[236:239], v14, s[16:19], s42 offen offset:3072 sc1
    s_add_u32 s42, s42, 4096
    buffer_load_dwordx4 a[240:243], v14, s[16:19], s42 offen offset:0 sc1
    buffer_load_dwordx4 a[244:247], v14, s[16:19], s42 offen offset:1024 sc1
    buffer_load_dwordx4 a[248:251], v14, s[16:19], s42 offen offset:2048 sc1
    buffer_load_dwordx4 a[252:255], v14, s[16:19], s42 offen offset:3072 sc1
    s_add_u32 s42, s42, 4096
    buffer_load_dwordx4 v[192:195], v14, s[16:19], s42 offen offset:0 sc1
    buffer_load_dwordx4 v[196:199], v14, s[16:19], s42 offen offset:1024 sc1
    buffer_load_dwordx4 v[200:203], v14, s[16:19], s42 offen offset:2048 sc1
    buffer_load_dwordx4 v[204:207], v14, s[16:19], s42 offen offset:3072 sc1
    s_add_u32 s42, s42, 4096
    buffer_load_dwordx4 v[208:211], v14, s[16:19], s42 offen offset:0 sc1
    buffer_load_dwordx4 v[212:215], v14, s[16:19], s42 offen offset:1024 sc1
    buffer_load_dwordx4 v[216:219], v14, s[16:19], s42 offen offset:2048 sc1
    buffer_load_dwordx4 v[220:223], v14, s[16:19], s42 offen offset:3072 sc1
    s_add_u32 s42, s42, 4096
    buffer_load_dwordx4 v[224:227], v14, s[16:19], s42 offen offset:0 sc1
    buffer_load_dwordx4 v[228:231], v14, s[16:19], s42 offen offset:1024 sc1
    buffer_load_dwordx4 v[232:235], v14, s[16:19], s42 offen offset:2048 sc1
    buffer_load_dwordx4 v[236:239], v14, s[16:19], s42 offen offset:3072 sc1
    s_add_u32 s42, s42, 4096
    buffer_load_dwordx4 v[240:243], v14, s[16:19], s42 offen offset:0 sc1
    buffer_load_dwordx4 v[244:247], v14, s[16:19], s42 offen offset:1024 sc1
    buffer_load_dwordx4 v[248:251], v14, s[16:19], s42 offen offset:2048 sc1
    buffer_load_dwordx4 v[252:255], v14, s[16:19], s42 offen offset:3072 sc1
    v_lshlrev_b32 v7, 7, v12
    v_lshl_add_u32 v7, v13, 4, v7
    v_add_u32 v7, 0, v7
    v_lshlrev_b32 v8, 4, v11
    v_lshl_add_u32 v8, v12, 3, v8
    s_lshl_b32 s42, s38, 10
    s_add_u32 s42, s42, 30720
    v_add_u32 v8, s42, v8
    v_cmp_gt_u32 vcc, 32, v1
    v_mov_b32 v2, 35840
    s_nop 1
    v_cndmask_b32 v8, v2, v8, vcc
    v_lshl_add_u32 v9, v12, 3, v13
    v_lshlrev_b32 v9, 4, v9
    v_add_u32 v9, s42, v9
    v_mul_u32_u24 v10, 640, v12
    v_add_u32 v10, v10, v13
    s_mul_i32 s42, s38, 5120
    s_lshl_b32 s43, s2, 3
    s_add_u32 s42, s42, s43
    v_add_u32 v10, s42, v10
    v_lshlrev_b32 v10, 4, v10
    v_and_b32 v2, 8, v1
    v_cmp_eq_u32 vcc, 0, v2
    v_mov_b32 v2, 0x7fffffff
    s_nop 1
    v_cndmask_b32 v10, v2, v10, vcc
    v_add_u32 v14, s42, v13
    v_lshlrev_b32 v14, 6, v14
    v_lshl_add_u32 v14, v12, 4, v14
    v_mul_u32_u24 v3, 80, v13
    s_mul_i32 s42, s38, 5120
    v_add_u32 v3, s42, v3
    v_lshl_add_u32 v15, v12, 4, v3
    v_add_u32 v15, 16, v15
    v_mul_u32_u24 v2, 640, v12
    v_add_u32 v3, v2, v3
    v_lshlrev_b32 v160, 7, v12
    v_lshl_add_u32 v160, v13, 2, v160
    s_lshl_b32 s42, s38, 8
    s_add_u32 s42, s42, 34816
    v_add_u32 v160, s42, v160
    v_and_b32 v2, 0x28, v1
    v_cmp_eq_u32 vcc, 0, v2
    v_mov_b32 v2, 35840
    s_nop 1
    v_cndmask_b32 v160, v2, v160, vcc
    v_lshlrev_b32 v161, 3, v1
    v_and_b32 v161, 0xff, v161
    v_add_u32 v161, 34816, v161
    v_lshlrev_b32 v162, 2, v1
    s_lshl_b32 s42, s2, 7
    v_add_u32 v162, s42, v162
    v_cmp_gt_u32 vcc, 32, v1
    v_mov_b32 v2, 0x7fffffff
    s_nop 1
    v_cndmask_b32 v162, v2, v162, vcc
    v_add_u32 v164, 2560, v15
    s_mov_b32 s3, 0
    s_mov_b32 s41, 0
    s_mov_b32 s44, 0
    s_mov_b32 s45, 0
    s_mov_b32 s46, 0
    s_mov_b32 s47, 10240
    s_mov_b32 s52, 0
    s_and_b32 s53, s52, 7
    s_cmp_lg_u32 s53, 0
    s_cbranch_scc1 uxw_58
    s_cmp_ge_u32 s52, 64
    s_cbranch_scc1 uxw_58
    s_lshr_b32 s53, s52, 3
    s_add_u32 s53, s53, 16
    s_lshl_b32 s53, s53, 7
    s_mov_b32 s40, 0
wf_59:
    v_mov_b32 v124, 0
    buffer_load_dword v124, v124, s[56:59], s53 offen sc1
    s_waitcnt vmcnt(0)
    v_readfirstlane_b32 s39, v124
    s_nop 3
    s_cmp_ge_u32 s39, 160
    s_cbranch_scc1 wf_ok_60
    s_add_u32 s40, s40, 1
    s_cmp_lt_u32 s40, 2097152
    s_cbranch_scc1 wf_59
    s_branch chain_fail
wf_ok_60:
uxw_58:
    s_add_u32 s52, s52, 1
    buffer_load_dwordx4 v[72:75], v14, s[20:23], s44 offen sc1
    v_add_u32 v2, 40960, v14
    buffer_load_dwordx4 v[76:79], v2, s[20:23], s44 offen sc1
    v_add_u32 v2, 81920, v14
    buffer_load_dwordx4 v[80:83], v2, s[20:23], s44 offen sc1
    v_add_u32 v2, 122880, v14
    buffer_load_dwordx4 v[84:87], v2, s[20:23], s44 offen sc1
    v_add_u32 v2, 163840, v14
    buffer_load_dwordx4 v[88:91], v2, s[20:23], s44 offen sc1
    v_add_u32 v2, 204800, v14
    buffer_load_dwordx4 v[92:95], v2, s[20:23], s44 offen sc1
    v_add_u32 v2, 245760, v14
    buffer_load_dwordx4 v[96:99], v2, s[20:23], s44 offen sc1
    v_add_u32 v2, 286720, v14
    buffer_load_dwordx4 v[100:103], v2, s[20:23], s44 offen sc1
    s_waitcnt vmcnt(0)
o_loop:
    s_mov_b32 s40, 0
om_poll_61:
    buffer_load_dwordx4 v[52:55], v4, s[8:11], s41 offen offset:0 sc1
    buffer_load_dwordx4 v[56:59], v6, s[8:11], s41 offen offset:0 sc1
    buffer_load_dwordx4 v[60:63], v5, s[8:11], s41 offen offset:0 sc1
    s_waitcnt vmcnt(0)
    v_max3_u32 v2, v52, v53, v54
    v_max3_u32 v2, v2, v55, v56
    v_max3_u32 v2, v2, v57, v58
    v_max3_u32 v2, v2, v59, v60
    v_max3_u32 v2, v2, v61, v62
    v_max_u32 v2, v2, v63
    v_cmp_eq_u32 vcc, -1, v2
    s_cbranch_vccz om_ok_62
    s_add_u32 s40, s40, 1
    s_cmp_lt_u32 s40, 2097152
    s_cbranch_scc1 om_poll_61
    s_branch chain_fail
om_ok_62:
    ds_write_b128 v4, v[52:55] offset:0
    ds_write_b128 v6, v[56:59] offset:0
    ds_write_b128 v5, v[60:63] offset:0
    s_waitcnt lgkmcnt(0)
    s_barrier
    s_cmp_lg_u32 s38, 1
    s_cbranch_scc1 o_cd_63
    s_cmp_eq_u32 s3, 0
    s_cbranch_scc1 o_cd_63
    s_add_u32 s53, s3, 47
    s_lshl_b32 s53, s53, 7
    s_mov_b64 exec, 1
    v_mov_b32 v124, 1
    v_mov_b32 v125, 0
    buffer_atomic_add v124, v125, s[56:59], s53 offen sc1
    s_mov_b64 exec, -1
o_cd_63:
    ds_read_b128 v[40:43], v7 offset:0
    ds_read_b128 v[44:47], v7 offset:512
    ds_read_b128 v[48:51], v7 offset:1024
    s_waitcnt lgkmcnt(2)
    v_mfma_f32_16x16x32_bf16 v[16:19], v[40:43], a[0:3], 0
    v_mfma_f32_16x16x32_bf16 v[20:23], v[40:43], a[4:7], 0
    v_mfma_f32_16x16x32_bf16 v[24:27], v[40:43], a[8:11], 0
    v_mfma_f32_16x16x32_bf16 v[28:31], v[40:43], a[12:15], 0
    ds_read_b128 v[40:43], v7 offset:1536
    s_waitcnt lgkmcnt(2)
    v_mfma_f32_16x16x32_bf16 v[16:19], v[44:47], a[16:19], v[16:19]
    v_mfma_f32_16x16x32_bf16 v[20:23], v[44:47], a[20:23], v[20:23]
    v_mfma_f32_16x16x32_bf16 v[24:27], v[44:47], a[24:27], v[24:27]
    v_mfma_f32_16x16x32_bf16 v[28:31], v[44:47], a[28:31], v[28:31]
    ds_read_b128 v[44:47], v7 offset:2048
    s_waitcnt lgkmcnt(2)
    v_mfma_f32_16x16x32_bf16 v[16:19], v[48:51], a[32:35], v[16:19]
    v_mfma_f32_16x16x32_bf16 v[20:23], v[48:51], a[36:39], v[20:23]
    v_mfma_f32_16x16x32_bf16 v[24:27], v[48:51], a[40:43], v[24:27]
    v_mfma_f32_16x16x32_bf16 v[28:31], v[48:51], a[44:47], v[28:31]
    ds_read_b128 v[48:51], v7 offset:2560
    s_waitcnt lgkmcnt(2)
    v_mfma_f32_16x16x32_bf16 v[16:19], v[40:43], a[48:51], v[16:19]
    v_mfma_f32_16x16x32_bf16 v[20:23], v[40:43], a[52:55], v[20:23]
    v_mfma_f32_16x16x32_bf16 v[24:27], v[40:43], a[56:59], v[24:27]
    v_mfma_f32_16x16x32_bf16 v[28:31], v[40:43], a[60:63], v[28:31]
    ds_read_b128 v[40:43], v7 offset:3072
    s_waitcnt lgkmcnt(2)
    v_mfma_f32_16x16x32_bf16 v[16:19], v[44:47], a[64:67], v[16:19]
    v_mfma_f32_16x16x32_bf16 v[20:23], v[44:47], a[68:71], v[20:23]
    v_mfma_f32_16x16x32_bf16 v[24:27], v[44:47], a[72:75], v[24:27]
    v_mfma_f32_16x16x32_bf16 v[28:31], v[44:47], a[76:79], v[28:31]
    ds_read_b128 v[44:47], v7 offset:3584
    s_waitcnt lgkmcnt(2)
    v_mfma_f32_16x16x32_bf16 v[16:19], v[48:51], a[80:83], v[16:19]
    v_mfma_f32_16x16x32_bf16 v[20:23], v[48:51], a[84:87], v[20:23]
    v_mfma_f32_16x16x32_bf16 v[24:27], v[48:51], a[88:91], v[24:27]
    v_mfma_f32_16x16x32_bf16 v[28:31], v[48:51], a[92:95], v[28:31]
    ds_read_b128 v[48:51], v7 offset:4096
    s_waitcnt lgkmcnt(2)
    v_mfma_f32_16x16x32_bf16 v[16:19], v[40:43], a[96:99], v[16:19]
    v_mfma_f32_16x16x32_bf16 v[20:23], v[40:43], a[100:103], v[20:23]
    v_mfma_f32_16x16x32_bf16 v[24:27], v[40:43], a[104:107], v[24:27]
    v_mfma_f32_16x16x32_bf16 v[28:31], v[40:43], a[108:111], v[28:31]
    ds_read_b128 v[40:43], v7 offset:4608
    s_waitcnt lgkmcnt(2)
    v_mfma_f32_16x16x32_bf16 v[16:19], v[44:47], a[112:115], v[16:19]
    v_mfma_f32_16x16x32_bf16 v[20:23], v[44:47], a[116:119], v[20:23]
    v_mfma_f32_16x16x32_bf16 v[24:27], v[44:47], a[120:123], v[24:27]
    v_mfma_f32_16x16x32_bf16 v[28:31], v[44:47], a[124:127], v[28:31]
    ds_read_b128 v[44:47], v7 offset:5120
    s_waitcnt lgkmcnt(2)
    v_mfma_f32_16x16x32_bf16 v[16:19], v[48:51], a[128:131], v[16:19]
    v_mfma_f32_16x16x32_bf16 v[20:23], v[48:51], a[132:135], v[20:23]
    v_mfma_f32_16x16x32_bf16 v[24:27], v[48:51], a[136:139], v[24:27]
    v_mfma_f32_16x16x32_bf16 v[28:31], v[48:51], a[140:143], v[28:31]
    ds_read_b128 v[48:51], v7 offset:5632
    s_waitcnt lgkmcnt(2)
    v_mfma_f32_16x16x32_bf16 v[16:19], v[40:43], a[144:147], v[16:19]
    v_mfma_f32_16x16x32_bf16 v[20:23], v[40:43], a[148:151], v[20:23]
    v_mfma_f32_16x16x32_bf16 v[24:27], v[40:43], a[152:155], v[24:27]
    v_mfma_f32_16x16x32_bf16 v[28:31], v[40:43], a[156:159], v[28:31]
    ds_read_b128 v[40:43], v7 offset:6144
    s_waitcnt lgkmcnt(2)
    v_mfma_f32_16x16x32_bf16 v[16:19], v[44:47], a[160:163], v[16:19]
    v_mfma_f32_16x16x32_bf16 v[20:23], v[44:47], a[164:167], v[20:23]
    v_mfma_f32_16x16x32_bf16 v[24:27], v[44:47], a[168:171], v[24:27]
    v_mfma_f32_16x16x32_bf16 v[28:31], v[44:47], a[172:175], v[28:31]
    ds_read_b128 v[44:47], v7 offset:6656
    s_waitcnt lgkmcnt(2)
    v_mfma_f32_16x16x32_bf16 v[16:19], v[48:51], a[176:179], v[16:19]
    v_mfma_f32_16x16x32_bf16 v[20:23], v[48:51], a[180:183], v[20:23]
    v_mfma_f32_16x16x32_bf16 v[24:27], v[48:51], a[184:187], v[24:27]
    v_mfma_f32_16x16x32_bf16 v[28:31], v[48:51], a[188:191], v[28:31]
    ds_read_b128 v[48:51], v7 offset:7168
    s_waitcnt lgkmcnt(2)
    v_mfma_f32_16x16x32_bf16 v[16:19], v[40:43], a[192:195], v[16:19]
    v_mfma_f32_16x16x32_bf16 v[20:23], v[40:43], a[196:199], v[20:23]
    v_mfma_f32_16x16x32_bf16 v[24:27], v[40:43], a[200:203], v[24:27]
    v_mfma_f32_16x16x32_bf16 v[28:31], v[40:43], a[204:207], v[28:31]
    ds_read_b128 v[40:43], v7 offset:7680
    s_waitcnt lgkmcnt(2)
    v_mfma_f32_16x16x32_bf16 v[16:19], v[44:47], a[208:211], v[16:19]
    v_mfma_f32_16x16x32_bf16 v[20:23], v[44:47], a[212:215], v[20:23]
    v_mfma_f32_16x16x32_bf16 v[24:27], v[44:47], a[216:219], v[24:27]
    v_mfma_f32_16x16x32_bf16 v[28:31], v[44:47], a[220:223], v[28:31]
    ds_read_b128 v[44:47], v7 offset:8192
    s_waitcnt lgkmcnt(2)
    v_mfma_f32_16x16x32_bf16 v[16:19], v[48:51], a[224:227], v[16:19]
    v_mfma_f32_16x16x32_bf16 v[20:23], v[48:51], a[228:231], v[20:23]
    v_mfma_f32_16x16x32_bf16 v[24:27], v[48:51], a[232:235], v[24:27]
    v_mfma_f32_16x16x32_bf16 v[28:31], v[48:51], a[236:239], v[28:31]
    ds_read_b128 v[48:51], v7 offset:8704
    s_waitcnt lgkmcnt(2)
    v_mfma_f32_16x16x32_bf16 v[16:19], v[40:43], a[240:243], v[16:19]
    v_mfma_f32_16x16x32_bf16 v[20:23], v[40:43], a[244:247], v[20:23]
    v_mfma_f32_16x16x32_bf16 v[24:27], v[40:43], a[248:251], v[24:27]
    v_mfma_f32_16x16x32_bf16 v[28:31], v[40:43], a[252:255], v[28:31]
    ds_read_b128 v[40:43], v7 offset:9216
    s_waitcnt lgkmcnt(2)
    v_mfma_f32_16x16x32_bf16 v[16:19], v[44:47], v[192:195], v[16:19]
    v_mfma_f32_16x16x32_bf16 v[20:23], v[44:47], v[196:199], v[20:23]
    v_mfma_f32_16x16x32_bf16 v[24:27], v[44:47], v[200:203], v[24:27]
    v_mfma_f32_16x16x32_bf16 v[28:31], v[44:47], v[204:207], v[28:31]
    ds_read_b128 v[44:47], v7 offset:9728
    s_waitcnt lgkmcnt(2)
    v_mfma_f32_16x16x32_bf16 v[16:19], v[48:51], v[208:211], v[16:19]
    v_mfma_f32_16x16x32_bf16 v[20:23], v[48:51], v[212:215], v[20:23]
    v_mfma_f32_16x16x32_bf16 v[24:27], v[48:51], v[216:219], v[24:27]
    v_mfma_f32_16x16x32_bf16 v[28:31], v[48:51], v[220:223], v[28:31]
    s_waitcnt lgkmcnt(1)
    v_mfma_f32_16x16x32_bf16 v[16:19], v[40:43], v[224:227], v[16:19]
    v_mfma_f32_16x16x32_bf16 v[20:23], v[40:43], v[228:231], v[20:23]
    v_mfma_f32_16x16x32_bf16 v[24:27], v[40:43], v[232:235], v[24:27]
    v_mfma_f32_16x16x32_bf16 v[28:31], v[40:43], v[236:239], v[28:31]
    s_waitcnt lgkmcnt(0)
    v_mfma_f32_16x16x32_bf16 v[16:19], v[44:47], v[240:243], v[16:19]
    v_mfma_f32_16x16x32_bf16 v[20:23], v[44:47], v[244:247], v[20:23]
    v_mfma_f32_16x16x32_bf16 v[24:27], v[44:47], v[248:251], v[24:27]
    v_mfma_f32_16x16x32_bf16 v[28:31], v[44:47], v[252:255], v[28:31]
    s_nop 7
    v_cvt_pk_bf16_f32 v52, v16, v17
    v_cvt_pk_bf16_f32 v53, v18, v19
    ds_write_b64 v8, v[52:53] offset:0
    v_cvt_pk_bf16_f32 v54, v20, v21
    v_cvt_pk_bf16_f32 v55, v22, v23
    ds_write_b64 v8, v[54:55] offset:256
    v_cvt_pk_bf16_f32 v56, v24, v25
    v_cvt_pk_bf16_f32 v57, v26, v27
    ds_write_b64 v8, v[56:57] offset:512
    v_cvt_pk_bf16_f32 v58, v28, v29
    v_cvt_pk_bf16_f32 v59, v30, v31
    ds_write_b64 v8, v[58:59] offset:768
    s_waitcnt lgkmcnt(0)
    ds_read_b128 v[104:107], v9 offset:0
    ds_read_b128 v[108:111], v9 offset:512
    s_waitcnt lgkmcnt(0)
    buffer_store_dwordx4 v[104:107], v10, s[24:27], s45 offen offset:0 sc1

    v_add_u32 v2, 40960, v10
    buffer_store_dwordx4 v[108:111], v2, s[24:27], s45 offen sc1
    s_mov_b32 s40, 0
op_poll_64:
    buffer_load_dwordx4 v[112:115], v15, s[12:15], s46 offen offset:0 sc1
    buffer_load_dwordx4 v[116:119], v15, s[12:15], s46 offen offset:640 sc1
    buffer_load_dwordx4 v[120:123], v15, s[12:15], s46 offen offset:1280 sc1
    buffer_load_dwordx4 v[124:127], v15, s[12:15], s46 offen offset:1920 sc1
    buffer_load_dwordx4 v[128:131], v15, s[12:15], s46 offen offset:2560 sc1
    buffer_load_dwordx4 v[132:135], v15, s[12:15], s46 offen offset:3200 sc1
    buffer_load_dwordx4 v[136:139], v15, s[12:15], s46 offen offset:3840 sc1
    buffer_load_dwordx4 v[140:143], v164, s[12:15], s46 offen offset:1920 sc1
    buffer_load_dwordx4 v[144:147], v3, s[12:15], s46 offen offset:0 sc1
    buffer_load_dwordx4 v[148:151], v3, s[12:15], s46 offen offset:2560 sc1
    s_waitcnt vmcnt(0)
    v_max3_u32 v2, v112, v113, v114
    v_max3_u32 v2, v2, v115, v116
    v_max3_u32 v2, v2, v117, v118
    v_max3_u32 v2, v2, v119, v120
    v_max3_u32 v2, v2, v121, v122
    v_max3_u32 v2, v2, v123, v124
    v_max3_u32 v2, v2, v125, v126
    v_max3_u32 v2, v2, v127, v128
    v_max3_u32 v2, v2, v129, v130
    v_max3_u32 v2, v2, v131, v132
    v_max3_u32 v2, v2, v133, v134
    v_max3_u32 v2, v2, v135, v136
    v_max3_u32 v2, v2, v137, v138
    v_max3_u32 v2, v2, v139, v140
    v_max3_u32 v2, v2, v141, v142
    v_max3_u32 v2, v2, v143, v144
    v_max3_u32 v2, v2, v145, v146
    v_max3_u32 v2, v2, v147, v148
    v_max3_u32 v2, v2, v149, v150
    v_max_u32 v2, v2, v151
    v_cmp_eq_u32 vcc, -1, v2
    s_cbranch_vccz op_ok_65
    s_add_u32 s40, s40, 1
    s_cmp_lt_u32 s40, 2097152
    s_cbranch_scc1 op_poll_64
    s_branch chain_fail
op_ok_65:
    v_mfma_f32_16x16x32_bf16 v[152:155], v[112:115], v[72:75], 0
    v_mfma_f32_16x16x32_bf16 v[152:155], v[116:119], v[76:79], v[152:155]
    v_mfma_f32_16x16x32_bf16 v[152:155], v[120:123], v[80:83], v[152:155]
    v_mfma_f32_16x16x32_bf16 v[152:155], v[124:127], v[84:87], v[152:155]
    v_mfma_f32_16x16x32_bf16 v[152:155], v[128:131], v[88:91], v[152:155]
    v_mfma_f32_16x16x32_bf16 v[152:155], v[132:135], v[92:95], v[152:155]
    v_mfma_f32_16x16x32_bf16 v[152:155], v[136:139], v[96:99], v[152:155]
    v_mfma_f32_16x16x32_bf16 v[152:155], v[140:143], v[100:103], v[152:155]
    v_mfma_f32_16x16x32_bf16 v[152:155], v[144:147], v[104:107], v[152:155]
    v_mfma_f32_16x16x32_bf16 v[152:155], v[148:151], v[108:111], v[152:155]
    s_add_u32 s44, s44, 1310720
    s_nop 7
    ds_write_b32 v160, v152 offset:0
    ds_write_b32 v160, v153 offset:32
    ds_write_b32 v160, v154 offset:64
    ds_write_b32 v160, v155 offset:96
    s_waitcnt lgkmcnt(0)
    s_barrier
    s_cmp_lg_u32 s38, 0
    s_cbranch_scc1 o_pre
    ds_read_b64 v[52:53], v161 offset:0
    ds_read_b64 v[54:55], v161 offset:256
    ds_read_b64 v[56:57], v161 offset:512
    ds_read_b64 v[58:59], v161 offset:768
    s_waitcnt lgkmcnt(0)
    v_add_f32 v52, v52, v54
    v_add_f32 v53, v53, v55
    v_add_f32 v56, v56, v58
    v_add_f32 v57, v57, v59
    v_add_f32 v52, v52, v56
    v_add_f32 v53, v53, v57
    v_cvt_pk_bf16_f32 v52, v52, v53
    v_min_u32 v52, -2, v52
    buffer_store_dword v52, v162, s[8:11], s47 offen sc1
o_pre:
    s_and_b32 s53, s52, 7
    s_cmp_lg_u32 s53, 0
    s_cbranch_scc1 uxw_66
    s_cmp_ge_u32 s52, 64
    s_cbranch_scc1 uxw_66
    s_lshr_b32 s53, s52, 3
    s_add_u32 s53, s53, 16
    s_lshl_b32 s53, s53, 7
    s_mov_b32 s40, 0
wf_67:
    v_mov_b32 v124, 0
    buffer_load_dword v124, v124, s[56:59], s53 offen sc1
    s_waitcnt vmcnt(0)
    v_readfirstlane_b32 s39, v124
    s_nop 3
    s_cmp_ge_u32 s39, 160
    s_cbranch_scc1 wf_ok_68
    s_add_u32 s40, s40, 1
    s_cmp_lt_u32 s40, 2097152
    s_cbranch_scc1 wf_67
    s_branch chain_fail
wf_ok_68:
uxw_66:
    s_add_u32 s52, s52, 1
    buffer_load_dwordx4 v[72:75], v14, s[20:23], s44 offen sc1
    v_add_u32 v2, 40960, v14
    buffer_load_dwordx4 v[76:79], v2, s[20:23], s44 offen sc1
    v_add_u32 v2, 81920, v14
    buffer_load_dwordx4 v[80:83], v2, s[20:23], s44 offen sc1
    v_add_u32 v2, 122880, v14
    buffer_load_dwordx4 v[84:87], v2, s[20:23], s44 offen sc1
    v_add_u32 v2, 163840, v14
    buffer_load_dwordx4 v[88:91], v2, s[20:23], s44 offen sc1
    v_add_u32 v2, 204800, v14
    buffer_load_dwordx4 v[92:95], v2, s[20:23], s44 offen sc1
    v_add_u32 v2, 245760, v14
    buffer_load_dwordx4 v[96:99], v2, s[20:23], s44 offen sc1
    v_add_u32 v2, 286720, v14
    buffer_load_dwordx4 v[100:103], v2, s[20:23], s44 offen sc1
o_next:
    s_add_u32 s3, s3, 1
    s_add_u32 s41, s41, 10240
    s_add_u32 s47, s47, 10240
    s_add_u32 s45, s45, 327680
    s_add_u32 s46, s46, 20480
    s_cmp_lt_u32 s3, 64
    s_cbranch_scc1 o_loop
    s_waitcnt vmcnt(0)
    s_barrier
    s_cmp_lg_u32 s38, 1
    s_cbranch_scc1 chain_end
    s_mov_b32 s53, 14208
    s_mov_b64 exec, 1
    v_mov_b32 v124, 1
    v_mov_b32 v125, 0
    buffer_atomic_add v124, v125, s[56:59], s53 offen sc1
    s_mov_b64 exec, -1
    s_endpgm
chain_fail:
    s_load_dwordx2 s[36:37], s[0:1], 96
    s_waitcnt lgkmcnt(0)
    s_mov_b32 s48, s36
    s_mov_b32 s49, s37
    s_mov_b32 s50, 256
    s_mov_b32 s51, 0x00020000
    v_mov_b32 v2, 0xdead
    v_mov_b32 v3, 0
    buffer_store_dword v2, v3, s[48:51], 0 offen
chain_end:
    s_endpgm
.section .rodata,"a"
.p2align 6
.amdhsa_kernel mega_kernel
  .amdhsa_next_free_vgpr 512
  .amdhsa_next_free_sgpr 96
  .amdhsa_accum_offset 256
  .amdhsa_group_segment_fixed_size 0
  .amdhsa_kernarg_size 112
  .amdhsa_user_sgpr_count 2
  .amdhsa_user_sgpr_kernarg_segment_ptr 1
  .amdhsa_system_sgpr_workgroup_id_x 1
.end_amdhsa_kernel
```
